```python
import torch

def _softmax(x, axis=-1):
    return torch.softmax(x, dim=axis)

def _gelu(x):
    return torch.nn.functional.gelu(x, approximate='tanh')

def _silu(x):
    return torch.nn.functional.silu(x)

def _sigmoid(x):
    return torch.sigmoid(x)

def _layernorm(x, axis=-1, eps=1e-05):
    m = x.mean(dim=axis, keepdim=True)
    v = x.var(dim=axis, keepdim=True, unbiased=False)
    return (x - m) / torch.sqrt(v + eps)

def _scatter_add(tgt, idx, src, axis=0):
    return tgt.clone().index_add_(axis, idx, src)

def _segment_sum(src, seg, n):
    out = torch.zeros((n,) + src.shape[1:], dtype=src.dtype)
    return out.index_add_(0, seg, src)

def _pad(x, pw):
    flat = tuple((v for pair in reversed(pw) for v in pair))
    return torch.nn.functional.pad(x, flat)
kernel_name = 'adaLN_cond__sliding_local_dilated__dense_activation_relu__prompt'

def setup_inputs():

    _w = lambda a: (lambda t: t.to(torch.bfloat16) if t.is_floating_point() else t)(torch.as_tensor(a))

    def _A_setup():
        B, S, D = (1, 2048, 576)
        return {'x': _w((lambda *s: torch.randn(*s, dtype=torch.bfloat16) * 0.05)(B, S, D)), 'wqkv': _w((lambda *s: torch.randn(*s, dtype=torch.bfloat16) * 0.05)(D, 3 * D)), 'wo': _w((lambda *s: torch.randn(*s, dtype=torch.bfloat16) * 0.05)(D, D))}
    _A_in = _A_setup()

    def _B_setup():
        B, S, D, Dff = (1, 2048, 576, 4608)
        return {'x': _w((lambda *s: torch.randn(*s, dtype=torch.bfloat16) * 0.05)(B, S, D)), 'w1': _w((lambda *s: torch.randn(*s, dtype=torch.bfloat16) * 0.05)(D, Dff)), 'w2': _w((lambda *s: torch.randn(*s, dtype=torch.bfloat16) * 0.05)(Dff, D))}
    _B_in = _B_setup()
    return {'A_x': _A_in['x'], 'A_wqkv': _A_in['wqkv'], 'A_wo': _A_in['wo'], 'B_x': _B_in['x'], 'B_w1': _B_in['w1'], 'B_w2': _B_in['w2'], 'c': _w((lambda *s: torch.randn(*s, dtype=torch.bfloat16) * 0.1)(1, 576) * 8.0), 'w_mod': _w((lambda *s: torch.randn(*s, dtype=torch.bfloat16) * 0.1)(576, 6 * 576) * 576 ** (-0.5) * 8.0)}

def reference(A_x, A_wqkv, A_wo, B_x, B_w1, B_w2, c, w_mod):

    def _A_ref(x, wqkv, wo):
        B, S, D = x.shape
        H = 32
        Dh = D // H
        W, dil = (8, 2)
        qkv = (lambda x, *d: x.permute(*d))((x @ wqkv).reshape(B, S, 3, H, Dh), 2, 0, 3, 1, 4)
        q, k, v = (qkv[0], qkv[1], qkv[2])
        scale = Dh ** (-0.5)
        pos = torch.arange(S)
        off = torch.arange(W) * dil
        idx = pos[:, None] - off[None, :]
        mask = idx >= 0
        idx_c = torch.where(mask, idx, 0).reshape(-1)
        kg = k[:, :, idx_c, :].reshape(B, H, S, W, Dh)
        vg = v[:, :, idx_c, :].reshape(B, H, S, W, Dh)
        logits = torch.einsum('bhsd,bhswd->bhsw', q, kg) * scale
        logits = torch.where(mask[None, None, :, :], logits, -1000000000.0)
        attn = _softmax(logits, axis=-1)
        o = torch.einsum('bhsw,bhswd->bhsd', attn, vg)
        return (lambda x, *d: x.permute(*d))(o, 0, 2, 1, 3).reshape(B, S, D) @ wo

    def _B_ref(x, w1, w2):
        h = torch.einsum('bsd,df->bsf', x, w1)
        zero = torch.zeros_like(h)
        h = torch.maximum(h, zero)
        return torch.einsum('bsf,fd->bsd', h, w2)
    x = A_x
    mod = (_silu(c) @ w_mod).reshape(c.shape[0], 6, 1, -1)
    sa, ca, ga, sb, cb, gb = (mod[:, 0].clone(), mod[:, 1].clone(), mod[:, 2].clone(), mod[:, 3].clone(), mod[:, 4].clone(), mod[:, 5].clone())
    h = _layernorm(x, axis=-1) * (1 + ca) + sa
    x = x + ga * _A_ref(h, A_wqkv, A_wo)
    h = _layernorm(x, axis=-1) * (1 + cb) + sb
    x = x + gb * _B_ref(h, B_w1, B_w2)
    return x
```

```asm
; @launch grid=(256,1,1) block=(256,1,1) lds=163840
.amdgcn_target "amdgcn-amd-amdhsa--gfx950"
.text
.globl adaLN_cond__sliding_local_dilated__dense_activation_relu__prompt_kernel
.p2align 8
.type adaLN_cond__sliding_local_dilated__dense_activation_relu__prompt_kernel,@function
adaLN_cond__sliding_local_dilated__dense_activation_relu__prompt_kernel:
s_cmp_ge_u32 s2, 256
s_cbranch_scc1 L_end
s_load_dwordx4 s[56:59], s[0:1], 0
s_load_dwordx2 s[60:61], s[0:1], 16
s_load_dwordx8 s[64:71], s[0:1], 32
s_load_dwordx4 s[72:75], s[0:1], 64
s_load_dwordx2 s[62:63], s[0:1], 80
v_and_b32 v1, 63, v0
v_lshrrev_b32 v2, 6, v0
s_nop 0
v_readfirstlane_b32 s48, v2
s_getpc_b64 s[6:7]
s_lshr_b32 s53, s2, 3
s_lshl_b32 s53, s53, 2
s_add_u32 s53, s53, s48
s_lshl_b32 s53, s53, 9
v_lshl_add_u32 v2, v1, 7, s53
v_min_u32 v2, (L_end-L_pc1), v2
v_mov_b32 v3, s7
v_add_co_u32 v2, vcc, s6, v2
s_nop 1
v_addc_co_u32 v3, vcc, 0, v3, vcc
s_mov_b64 exec, 15
global_load_dword v253, v[2:3], off
s_mov_b64 exec, -1
L_pc1:
s_and_b32 s53, s2, 7
s_lshr_b32 s54, s2, 3
s_and_b32 s50, s53, 3
s_lshl_b32 s50, s50, 1
s_and_b32 s55, s54, 1
s_add_u32 s50, s50, s55
s_lshr_b32 s49, s53, 2
s_lshl_b32 s49, s49, 4
s_lshr_b32 s55, s54, 1
s_add_u32 s49, s49, s55
s_and_b32 s52, s53, 3
s_lshl_b32 s52, s52, 1
s_and_b32 s55, s54, 1
s_add_u32 s52, s52, s55
s_lshr_b32 s51, s53, 2
s_lshl_b32 s51, s51, 4
s_lshr_b32 s55, s54, 1
s_add_u32 s51, s51, s55
s_waitcnt lgkmcnt(0)
s_load_dword s4, s[62:63], 0
s_mov_b64 s[28:29], s[70:71]
s_mov_b32 s30, 3981312
s_mov_b32 s31, 0x20000
s_mov_b64 s[32:33], s[68:69]
s_mov_b32 s34, 1152
s_mov_b32 s35, 0x20000
v_lshrrev_b32 v2, 3, v0
v_and_b32 v3, 7, v0
v_mul_u32_u24 v4, 6912, v2
v_lshl_add_u32 v242, v3, 4, v4
v_lshlrev_b32 v5, 1, v2
s_and_b32 s54, s2, 3
s_mul_i32 s53, s54, 995328
s_mul_i32 s54, s54, 288
s_lshr_b32 s55, s2, 2
s_lshl_b32 s55, s55, 7
s_add_u32 s53, s53, s55
s_cmp_ge_u32 s2, 216
s_cselect_b32 s3, 0x70000000, s53
buffer_load_ushort v164, v5, s[32:35], s54 offen offset:0
buffer_load_ushort v165, v5, s[32:35], s54 offen offset:64
buffer_load_ushort v166, v5, s[32:35], s54 offen offset:128
buffer_load_ushort v167, v5, s[32:35], s54 offen offset:192
buffer_load_ushort v168, v5, s[32:35], s54 offen offset:256
s_cmp_lt_u32 s2, 72
s_cbranch_scc0 L_oAl
buffer_load_dwordx4 v[144:147], v242, s[28:31], s3 offen
s_add_u32 s3, s3, 221184
buffer_load_dwordx4 v[148:151], v242, s[28:31], s3 offen
s_add_u32 s3, s3, 221184
buffer_load_dwordx4 v[152:155], v242, s[28:31], s3 offen
s_add_u32 s3, s3, 221184
buffer_load_dwordx4 v[156:159], v242, s[28:31], s3 offen
s_add_u32 s3, s3, 221184
s_cmp_ge_u32 s48, 2
s_cselect_b32 s3, 0x7ff00000, s3
buffer_load_dwordx4 v[160:163], v242, s[28:31], s3 offen
s_add_u32 s3, s3, 221184
L_oAl:
s_mov_b64 s[8:9], s[56:57]
s_mov_b32 s10, 2359296
s_mov_b32 s11, 0x20000
s_mov_b64 s[12:13], s[58:59]
s_mov_b32 s14, 1990656
s_mov_b32 s15, 0x20000
s_mov_b64 s[16:17], s[60:61]
s_mov_b32 s18, 663552
s_mov_b32 s19, 0x20000
s_mov_b64 s[20:21], s[64:65]
s_mov_b32 s22, 5308416
s_mov_b32 s23, 0x20000
s_mov_b64 s[24:25], s[66:67]
s_mov_b32 s26, 5308416
s_mov_b32 s27, 0x20000
s_mov_b64 s[36:37], s[72:73]
s_mov_b32 s38, 2359296
s_mov_b32 s39, 0x20000
s_mov_b64 s[44:45], s[62:63]
s_mov_b32 s46, 22872064
s_mov_b32 s47, 0x20000
v_and_b32 v6, 15, v1
v_lshrrev_b32 v7, 4, v1
v_lshlrev_b32 v9, 4, v1
s_mov_b32 s56, 0xaaaaaaaa
s_mov_b32 s57, 0xaaaaaaaa
s_mov_b32 s58, 0xcccccccc
s_mov_b32 s59, 0xcccccccc
v_bfe_u32 v28, v1, 2, 3
v_lshrrev_b32 v29, 5, v1
s_and_b32 s54, s50, 1
s_lshl_b32 s53, s54, 1
v_and_b32 v2, 1, v7
v_add_u32 v2, s53, v2
v_sub_u32 v2, 0, v2
v_xor_b32 v2, v2, v1
v_and_b32 v30, 3, v2
v_mul_u32_u24 v2, 1152, v28
v_lshl_add_u32 v2, v30, 4, v2
v_lshl_add_u32 v3, v29, 6, v2
s_lshl_b32 s53, s48, 8
v_add_u32 v19, s53, v3
s_mul_i32 s64, s49, 73728
s_mul_i32 s65, s50, 9216
s_add_u32 s65, s65, s64
buffer_load_dwordx4 v[36:39], v19, s[8:11], s65 offen
buffer_load_dwordx4 v[44:47], v19, s[8:11], s65 offen offset:128
s_and_b32 s55, s48, 1
s_lshl_b32 s53, s55, 6
v_add_u32 v20, s53, v2
s_cmp_lt_u32 s48, 2
s_cselect_b32 s53, 32, 0
v_cmp_gt_u32 vcc, s53, v1
v_bfrev_b32 v31, -2
s_nop 0
v_cndmask_b32 v20, v31, v20, vcc
buffer_load_dwordx4 v[52:55], v20, s[8:11], s65 offen offset:1024
v_and_b32 v2, 31, v1
v_lshlrev_b32 v2, 4, v2
s_lshl_b32 s53, s54, 9
v_add_u32 v2, s53, v2
v_lshl_add_u32 v22, v29, 10, v2
s_lshl_b32 s53, s48, 12
v_add_u32 v22, s53, v22
s_lshl_b32 s53, s55, 10
s_add_u32 s72, s53, 16384
v_add_u32 v23, s72, v2
v_cndmask_b32 v23, v31, v23, vcc
v_mul_u32_u24 v2, 21846, v1
v_lshrrev_b32 v2, 16, v2
v_mul_u32_u24 v2, 768, v2
v_lshl_add_u32 v2, v1, 7, v2
v_cmp_gt_u32 vcc, 18, v1
s_lshr_b32 s75, s50, 1
s_mul_i32 s75, s75, 288
v_cndmask_b32 v27, v31, v2, vcc
s_and_b32 s75, s75, -128
s_lshr_b32 s74, s2, 3
s_mul_i32 s74, s74, 6912
s_add_u32 s75, s75, s74
s_lshl_b32 s74, s48, 2
s_lshr_b32 s74, 62496, s74
s_and_b32 s74, s74, 15
s_mul_i32 s74, s74, 221184
s_add_u32 s74, s74, s75
buffer_load_dword v250, v27, s[12:15], s74 offen
v_lshlrev_b32 v2, 5, v30
v_add_u32 v2, 147456, v2
v_lshl_add_u32 v24, v29, 7, v2
s_lshl_b32 s53, s48, 9
v_add_u32 v24, s53, v24
s_lshl_b32 s53, s55, 7
s_add_u32 s53, s53, 2048
v_add_u32 v25, s53, v2
s_lshr_b32 s53, s50, 1
s_mul_i32 s53, s53, 18432
s_mul_i32 s66, s49, 608256
s_add_u32 s66, s66, 3745792
s_lshl_b32 s71, s48, 12
s_add_u32 s68, s66, s71
s_add_u32 s70, s66, s72
s_add_u32 s66, s66, s53
s_min_u32 s53, s49, 1
s_mul_i32 s53, s53, 552960
s_sub_u32 s67, s68, s53
s_sub_u32 s69, s70, s53
s_mul_i32 s53, s49, 24576
s_lshl_b32 s73, s48, 10
s_add_u32 s73, s73, 217088
s_max_u32 s54, s49, 1
s_mul_i32 s54, s54, 24576
s_sub_u32 s54, s54, 24832
v_lshlrev_b32 v2, 7, v1
v_add_u32 v3, s53, v2
v_add_u32 v2, s54, v2
v_cmp_gt_u32 vcc, 8, v1
s_nop 1
v_cndmask_b32 v26, v2, v3, vcc
s_mul_i32 s53, s49, 192
s_add_u32 s53, s53, s50
s_mul_i32 s54, s51, 192
s_add_u32 s54, s54, s52
v_mov_b32 v2, s53
v_mov_b32 v3, s54
s_mov_b64 vcc, 28
s_lshl_b32 s53, s2, 7
v_cndmask_b32 v2, v2, v3, vcc
v_lshl_add_u32 v2, v1, 5, v2
v_lshlrev_b32 v2, 7, v2
s_lshl_b32 s54, s48, 10
s_add_u32 s54, s54, 196608
v_add_u32 v248, s54, v2
s_add_u32 s53, s53, 163840
v_writelane_b32 v248, s53, 6
v_mul_u32_u24 v2, 2428, v1
v_lshrrev_b32 v2, 16, v2
v_mul_u32_u24 v3, 27, v2
v_sub_u32 v3, v1, v3
v_mul_u32_u24 v4, 7282, v3
v_lshrrev_b32 v4, 16, v4
v_mul_u32_u24 v5, 9, v4
v_sub_u32 v5, v3, v5
v_mul_u32_u24 v10, 55296, v2
v_mul_u32_u24 v4, 1152, v4
v_add_u32 v10, v10, v4
v_lshl_add_u32 v10, v5, 4, v10
s_and_b32 s53, s48, 1
s_lshl_b32 s53, s53, 3
s_lshr_b32 s54, s48, 1
s_lshl_b32 s54, s54, 2
s_add_u32 s53, s53, s54
s_mul_i32 s60, s53, 3456
s_mul_i32 s54, s50, 144
s_add_u32 s60, s60, s54
s_mul_i32 s61, s48, 3456
v_and_b32 v2, 1, v7
v_bfe_u32 v3, v1, 2, 2
v_lshl_add_u32 v2, v2, 2, v3
v_lshrrev_b32 v3, 1, v7
v_lshl_add_u32 v15, v2, 1, v3
v_and_b32 v16, 3, v1
s_mul_i32 s53, s48, 36
s_and_b32 s54, s48, 1
s_lshl_b32 s54, s54, 2
s_add_u32 s53, s53, s54
s_lshr_b32 s54, s48, 1
s_mul_i32 s54, s54, 72
s_add_u32 s54, s54, 32
v_mul_u32_u24 v2, 432, v15
v_lshl_add_u32 v11, v16, 3, v2
v_add_u32 v11, s53, v11
v_min_u32 v3, 2, v16
v_mul_u32_u24 v3, 144, v3
v_add3_u32 v12, v2, v3, s54
v_add_u32 v13, 41472, v11
v_add_u32 v14, 41472, v12
v_add_u32 v196, 92160, v11
v_add_u32 v197, 92160, v12
v_add_u32 v8, 2592, v10
v_add_u32 v17, 5184, v10
v_add_u32 v18, 7776, v10
s_waitcnt lgkmcnt(0)
s_mul_i32 s4, s4, 1664525
s_add_u32 s4, s4, 1013904223
v_mov_b32 v21, s4
s_cmp_lt_u32 s2, 72
s_cbranch_scc0 L_oAm
s_waitcnt vmcnt(9)
v_lshlrev_b32 v164, 16, v164
v_mul_f32 v170, 0xbfb8aa3b, v164
v_lshlrev_b32 v165, 16, v165
v_mul_f32 v171, 0xbfb8aa3b, v165
v_lshlrev_b32 v166, 16, v166
v_mul_f32 v172, 0xbfb8aa3b, v166
v_lshlrev_b32 v167, 16, v167
v_mul_f32 v173, 0xbfb8aa3b, v167
v_lshlrev_b32 v168, 16, v168
v_mul_f32 v174, 0xbfb8aa3b, v168
v_exp_f32 v170, v170
v_exp_f32 v171, v171
v_exp_f32 v172, v172
v_exp_f32 v173, v173
v_exp_f32 v174, v174
v_add_f32 v170, 1.0, v170
v_add_f32 v171, 1.0, v171
v_add_f32 v172, 1.0, v172
v_add_f32 v173, 1.0, v173
v_add_f32 v174, 1.0, v174
v_rcp_f32 v170, v170
v_rcp_f32 v171, v171
v_rcp_f32 v172, v172
v_rcp_f32 v173, v173
v_rcp_f32 v174, v174
v_mul_f32 v164, v164, v170
v_mul_f32 v165, v165, v171
v_mul_f32 v166, v166, v172
v_mul_f32 v167, v167, v173
v_mul_f32 v168, v168, v174
v_cvt_pk_bf16_f32 v164, v164, v164
v_cvt_pk_bf16_f32 v165, v165, v165
v_cvt_pk_bf16_f32 v166, v166, v166
v_cvt_pk_bf16_f32 v167, v167, v167
v_cvt_pk_bf16_f32 v168, v168, v168
v_and_b32 v170, 0xffff0000, v164
v_and_b32 v172, 0xffff0000, v165
v_and_b32 v174, 0xffff0000, v166
v_and_b32 v176, 0xffff0000, v167
v_and_b32 v178, 0xffff0000, v168
s_waitcnt vmcnt(8)
v_lshlrev_b32 v232, 16, v144
v_and_b32 v233, 0xffff0000, v144
v_lshlrev_b32 v234, 16, v145
v_and_b32 v235, 0xffff0000, v145
v_lshlrev_b32 v236, 16, v146
v_and_b32 v237, 0xffff0000, v146
v_lshlrev_b32 v238, 16, v147
v_and_b32 v239, 0xffff0000, v147
v_pk_mul_f32 v[224:225], v[232:233], v[170:171] op_sel_hi:[1,0]
v_pk_mul_f32 v[226:227], v[234:235], v[170:171] op_sel_hi:[1,0]
v_pk_mul_f32 v[228:229], v[236:237], v[170:171] op_sel_hi:[1,0]
v_pk_mul_f32 v[230:231], v[238:239], v[170:171] op_sel_hi:[1,0]
s_waitcnt vmcnt(7)
v_lshlrev_b32 v232, 16, v148
v_and_b32 v233, 0xffff0000, v148
v_lshlrev_b32 v234, 16, v149
v_and_b32 v235, 0xffff0000, v149
v_lshlrev_b32 v236, 16, v150
v_and_b32 v237, 0xffff0000, v150
v_lshlrev_b32 v238, 16, v151
v_and_b32 v239, 0xffff0000, v151
v_pk_fma_f32 v[224:225], v[232:233], v[172:173], v[224:225] op_sel_hi:[1,0,1]
v_pk_fma_f32 v[226:227], v[234:235], v[172:173], v[226:227] op_sel_hi:[1,0,1]
v_pk_fma_f32 v[228:229], v[236:237], v[172:173], v[228:229] op_sel_hi:[1,0,1]
v_pk_fma_f32 v[230:231], v[238:239], v[172:173], v[230:231] op_sel_hi:[1,0,1]
s_waitcnt vmcnt(6)
v_lshlrev_b32 v232, 16, v152
v_and_b32 v233, 0xffff0000, v152
v_lshlrev_b32 v234, 16, v153
v_and_b32 v235, 0xffff0000, v153
v_lshlrev_b32 v236, 16, v154
v_and_b32 v237, 0xffff0000, v154
v_lshlrev_b32 v238, 16, v155
v_and_b32 v239, 0xffff0000, v155
v_pk_fma_f32 v[224:225], v[232:233], v[174:175], v[224:225] op_sel_hi:[1,0,1]
v_pk_fma_f32 v[226:227], v[234:235], v[174:175], v[226:227] op_sel_hi:[1,0,1]
v_pk_fma_f32 v[228:229], v[236:237], v[174:175], v[228:229] op_sel_hi:[1,0,1]
v_pk_fma_f32 v[230:231], v[238:239], v[174:175], v[230:231] op_sel_hi:[1,0,1]
s_waitcnt vmcnt(5)
v_lshlrev_b32 v232, 16, v156
v_and_b32 v233, 0xffff0000, v156
v_lshlrev_b32 v234, 16, v157
v_and_b32 v235, 0xffff0000, v157
v_lshlrev_b32 v236, 16, v158
v_and_b32 v237, 0xffff0000, v158
v_lshlrev_b32 v238, 16, v159
v_and_b32 v239, 0xffff0000, v159
v_pk_fma_f32 v[224:225], v[232:233], v[176:177], v[224:225] op_sel_hi:[1,0,1]
v_pk_fma_f32 v[226:227], v[234:235], v[176:177], v[226:227] op_sel_hi:[1,0,1]
v_pk_fma_f32 v[228:229], v[236:237], v[176:177], v[228:229] op_sel_hi:[1,0,1]
v_pk_fma_f32 v[230:231], v[238:239], v[176:177], v[230:231] op_sel_hi:[1,0,1]
s_waitcnt vmcnt(4)
v_lshlrev_b32 v232, 16, v160
v_and_b32 v233, 0xffff0000, v160
v_lshlrev_b32 v234, 16, v161
v_and_b32 v235, 0xffff0000, v161
v_lshlrev_b32 v236, 16, v162
v_and_b32 v237, 0xffff0000, v162
v_lshlrev_b32 v238, 16, v163
v_and_b32 v239, 0xffff0000, v163
v_pk_fma_f32 v[224:225], v[232:233], v[178:179], v[224:225] op_sel_hi:[1,0,1]
v_pk_fma_f32 v[226:227], v[234:235], v[178:179], v[226:227] op_sel_hi:[1,0,1]
v_pk_fma_f32 v[228:229], v[236:237], v[178:179], v[228:229] op_sel_hi:[1,0,1]
v_pk_fma_f32 v[230:231], v[238:239], v[178:179], v[230:231] op_sel_hi:[1,0,1]
v_add_f32_dpp v224, v224, v224 row_ror:8 row_mask:0xf bank_mask:0xf
v_add_f32_dpp v225, v225, v225 row_ror:8 row_mask:0xf bank_mask:0xf
v_add_f32_dpp v226, v226, v226 row_ror:8 row_mask:0xf bank_mask:0xf
v_add_f32_dpp v227, v227, v227 row_ror:8 row_mask:0xf bank_mask:0xf
v_add_f32_dpp v228, v228, v228 row_ror:8 row_mask:0xf bank_mask:0xf
v_add_f32_dpp v229, v229, v229 row_ror:8 row_mask:0xf bank_mask:0xf
v_add_f32_dpp v230, v230, v230 row_ror:8 row_mask:0xf bank_mask:0xf
v_add_f32_dpp v231, v231, v231 row_ror:8 row_mask:0xf bank_mask:0xf
v_lshrrev_b32 v240, 4, v0
v_and_b32 v241, 7, v0
v_lshlrev_b32 v240, 8, v240
v_lshl_add_u32 v240, v241, 5, v240
v_add_u32 v240, 82944, v240
s_mov_b32 exec_lo, 0xff00ff
s_mov_b32 exec_hi, 0xff00ff
ds_write_b128 v240, v[224:227]
ds_write_b128 v240, v[228:231] offset:16
s_mov_b64 exec, -1
s_waitcnt lgkmcnt(0)
s_barrier
s_cmp_lg_u32 s48, 3
s_cbranch_scc1 L_nomodA
s_cmp_ge_u32 s2, 216
s_cbranch_scc1 L_nomodA
v_lshlrev_b32 v240, 2, v1
v_add_u32 v241, 82944, v240
ds_read2st64_b32 v[224:225], v241 offset0:0 offset1:1
ds_read2st64_b32 v[226:227], v241 offset0:2 offset1:3
ds_read2st64_b32 v[228:229], v241 offset0:4 offset1:5
ds_read2st64_b32 v[230:231], v241 offset0:6 offset1:7
ds_read2st64_b32 v[232:233], v241 offset0:8 offset1:9
ds_read2st64_b32 v[234:235], v241 offset0:10 offset1:11
ds_read2st64_b32 v[236:237], v241 offset0:12 offset1:13
ds_read2st64_b32 v[238:239], v241 offset0:14 offset1:15
s_and_b32 s53, s2, 3
s_mul_i32 s53, s53, 13824
s_lshr_b32 s54, s2, 2
s_lshl_b32 s54, s54, 8
s_add_u32 s53, s53, s54
s_add_u32 s53, s53, 4096
s_waitcnt lgkmcnt(0)
v_pk_add_f32 v[224:225], v[224:225], v[232:233]
v_pk_add_f32 v[226:227], v[226:227], v[234:235]
v_pk_add_f32 v[228:229], v[228:229], v[236:237]
v_pk_add_f32 v[230:231], v[230:231], v[238:239]
v_pk_add_f32 v[224:225], v[224:225], v[228:229]
v_pk_add_f32 v[226:227], v[226:227], v[230:231]
v_pk_add_f32 v[224:225], v[224:225], v[226:227]
v_add_f32 v224, v224, v225
buffer_store_dword v224, v240, s[44:47], s53 offen sc1
L_nomodA:
L_oAm:
s_waitcnt vmcnt(3)
s_add_u32 m0, s61, 0
s_add_u32 s76, s60, 0
s_mov_b32 exec_hi, 0x3fffff
buffer_load_dwordx4 v10, s[12:15], s76 offen offset:0 lds
s_mov_b32 exec_hi, -1
v_lshlrev_b32 v32, 16, v36
v_and_b32 v33, 0xffff0000, v36
v_lshlrev_b32 v34, 16, v37
v_and_b32 v35, 0xffff0000, v37
v_lshlrev_b32 v36, 16, v38
v_and_b32 v37, 0xffff0000, v38
v_lshlrev_b32 v38, 16, v39
v_and_b32 v39, 0xffff0000, v39
v_pk_mul_f32 v[58:59], v[32:33], v[32:33]
v_pk_add_f32 v[56:57], v[34:35], v[32:33]
v_pk_fma_f32 v[58:59], v[34:35], v[34:35], v[58:59]
v_pk_add_f32 v[56:57], v[36:37], v[56:57]
v_pk_fma_f32 v[58:59], v[36:37], v[36:37], v[58:59]
v_pk_add_f32 v[56:57], v[38:39], v[56:57]
v_pk_fma_f32 v[58:59], v[38:39], v[38:39], v[58:59]
s_waitcnt vmcnt(3)
v_lshlrev_b32 v40, 16, v44
v_and_b32 v41, 0xffff0000, v44
v_lshlrev_b32 v42, 16, v45
v_and_b32 v43, 0xffff0000, v45
v_lshlrev_b32 v44, 16, v46
v_and_b32 v45, 0xffff0000, v46
v_lshlrev_b32 v46, 16, v47
v_and_b32 v47, 0xffff0000, v47
v_pk_add_f32 v[56:57], v[40:41], v[56:57]
v_pk_fma_f32 v[58:59], v[40:41], v[40:41], v[58:59]
v_pk_add_f32 v[56:57], v[42:43], v[56:57]
v_pk_fma_f32 v[58:59], v[42:43], v[42:43], v[58:59]
v_pk_add_f32 v[56:57], v[44:45], v[56:57]
v_pk_fma_f32 v[58:59], v[44:45], v[44:45], v[58:59]
v_pk_add_f32 v[56:57], v[46:47], v[56:57]
v_pk_fma_f32 v[58:59], v[46:47], v[46:47], v[58:59]
s_waitcnt vmcnt(2)
v_lshlrev_b32 v48, 16, v52
v_and_b32 v49, 0xffff0000, v52
v_lshlrev_b32 v50, 16, v53
v_and_b32 v51, 0xffff0000, v53
v_lshlrev_b32 v52, 16, v54
v_and_b32 v53, 0xffff0000, v54
v_lshlrev_b32 v54, 16, v55
v_and_b32 v55, 0xffff0000, v55
v_pk_add_f32 v[56:57], v[48:49], v[56:57]
v_pk_fma_f32 v[58:59], v[48:49], v[48:49], v[58:59]
v_pk_add_f32 v[56:57], v[50:51], v[56:57]
v_pk_fma_f32 v[58:59], v[50:51], v[50:51], v[58:59]
v_pk_add_f32 v[56:57], v[52:53], v[56:57]
v_pk_fma_f32 v[58:59], v[52:53], v[52:53], v[58:59]
v_pk_add_f32 v[56:57], v[54:55], v[56:57]
s_mov_b32 exec_hi, 0x3fffff
buffer_load_dwordx4 v8, s[12:15], s76 offen offset:864 lds
s_mov_b32 exec_hi, -1
v_pk_fma_f32 v[58:59], v[54:55], v[54:55], v[58:59]
v_add_f32 v56, v56, v57
v_add_f32 v57, v58, v59
s_lshl_b32 s53, s48, 3
v_lshlrev_b32 v4, 5, v28
v_add_u32 v4, 87040, v4
v_add_u32 v3, s53, v4
v_add_f32_dpp v56, v56, v56 quad_perm:[1,0,3,2] row_mask:0xf bank_mask:0xf
v_add_f32_dpp v57, v57, v57 quad_perm:[1,0,3,2] row_mask:0xf bank_mask:0xf
s_nop 0
v_add_f32_dpp v56, v56, v56 quad_perm:[2,3,0,1] row_mask:0xf bank_mask:0xf
v_add_f32_dpp v57, v57, v57 quad_perm:[2,3,0,1] row_mask:0xf bank_mask:0xf
v_mov_b32 v58, v56
v_mov_b32 v59, v57
s_nop 0
v_permlane32_swap_b32 v58, v56
v_permlane32_swap_b32 v59, v57
v_add_f32 v56, v56, v58
v_add_f32 v57, v57, v59
ds_write_b64 v3, v[56:57]
v_bfe_u32 v2, v1, 2, 1
s_lshl_b32 s53, s48, 1
v_add_u32 v2, s53, v2
v_and_b32 v5, 8, v1
v_max_u32 v2, v2, v5
v_bfe_u32 v5, v1, 4, 1
v_mad_u32_u24 v2, v5, 9, v2
v_lshl_add_u32 v2, v2, 2, v16
v_lshlrev_b32 v19, 7, v2
s_mov_b32 s5, 163840
v_lshrrev_b32 v2, 5, v1
v_cvt_f32_u32 v28, v2
v_mul_u32_u24 v2, 1792, v2
s_lshl_b32 s53, s48, 9
v_add3_u32 v30, v2, v9, s53
v_bfe_u32 v3, v1, 3, 1
v_cvt_f32_u32 v29, v3
v_mul_u32_u24 v3, 2176, v3
v_lshl_add_u32 v3, v6, 4, v3
s_lshr_b32 s54, s72, 3
v_add_u32 v31, s54, v3
v_add_u32 v2, 147456, v30
v_add_u32 v5, 147456, v31
v_lshrrev_b32 v3, 2, v6
v_sub_u32 v3, 0, v3
v_xor_b32 v3, v3, v7
v_and_b32 v3, 3, v3
v_lshlrev_b32 v3, 4, v3
v_lshl_add_u32 v215, v6, 6, v3
v_add_u32 v214, 55296, v215
s_cmp_lt_u32 s2, 72
s_cbranch_scc0 L_oAs
s_cmp_lg_u32 s48, 3
s_cbranch_scc1 L_nosigA
s_lshl_b32 s53, s2, 7
s_add_u32 s53, s53, 163840
v_lshlrev_b32 v247, 2, v1
s_waitcnt vmcnt(2)
s_mov_b32 exec_lo, 0xffffffff
s_mov_b32 exec_hi, 0x0
buffer_store_dword v21, v247, s[44:47], s53 offen sc1
s_mov_b64 exec, -1
L_nosigA:
L_oAs:
s_mov_b64 exec, 63
buffer_load_dword v249, v248, s[44:47], 0 offen
s_mov_b64 exec, -1
s_lshl_b32 s74, s48, 2
s_lshr_b32 s74, 21270, s74
s_and_b32 s74, s74, 15
s_mul_i32 s74, s74, 221184
s_add_u32 s74, s74, s75
buffer_load_dword v251, v27, s[12:15], s74 offen
s_mov_b32 exec_hi, 0x3fffff
buffer_load_dwordx4 v17, s[12:15], s76 offen offset:1728 lds
s_mov_b32 exec_hi, -1
s_mov_b32 exec_hi, 0x3fffff
buffer_load_dwordx4 v18, s[12:15], s76 offen offset:2592 lds
s_mov_b32 exec_hi, -1
s_add_u32 m0, s61, 13824
s_add_u32 s76, s60, 110592
s_mov_b32 exec_hi, 0x3fffff
buffer_load_dwordx4 v10, s[12:15], s76 offen offset:0 lds
s_mov_b32 exec_hi, -1
s_mov_b32 exec_hi, 0x3fffff
buffer_load_dwordx4 v8, s[12:15], s76 offen offset:864 lds
s_mov_b32 exec_hi, -1
s_mov_b32 exec_hi, 0x3fffff
buffer_load_dwordx4 v17, s[12:15], s76 offen offset:1728 lds
s_mov_b32 exec_hi, -1
s_mov_b32 exec_hi, 0x3fffff
buffer_load_dwordx4 v18, s[12:15], s76 offen offset:2592 lds
s_mov_b32 exec_hi, -1
s_cmp_lt_u32 s2, 72
s_cbranch_scc1 L_pa
buffer_load_dwordx4 v[144:147], v242, s[28:31], s3 offen
s_add_u32 s3, s3, 221184
buffer_load_dwordx4 v[148:151], v242, s[28:31], s3 offen
s_add_u32 s3, s3, 221184
buffer_load_dwordx4 v[152:155], v242, s[28:31], s3 offen
s_add_u32 s3, s3, 221184
buffer_load_dwordx4 v[156:159], v242, s[28:31], s3 offen
s_add_u32 s3, s3, 221184
s_cmp_ge_u32 s48, 2
s_cselect_b32 s3, 0x7ff00000, s3
buffer_load_dwordx4 v[160:163], v242, s[28:31], s3 offen
s_add_u32 s3, s3, 221184
s_add_u32 m0, s61, 27648
s_add_u32 s76, s60, 442368
s_mov_b32 exec_hi, 0x3fffff
buffer_load_dwordx4 v10, s[12:15], s76 offen offset:0 lds
s_mov_b32 exec_hi, -1
s_mov_b32 exec_hi, 0x3fffff
buffer_load_dwordx4 v8, s[12:15], s76 offen offset:864 lds
s_mov_b32 exec_hi, -1
s_mov_b32 exec_hi, 0x3fffff
buffer_load_dwordx4 v17, s[12:15], s76 offen offset:1728 lds
s_mov_b32 exec_hi, -1
s_mov_b32 exec_hi, 0x3fffff
buffer_load_dwordx4 v18, s[12:15], s76 offen offset:2592 lds
s_mov_b32 exec_hi, -1
s_add_u32 m0, s61, 41472
s_add_u32 s76, s60, 552960
s_mov_b32 exec_hi, 0x3fffff
buffer_load_dwordx4 v10, s[12:15], s76 offen offset:0 lds
s_mov_b32 exec_hi, -1
s_mov_b32 exec_hi, 0x3fffff
buffer_load_dwordx4 v8, s[12:15], s76 offen offset:864 lds
s_mov_b32 exec_hi, -1
s_mov_b32 exec_hi, 0x3fffff
buffer_load_dwordx4 v17, s[12:15], s76 offen offset:1728 lds
s_mov_b32 exec_hi, -1
s_mov_b32 exec_hi, 0x3fffff
buffer_load_dwordx4 v18, s[12:15], s76 offen offset:2592 lds
s_mov_b32 exec_hi, -1
s_add_u32 m0, s61, 55296
s_add_u32 s76, s60, 884736
s_mov_b32 exec_hi, 0x3fffff
buffer_load_dwordx4 v10, s[12:15], s76 offen offset:0 lds
s_mov_b32 exec_hi, -1
s_mov_b32 exec_hi, 0x3fffff
buffer_load_dwordx4 v8, s[12:15], s76 offen offset:864 lds
s_mov_b32 exec_hi, -1
s_mov_b32 exec_hi, 0x3fffff
buffer_load_dwordx4 v17, s[12:15], s76 offen offset:1728 lds
s_mov_b32 exec_hi, -1
s_mov_b32 exec_hi, 0x3fffff
buffer_load_dwordx4 v18, s[12:15], s76 offen offset:2592 lds
s_mov_b32 exec_hi, -1
s_add_u32 m0, s61, 69120
s_add_u32 s76, s60, 995328
s_mov_b32 exec_hi, 0x3fffff
buffer_load_dwordx4 v10, s[12:15], s76 offen offset:0 lds
s_mov_b32 exec_hi, -1
s_mov_b32 exec_hi, 0x3fffff
buffer_load_dwordx4 v8, s[12:15], s76 offen offset:864 lds
s_mov_b32 exec_hi, -1
s_mov_b32 exec_hi, 0x3fffff
buffer_load_dwordx4 v17, s[12:15], s76 offen offset:1728 lds
s_mov_b32 exec_hi, -1
s_mov_b32 exec_hi, 0x3fffff
buffer_load_dwordx4 v18, s[12:15], s76 offen offset:2592 lds
s_mov_b32 exec_hi, -1
s_add_u32 m0, s61, 92160
s_add_u32 s76, s60, 1327104
s_mov_b32 exec_hi, 0x3fffff
buffer_load_dwordx4 v10, s[12:15], s76 offen offset:0 lds
s_mov_b32 exec_hi, -1
s_mov_b32 exec_hi, 0x3fffff
buffer_load_dwordx4 v8, s[12:15], s76 offen offset:864 lds
s_mov_b32 exec_hi, -1
s_mov_b32 exec_hi, 0x3fffff
buffer_load_dwordx4 v17, s[12:15], s76 offen offset:1728 lds
s_mov_b32 exec_hi, -1
s_mov_b32 exec_hi, 0x3fffff
buffer_load_dwordx4 v18, s[12:15], s76 offen offset:2592 lds
s_mov_b32 exec_hi, -1
s_add_u32 m0, s61, 105984
s_add_u32 s76, s60, 1437696
s_mov_b32 exec_hi, 0x3fffff
buffer_load_dwordx4 v10, s[12:15], s76 offen offset:0 lds
s_mov_b32 exec_hi, -1
s_mov_b32 exec_hi, 0x3fffff
buffer_load_dwordx4 v8, s[12:15], s76 offen offset:864 lds
s_mov_b32 exec_hi, -1
s_mov_b32 exec_hi, 0x3fffff
buffer_load_dwordx4 v17, s[12:15], s76 offen offset:1728 lds
s_mov_b32 exec_hi, -1
s_mov_b32 exec_hi, 0x3fffff
buffer_load_dwordx4 v18, s[12:15], s76 offen offset:2592 lds
s_mov_b32 exec_hi, -1
v_lshlrev_b32 v164, 16, v164
v_mul_f32 v170, 0xbfb8aa3b, v164
v_lshlrev_b32 v165, 16, v165
v_mul_f32 v171, 0xbfb8aa3b, v165
v_lshlrev_b32 v166, 16, v166
v_mul_f32 v172, 0xbfb8aa3b, v166
v_lshlrev_b32 v167, 16, v167
v_mul_f32 v173, 0xbfb8aa3b, v167
v_lshlrev_b32 v168, 16, v168
v_mul_f32 v174, 0xbfb8aa3b, v168
v_exp_f32 v170, v170
v_exp_f32 v171, v171
v_exp_f32 v172, v172
v_exp_f32 v173, v173
v_exp_f32 v174, v174
v_add_f32 v170, 1.0, v170
v_add_f32 v171, 1.0, v171
v_add_f32 v172, 1.0, v172
v_add_f32 v173, 1.0, v173
v_add_f32 v174, 1.0, v174
v_rcp_f32 v170, v170
v_rcp_f32 v171, v171
v_rcp_f32 v172, v172
v_rcp_f32 v173, v173
v_rcp_f32 v174, v174
v_mul_f32 v164, v164, v170
v_mul_f32 v165, v165, v171
v_mul_f32 v166, v166, v172
v_mul_f32 v167, v167, v173
v_mul_f32 v168, v168, v174
v_cvt_pk_bf16_f32 v164, v164, v164
v_cvt_pk_bf16_f32 v165, v165, v165
v_cvt_pk_bf16_f32 v166, v166, v166
v_cvt_pk_bf16_f32 v167, v167, v167
v_cvt_pk_bf16_f32 v168, v168, v168
v_and_b32 v170, 0xffff0000, v164
v_and_b32 v172, 0xffff0000, v165
v_and_b32 v174, 0xffff0000, v166
v_and_b32 v176, 0xffff0000, v167
v_and_b32 v178, 0xffff0000, v168
s_waitcnt vmcnt(28)
v_lshlrev_b32 v232, 16, v144
v_and_b32 v233, 0xffff0000, v144
v_lshlrev_b32 v234, 16, v145
v_and_b32 v235, 0xffff0000, v145
v_lshlrev_b32 v236, 16, v146
v_and_b32 v237, 0xffff0000, v146
v_lshlrev_b32 v238, 16, v147
v_and_b32 v239, 0xffff0000, v147
v_pk_mul_f32 v[224:225], v[232:233], v[170:171] op_sel_hi:[1,0]
v_pk_mul_f32 v[226:227], v[234:235], v[170:171] op_sel_hi:[1,0]
v_pk_mul_f32 v[228:229], v[236:237], v[170:171] op_sel_hi:[1,0]
v_pk_mul_f32 v[230:231], v[238:239], v[170:171] op_sel_hi:[1,0]
s_waitcnt vmcnt(27)
v_lshlrev_b32 v232, 16, v148
v_and_b32 v233, 0xffff0000, v148
v_lshlrev_b32 v234, 16, v149
v_and_b32 v235, 0xffff0000, v149
v_lshlrev_b32 v236, 16, v150
v_and_b32 v237, 0xffff0000, v150
v_lshlrev_b32 v238, 16, v151
v_and_b32 v239, 0xffff0000, v151
v_pk_fma_f32 v[224:225], v[232:233], v[172:173], v[224:225] op_sel_hi:[1,0,1]
v_pk_fma_f32 v[226:227], v[234:235], v[172:173], v[226:227] op_sel_hi:[1,0,1]
v_pk_fma_f32 v[228:229], v[236:237], v[172:173], v[228:229] op_sel_hi:[1,0,1]
v_pk_fma_f32 v[230:231], v[238:239], v[172:173], v[230:231] op_sel_hi:[1,0,1]
s_waitcnt vmcnt(26)
v_lshlrev_b32 v232, 16, v152
v_and_b32 v233, 0xffff0000, v152
v_lshlrev_b32 v234, 16, v153
v_and_b32 v235, 0xffff0000, v153
v_lshlrev_b32 v236, 16, v154
v_and_b32 v237, 0xffff0000, v154
v_lshlrev_b32 v238, 16, v155
v_and_b32 v239, 0xffff0000, v155
v_pk_fma_f32 v[224:225], v[232:233], v[174:175], v[224:225] op_sel_hi:[1,0,1]
v_pk_fma_f32 v[226:227], v[234:235], v[174:175], v[226:227] op_sel_hi:[1,0,1]
v_pk_fma_f32 v[228:229], v[236:237], v[174:175], v[228:229] op_sel_hi:[1,0,1]
v_pk_fma_f32 v[230:231], v[238:239], v[174:175], v[230:231] op_sel_hi:[1,0,1]
s_waitcnt vmcnt(25)
v_lshlrev_b32 v232, 16, v156
v_and_b32 v233, 0xffff0000, v156
v_lshlrev_b32 v234, 16, v157
v_and_b32 v235, 0xffff0000, v157
v_lshlrev_b32 v236, 16, v158
v_and_b32 v237, 0xffff0000, v158
v_lshlrev_b32 v238, 16, v159
v_and_b32 v239, 0xffff0000, v159
v_pk_fma_f32 v[224:225], v[232:233], v[176:177], v[224:225] op_sel_hi:[1,0,1]
v_pk_fma_f32 v[226:227], v[234:235], v[176:177], v[226:227] op_sel_hi:[1,0,1]
v_pk_fma_f32 v[228:229], v[236:237], v[176:177], v[228:229] op_sel_hi:[1,0,1]
v_pk_fma_f32 v[230:231], v[238:239], v[176:177], v[230:231] op_sel_hi:[1,0,1]
s_waitcnt vmcnt(24)
v_lshlrev_b32 v232, 16, v160
v_and_b32 v233, 0xffff0000, v160
v_lshlrev_b32 v234, 16, v161
v_and_b32 v235, 0xffff0000, v161
v_lshlrev_b32 v236, 16, v162
v_and_b32 v237, 0xffff0000, v162
v_lshlrev_b32 v238, 16, v163
v_and_b32 v239, 0xffff0000, v163
v_pk_fma_f32 v[224:225], v[232:233], v[178:179], v[224:225] op_sel_hi:[1,0,1]
v_pk_fma_f32 v[226:227], v[234:235], v[178:179], v[226:227] op_sel_hi:[1,0,1]
v_pk_fma_f32 v[228:229], v[236:237], v[178:179], v[228:229] op_sel_hi:[1,0,1]
v_pk_fma_f32 v[230:231], v[238:239], v[178:179], v[230:231] op_sel_hi:[1,0,1]
v_add_f32_dpp v224, v224, v224 row_ror:8 row_mask:0xf bank_mask:0xf
v_add_f32_dpp v225, v225, v225 row_ror:8 row_mask:0xf bank_mask:0xf
v_add_f32_dpp v226, v226, v226 row_ror:8 row_mask:0xf bank_mask:0xf
v_add_f32_dpp v227, v227, v227 row_ror:8 row_mask:0xf bank_mask:0xf
v_add_f32_dpp v228, v228, v228 row_ror:8 row_mask:0xf bank_mask:0xf
v_add_f32_dpp v229, v229, v229 row_ror:8 row_mask:0xf bank_mask:0xf
v_add_f32_dpp v230, v230, v230 row_ror:8 row_mask:0xf bank_mask:0xf
v_add_f32_dpp v231, v231, v231 row_ror:8 row_mask:0xf bank_mask:0xf
v_lshrrev_b32 v240, 4, v0
v_and_b32 v241, 7, v0
v_lshlrev_b32 v240, 8, v240
v_lshl_add_u32 v240, v241, 5, v240
v_add_u32 v240, 82944, v240
s_mov_b32 exec_lo, 0xff00ff
s_mov_b32 exec_hi, 0xff00ff
ds_write_b128 v240, v[224:227]
ds_write_b128 v240, v[228:231] offset:16
s_mov_b64 exec, -1
s_waitcnt lgkmcnt(0)
s_barrier
s_cmp_lg_u32 s48, 3
s_cbranch_scc1 L_nomodB
s_cmp_ge_u32 s2, 216
s_cbranch_scc1 L_nomodB
v_lshlrev_b32 v240, 2, v1
v_add_u32 v241, 82944, v240
ds_read2st64_b32 v[224:225], v241 offset0:0 offset1:1
ds_read2st64_b32 v[226:227], v241 offset0:2 offset1:3
ds_read2st64_b32 v[228:229], v241 offset0:4 offset1:5
ds_read2st64_b32 v[230:231], v241 offset0:6 offset1:7
ds_read2st64_b32 v[232:233], v241 offset0:8 offset1:9
ds_read2st64_b32 v[234:235], v241 offset0:10 offset1:11
ds_read2st64_b32 v[236:237], v241 offset0:12 offset1:13
ds_read2st64_b32 v[238:239], v241 offset0:14 offset1:15
s_and_b32 s53, s2, 3
s_mul_i32 s53, s53, 13824
s_lshr_b32 s54, s2, 2
s_lshl_b32 s54, s54, 8
s_add_u32 s53, s53, s54
s_add_u32 s53, s53, 4096
s_waitcnt lgkmcnt(0)
v_pk_add_f32 v[224:225], v[224:225], v[232:233]
v_pk_add_f32 v[226:227], v[226:227], v[234:235]
v_pk_add_f32 v[228:229], v[228:229], v[236:237]
v_pk_add_f32 v[230:231], v[230:231], v[238:239]
v_pk_add_f32 v[224:225], v[224:225], v[228:229]
v_pk_add_f32 v[226:227], v[226:227], v[230:231]
v_pk_add_f32 v[224:225], v[224:225], v[226:227]
v_add_f32 v224, v224, v225
buffer_store_dword v224, v240, s[44:47], s53 offen sc1
L_nomodB:
s_branch L_pj
L_pa:
s_add_u32 m0, s61, 27648
s_add_u32 s76, s60, 442368
s_mov_b32 exec_hi, 0x3fffff
buffer_load_dwordx4 v10, s[12:15], s76 offen offset:0 lds
s_mov_b32 exec_hi, -1
s_mov_b32 exec_hi, 0x3fffff
buffer_load_dwordx4 v8, s[12:15], s76 offen offset:864 lds
s_mov_b32 exec_hi, -1
s_mov_b32 exec_hi, 0x3fffff
buffer_load_dwordx4 v17, s[12:15], s76 offen offset:1728 lds
s_mov_b32 exec_hi, -1
s_mov_b32 exec_hi, 0x3fffff
buffer_load_dwordx4 v18, s[12:15], s76 offen offset:2592 lds
s_mov_b32 exec_hi, -1
s_add_u32 m0, s61, 41472
s_add_u32 s76, s60, 552960
s_mov_b32 exec_hi, 0x3fffff
buffer_load_dwordx4 v10, s[12:15], s76 offen offset:0 lds
s_mov_b32 exec_hi, -1
s_mov_b32 exec_hi, 0x3fffff
buffer_load_dwordx4 v8, s[12:15], s76 offen offset:864 lds
s_mov_b32 exec_hi, -1
s_mov_b32 exec_hi, 0x3fffff
buffer_load_dwordx4 v17, s[12:15], s76 offen offset:1728 lds
s_mov_b32 exec_hi, -1
s_mov_b32 exec_hi, 0x3fffff
buffer_load_dwordx4 v18, s[12:15], s76 offen offset:2592 lds
s_mov_b32 exec_hi, -1
s_add_u32 m0, s61, 55296
s_add_u32 s76, s60, 884736
s_mov_b32 exec_hi, 0x3fffff
buffer_load_dwordx4 v10, s[12:15], s76 offen offset:0 lds
s_mov_b32 exec_hi, -1
s_mov_b32 exec_hi, 0x3fffff
buffer_load_dwordx4 v8, s[12:15], s76 offen offset:864 lds
s_mov_b32 exec_hi, -1
s_mov_b32 exec_hi, 0x3fffff
buffer_load_dwordx4 v17, s[12:15], s76 offen offset:1728 lds
s_mov_b32 exec_hi, -1
s_mov_b32 exec_hi, 0x3fffff
buffer_load_dwordx4 v18, s[12:15], s76 offen offset:2592 lds
s_mov_b32 exec_hi, -1
s_add_u32 m0, s61, 69120
s_add_u32 s76, s60, 995328
s_mov_b32 exec_hi, 0x3fffff
buffer_load_dwordx4 v10, s[12:15], s76 offen offset:0 lds
s_mov_b32 exec_hi, -1
s_mov_b32 exec_hi, 0x3fffff
buffer_load_dwordx4 v8, s[12:15], s76 offen offset:864 lds
s_mov_b32 exec_hi, -1
s_mov_b32 exec_hi, 0x3fffff
buffer_load_dwordx4 v17, s[12:15], s76 offen offset:1728 lds
s_mov_b32 exec_hi, -1
s_mov_b32 exec_hi, 0x3fffff
buffer_load_dwordx4 v18, s[12:15], s76 offen offset:2592 lds
s_mov_b32 exec_hi, -1
s_add_u32 m0, s61, 92160
s_add_u32 s76, s60, 1327104
s_mov_b32 exec_hi, 0x3fffff
buffer_load_dwordx4 v10, s[12:15], s76 offen offset:0 lds
s_mov_b32 exec_hi, -1
s_mov_b32 exec_hi, 0x3fffff
buffer_load_dwordx4 v8, s[12:15], s76 offen offset:864 lds
s_mov_b32 exec_hi, -1
s_mov_b32 exec_hi, 0x3fffff
buffer_load_dwordx4 v17, s[12:15], s76 offen offset:1728 lds
s_mov_b32 exec_hi, -1
s_mov_b32 exec_hi, 0x3fffff
buffer_load_dwordx4 v18, s[12:15], s76 offen offset:2592 lds
s_mov_b32 exec_hi, -1
s_add_u32 m0, s61, 105984
s_add_u32 s76, s60, 1437696
s_mov_b32 exec_hi, 0x3fffff
buffer_load_dwordx4 v10, s[12:15], s76 offen offset:0 lds
s_mov_b32 exec_hi, -1
s_mov_b32 exec_hi, 0x3fffff
buffer_load_dwordx4 v8, s[12:15], s76 offen offset:864 lds
s_mov_b32 exec_hi, -1
s_mov_b32 exec_hi, 0x3fffff
buffer_load_dwordx4 v17, s[12:15], s76 offen offset:1728 lds
s_mov_b32 exec_hi, -1
s_mov_b32 exec_hi, 0x3fffff
buffer_load_dwordx4 v18, s[12:15], s76 offen offset:2592 lds
s_mov_b32 exec_hi, -1
L_pj:
s_mov_b32 exec_hi, 0
buffer_load_dword v20, v19, s[44:47], s5 offen sc1
s_mov_b32 exec_hi, -1
s_waitcnt lgkmcnt(0)
s_barrier
ds_read_b128 v[56:59], v4 offset:0
ds_read_b128 v[60:63], v4 offset:16
s_waitcnt lgkmcnt(0)
v_pk_add_f32 v[56:57], v[56:57], v[58:59]
v_pk_add_f32 v[60:61], v[60:61], v[62:63]
v_pk_add_f32 v[56:57], v[56:57], v[60:61]
v_mul_f32 v56, 0x3ae38e39, v56
v_mul_f32 v57, 0x3ae38e39, v57
v_fma_f32 v57, -v56, v56, v57
v_max_f32 v57, 0, v57
v_add_f32 v57, 0x3727c5ac, v57
v_rsq_f32 v58, v57
s_nop 0
v_mul_f32 v59, -v56, v58
v_pk_fma_f32 v[32:33], v[32:33], v[58:59], v[58:59] op_sel:[0,0,1] op_sel_hi:[1,0,1]
v_pk_fma_f32 v[34:35], v[34:35], v[58:59], v[58:59] op_sel:[0,0,1] op_sel_hi:[1,0,1]
v_pk_fma_f32 v[36:37], v[36:37], v[58:59], v[58:59] op_sel:[0,0,1] op_sel_hi:[1,0,1]
v_pk_fma_f32 v[38:39], v[38:39], v[58:59], v[58:59] op_sel:[0,0,1] op_sel_hi:[1,0,1]
v_pk_fma_f32 v[40:41], v[40:41], v[58:59], v[58:59] op_sel:[0,0,1] op_sel_hi:[1,0,1]
v_pk_fma_f32 v[42:43], v[42:43], v[58:59], v[58:59] op_sel:[0,0,1] op_sel_hi:[1,0,1]
v_pk_fma_f32 v[44:45], v[44:45], v[58:59], v[58:59] op_sel:[0,0,1] op_sel_hi:[1,0,1]
v_pk_fma_f32 v[46:47], v[46:47], v[58:59], v[58:59] op_sel:[0,0,1] op_sel_hi:[1,0,1]
v_pk_fma_f32 v[48:49], v[48:49], v[58:59], v[58:59] op_sel:[0,0,1] op_sel_hi:[1,0,1]
v_pk_fma_f32 v[50:51], v[50:51], v[58:59], v[58:59] op_sel:[0,0,1] op_sel_hi:[1,0,1]
v_pk_fma_f32 v[52:53], v[52:53], v[58:59], v[58:59] op_sel:[0,0,1] op_sel_hi:[1,0,1]
v_pk_fma_f32 v[54:55], v[54:55], v[58:59], v[58:59] op_sel:[0,0,1] op_sel_hi:[1,0,1]
s_cmp_lt_u32 s2, 72
s_cbranch_scc1 L_oBs
s_cmp_lg_u32 s48, 3
s_cbranch_scc1 L_nosigB
s_lshl_b32 s53, s2, 7
s_add_u32 s53, s53, 163840
v_lshlrev_b32 v247, 2, v1
s_waitcnt vmcnt(1)
s_mov_b32 exec_lo, 0xffffffff
s_mov_b32 exec_hi, 0x0
buffer_store_dword v21, v247, s[44:47], s53 offen sc1
s_mov_b64 exec, -1
L_nosigB:
L_oBs:
s_mov_b32 exec_lo, 0xffffffff
s_mov_b32 exec_hi, 0x0
s_waitcnt vmcnt(0)
v_cmp_ne_u32 vcc, v21, v20
s_nop 4
s_cbranch_vccz L_poll1d
s_mov_b32 s77, 0x20000
L_poll1:
buffer_load_dword v20, v19, s[44:47], s5 offen sc1
s_waitcnt vmcnt(0)
v_cmp_ne_u32 vcc, v21, v20
s_nop 4
s_cbranch_vccz L_poll1d
s_sub_u32 s77, s77, 1
s_cmp_lg_u32 s77, 0
s_cbranch_scc1 L_poll1
L_poll1d:
s_mov_b64 exec, -1
s_mov_b32 s53, 4096
buffer_load_dwordx4 v[64:67], v30, s[44:47], s53 offen sc1
s_mov_b32 s53, 17920
buffer_load_dwordx4 v[68:71], v30, s[44:47], s53 offen sc1
s_mov_b32 s53, 31744
buffer_load_dwordx4 v[72:75], v30, s[44:47], s53 offen sc1
s_mov_b32 s53, 45568
buffer_load_dwordx4 v[76:79], v30, s[44:47], s53 offen sc1
s_mov_b32 exec_lo, 0xffff
s_mov_b32 exec_hi, 0x0
s_mov_b32 s53, 4096
buffer_load_dwordx4 v[80:83], v31, s[44:47], s53 offen sc1
s_mov_b32 s53, 17920
buffer_load_dwordx4 v[84:87], v31, s[44:47], s53 offen sc1
s_mov_b32 s53, 31744
buffer_load_dwordx4 v[88:91], v31, s[44:47], s53 offen sc1
s_mov_b32 s53, 45568
buffer_load_dwordx4 v[92:95], v31, s[44:47], s53 offen sc1
s_mov_b64 exec, -1
s_barrier
ds_read_b64_tr_b16 a[0:1], v11 offset:0
s_add_u32 m0, s61, 119808
s_add_u32 s76, s60, 221184
s_mov_b32 exec_hi, 0x3fffff
buffer_load_dwordx4 v10, s[12:15], s76 offen offset:0 lds
s_mov_b32 exec_hi, -1
ds_read_b64_tr_b16 a[2:3], v11 offset:6912
ds_read_b64_tr_b16 a[4:5], v11 offset:144
ds_read_b64_tr_b16 a[6:7], v11 offset:7056
ds_read_b64_tr_b16 a[8:9], v11 offset:288
ds_read_b64_tr_b16 a[10:11], v11 offset:7200
ds_read_b64_tr_b16 a[12:13], v12 offset:0
s_mov_b32 exec_hi, 0x3fffff
buffer_load_dwordx4 v8, s[12:15], s76 offen offset:864 lds
s_mov_b32 exec_hi, -1
ds_read_b64_tr_b16 a[14:15], v12 offset:6912
ds_read_b64_tr_b16 a[16:17], v11 offset:13824
ds_read_b64_tr_b16 a[18:19], v11 offset:20736
ds_read_b64_tr_b16 a[20:21], v11 offset:13968
ds_read_b64_tr_b16 a[22:23], v11 offset:20880
ds_read_b64_tr_b16 a[24:25], v11 offset:14112
s_mov_b32 exec_hi, 0x3fffff
buffer_load_dwordx4 v17, s[12:15], s76 offen offset:1728 lds
s_mov_b32 exec_hi, -1
ds_read_b64_tr_b16 a[26:27], v11 offset:21024
ds_read_b64_tr_b16 a[28:29], v12 offset:13824
ds_read_b64_tr_b16 a[30:31], v12 offset:20736
ds_read_b64_tr_b16 a[32:33], v11 offset:27648
ds_read_b64_tr_b16 a[34:35], v11 offset:34560
ds_read_b64_tr_b16 a[36:37], v11 offset:27792
s_mov_b32 exec_hi, 0x3fffff
buffer_load_dwordx4 v18, s[12:15], s76 offen offset:2592 lds
s_mov_b32 exec_hi, -1
ds_read_b64_tr_b16 a[38:39], v11 offset:34704
ds_read_b64_tr_b16 a[40:41], v11 offset:27936
ds_read_b64_tr_b16 a[42:43], v11 offset:34848
ds_read_b64_tr_b16 a[44:45], v12 offset:27648
ds_read_b64_tr_b16 a[46:47], v12 offset:34560
ds_read_b64_tr_b16 a[48:49], v13 offset:0
s_add_u32 m0, s61, 133632
s_add_u32 s76, s60, 331776
s_mov_b32 exec_hi, 0x3fffff
buffer_load_dwordx4 v10, s[12:15], s76 offen offset:0 lds
s_mov_b32 exec_hi, -1
ds_read_b64_tr_b16 a[50:51], v13 offset:6912
ds_read_b64_tr_b16 a[52:53], v13 offset:144
ds_read_b64_tr_b16 a[54:55], v13 offset:7056
ds_read_b64_tr_b16 a[56:57], v13 offset:288
ds_read_b64_tr_b16 a[58:59], v13 offset:7200
ds_read_b64_tr_b16 a[60:61], v14 offset:0
s_mov_b32 exec_hi, 0x3fffff
buffer_load_dwordx4 v8, s[12:15], s76 offen offset:864 lds
s_mov_b32 exec_hi, -1
ds_read_b64_tr_b16 a[62:63], v14 offset:6912
ds_read_b64_tr_b16 a[64:65], v13 offset:13824
ds_read_b64_tr_b16 a[66:67], v13 offset:20736
ds_read_b64_tr_b16 a[68:69], v13 offset:13968
ds_read_b64_tr_b16 a[70:71], v13 offset:20880
ds_read_b64_tr_b16 a[72:73], v13 offset:14112
s_mov_b32 exec_hi, 0x3fffff
buffer_load_dwordx4 v17, s[12:15], s76 offen offset:1728 lds
s_mov_b32 exec_hi, -1
ds_read_b64_tr_b16 a[74:75], v13 offset:21024
ds_read_b64_tr_b16 a[76:77], v14 offset:13824
ds_read_b64_tr_b16 a[78:79], v14 offset:20736
ds_read_b64_tr_b16 a[80:81], v13 offset:27648
ds_read_b64_tr_b16 a[82:83], v13 offset:34560
ds_read_b64_tr_b16 a[84:85], v13 offset:27792
s_mov_b32 exec_hi, 0x3fffff
buffer_load_dwordx4 v18, s[12:15], s76 offen offset:2592 lds
s_mov_b32 exec_hi, -1
ds_read_b64_tr_b16 a[86:87], v13 offset:34704
ds_read_b64_tr_b16 a[88:89], v13 offset:27936
ds_read_b64_tr_b16 a[90:91], v13 offset:34848
ds_read_b64_tr_b16 a[92:93], v14 offset:27648
ds_read_b64_tr_b16 a[94:95], v14 offset:34560
s_waitcnt vmcnt(8)
v_pk_add_f32 v[64:65], v[64:65], v[68:69]
v_pk_add_f32 v[66:67], v[66:67], v[70:71]
v_pk_add_f32 v[72:73], v[72:73], v[76:77]
v_pk_add_f32 v[74:75], v[74:75], v[78:79]
v_pk_add_f32 v[64:65], v[64:65], v[72:73]
v_pk_add_f32 v[66:67], v[66:67], v[74:75]
v_cvt_pk_bf16_f32 v68, v64, v65
v_cvt_pk_bf16_f32 v69, v66, v67
v_lshlrev_b32 v64, 16, v68
v_and_b32 v65, 0xffff0000, v68
v_lshlrev_b32 v66, 16, v69
v_and_b32 v67, 0xffff0000, v69
v_add_f32 v64, v28, v64
v_add_f32 v65, v28, v65
v_add_f32 v66, v28, v66
v_add_f32 v67, v28, v67
v_cvt_pk_bf16_f32 v68, v64, v65
v_cvt_pk_bf16_f32 v69, v66, v67
v_lshlrev_b32 v64, 16, v68
v_and_b32 v65, 0xffff0000, v68
v_lshlrev_b32 v66, 16, v69
v_and_b32 v67, 0xffff0000, v69
ds_write_b128 v2, v[64:67]
v_pk_add_f32 v[80:81], v[80:81], v[84:85]
v_pk_add_f32 v[82:83], v[82:83], v[86:87]
v_pk_add_f32 v[88:89], v[88:89], v[92:93]
v_pk_add_f32 v[90:91], v[90:91], v[94:95]
v_pk_add_f32 v[80:81], v[80:81], v[88:89]
v_pk_add_f32 v[82:83], v[82:83], v[90:91]
v_cvt_pk_bf16_f32 v84, v80, v81
v_cvt_pk_bf16_f32 v85, v82, v83
v_lshlrev_b32 v80, 16, v84
v_and_b32 v81, 0xffff0000, v84
v_lshlrev_b32 v82, 16, v85
v_and_b32 v83, 0xffff0000, v85
v_add_f32 v80, v29, v80
v_add_f32 v81, v29, v81
v_add_f32 v82, v29, v82
v_add_f32 v83, v29, v83
v_cvt_pk_bf16_f32 v84, v80, v81
v_cvt_pk_bf16_f32 v85, v82, v83
v_lshlrev_b32 v80, 16, v84
v_and_b32 v81, 0xffff0000, v84
v_lshlrev_b32 v82, 16, v85
v_and_b32 v83, 0xffff0000, v85
s_mov_b32 exec_lo, 0xffff
s_mov_b32 exec_hi, 0x0
ds_write_b128 v5, v[80:83]
s_mov_b64 exec, -1
ds_read_b128 v[96:99], v24 offset:2304
ds_read_b128 v[100:103], v24 offset:2320
ds_read_b128 v[104:107], v24 offset:0
ds_read_b128 v[108:111], v24 offset:16
ds_read_b128 v[112:115], v24 offset:2560
ds_read_b128 v[116:119], v24 offset:2576
ds_read_b128 v[120:123], v24 offset:256
ds_read_b128 v[124:127], v24 offset:272
ds_read_b128 v[128:131], v25 offset:2304
ds_read_b128 v[132:135], v25 offset:2320
ds_read_b128 v[136:139], v25 offset:0
ds_read_b128 v[140:143], v25 offset:16
s_waitcnt lgkmcnt(8)
v_pk_fma_f32 v[32:33], v[32:33], v[96:97], v[104:105]
v_pk_fma_f32 v[34:35], v[34:35], v[98:99], v[106:107]
v_pk_fma_f32 v[36:37], v[36:37], v[100:101], v[108:109]
v_pk_fma_f32 v[38:39], v[38:39], v[102:103], v[110:111]
v_cvt_pk_bf16_f32 v32, v32, v33
v_cvt_pk_bf16_f32 v33, v34, v35
v_cvt_pk_bf16_f32 v34, v36, v37
v_cvt_pk_bf16_f32 v35, v38, v39
buffer_store_dwordx4 v[32:35], v22, s[44:47], s66 offen offset:0 sc1
s_waitcnt lgkmcnt(4)
v_pk_fma_f32 v[40:41], v[40:41], v[112:113], v[120:121]
v_pk_fma_f32 v[42:43], v[42:43], v[114:115], v[122:123]
v_pk_fma_f32 v[44:45], v[44:45], v[116:117], v[124:125]
v_pk_fma_f32 v[46:47], v[46:47], v[118:119], v[126:127]
v_cvt_pk_bf16_f32 v40, v40, v41
v_cvt_pk_bf16_f32 v41, v42, v43
v_cvt_pk_bf16_f32 v42, v44, v45
v_cvt_pk_bf16_f32 v43, v46, v47
buffer_store_dwordx4 v[40:43], v22, s[44:47], s66 offen offset:2048 sc1
s_waitcnt lgkmcnt(0)
v_pk_fma_f32 v[48:49], v[48:49], v[128:129], v[136:137]
v_pk_fma_f32 v[50:51], v[50:51], v[130:131], v[138:139]
v_pk_fma_f32 v[52:53], v[52:53], v[132:133], v[140:141]
v_pk_fma_f32 v[54:55], v[54:55], v[134:135], v[142:143]
v_cvt_pk_bf16_f32 v48, v48, v49
v_cvt_pk_bf16_f32 v49, v50, v51
v_cvt_pk_bf16_f32 v50, v52, v53
v_cvt_pk_bf16_f32 v51, v54, v55
buffer_store_dwordx4 v[48:51], v23, s[44:47], s66 offen offset:0 sc1
s_waitcnt vmcnt(3)
s_barrier
ds_read_b64_tr_b16 a[96:97], v196 offset:0
ds_read_b64_tr_b16 a[98:99], v196 offset:6912
ds_read_b64_tr_b16 a[100:101], v196 offset:144
ds_read_b64_tr_b16 a[102:103], v196 offset:7056
ds_read_b64_tr_b16 a[104:105], v196 offset:288
ds_read_b64_tr_b16 a[106:107], v196 offset:7200
ds_read_b64_tr_b16 a[108:109], v197 offset:0
ds_read_b64_tr_b16 a[110:111], v197 offset:6912
ds_read_b64_tr_b16 a[112:113], v196 offset:13824
ds_read_b64_tr_b16 a[114:115], v196 offset:20736
ds_read_b64_tr_b16 a[116:117], v196 offset:13968
ds_read_b64_tr_b16 a[118:119], v196 offset:20880
ds_read_b64_tr_b16 a[120:121], v196 offset:14112
ds_read_b64_tr_b16 a[122:123], v196 offset:21024
ds_read_b64_tr_b16 a[124:125], v197 offset:13824
ds_read_b64_tr_b16 a[126:127], v197 offset:20736
ds_read_b64_tr_b16 a[128:129], v196 offset:27648
ds_read_b64_tr_b16 a[130:131], v196 offset:34560
ds_read_b64_tr_b16 a[132:133], v196 offset:27792
ds_read_b64_tr_b16 a[134:135], v196 offset:34704
ds_read_b64_tr_b16 a[136:137], v196 offset:27936
ds_read_b64_tr_b16 a[138:139], v196 offset:34848
ds_read_b64_tr_b16 a[140:141], v197 offset:27648
ds_read_b64_tr_b16 a[142:143], v197 offset:34560
ds_read_b64_tr_b16 a[144:145], v196 offset:41472
ds_read_b64_tr_b16 a[146:147], v196 offset:48384
ds_read_b64_tr_b16 a[148:149], v196 offset:41616
ds_read_b64_tr_b16 a[150:151], v196 offset:48528
ds_read_b64_tr_b16 a[152:153], v196 offset:41760
ds_read_b64_tr_b16 a[154:155], v196 offset:48672
ds_read_b64_tr_b16 a[156:157], v197 offset:41472
ds_read_b64_tr_b16 a[158:159], v197 offset:48384
s_waitcnt vmcnt(0)
s_mul_i32 s53, s49, 24
s_add_u32 s53, s53, s48
s_lshl_b32 s53, s53, 3
s_add_u32 s53, s53, s50
s_lshl_b32 s53, s53, 7
s_add_u32 s53, s53, 217088
s_mov_b64 exec, 1
buffer_store_dword v21, v9, s[44:47], s53 offen sc1
s_mov_b64 exec, -1
s_waitcnt lgkmcnt(0)
s_barrier
s_add_u32 m0, s61, 92160
s_add_u32 s76, s60, 663552
s_mov_b32 exec_hi, 0x3fffff
buffer_load_dwordx4 v10, s[12:15], s76 offen offset:0 lds
s_mov_b32 exec_hi, -1
s_mov_b32 exec_hi, 0x3fffff
buffer_load_dwordx4 v8, s[12:15], s76 offen offset:864 lds
s_mov_b32 exec_hi, -1
s_mov_b32 exec_hi, 0x3fffff
buffer_load_dwordx4 v17, s[12:15], s76 offen offset:1728 lds
s_mov_b32 exec_hi, -1
s_mov_b32 exec_hi, 0x3fffff
buffer_load_dwordx4 v18, s[12:15], s76 offen offset:2592 lds
s_mov_b32 exec_hi, -1
s_add_u32 m0, s61, 105984
s_add_u32 s76, s60, 774144
s_mov_b32 exec_hi, 0x3fffff
buffer_load_dwordx4 v10, s[12:15], s76 offen offset:0 lds
s_mov_b32 exec_hi, -1
s_mov_b32 exec_hi, 0x3fffff
buffer_load_dwordx4 v8, s[12:15], s76 offen offset:864 lds
s_mov_b32 exec_hi, -1
s_mov_b32 exec_hi, 0x3fffff
buffer_load_dwordx4 v17, s[12:15], s76 offen offset:1728 lds
s_mov_b32 exec_hi, -1
s_mov_b32 exec_hi, 0x3fffff
buffer_load_dwordx4 v18, s[12:15], s76 offen offset:2592 lds
s_mov_b32 exec_hi, -1
s_add_u32 m0, s61, 119808
s_add_u32 s76, s60, 1105920
s_mov_b32 exec_hi, 0x3fffff
buffer_load_dwordx4 v10, s[12:15], s76 offen offset:0 lds
s_mov_b32 exec_hi, -1
s_mov_b32 exec_hi, 0x3fffff
buffer_load_dwordx4 v8, s[12:15], s76 offen offset:864 lds
s_mov_b32 exec_hi, -1
s_mov_b32 exec_hi, 0x3fffff
buffer_load_dwordx4 v17, s[12:15], s76 offen offset:1728 lds
s_mov_b32 exec_hi, -1
s_mov_b32 exec_hi, 0x3fffff
buffer_load_dwordx4 v18, s[12:15], s76 offen offset:2592 lds
s_mov_b32 exec_hi, -1
s_add_u32 m0, s61, 133632
s_add_u32 s76, s60, 1216512
s_mov_b32 exec_hi, 0x3fffff
buffer_load_dwordx4 v10, s[12:15], s76 offen offset:0 lds
s_mov_b32 exec_hi, -1
s_mov_b32 exec_hi, 0x3fffff
buffer_load_dwordx4 v8, s[12:15], s76 offen offset:864 lds
s_mov_b32 exec_hi, -1
s_mov_b32 exec_hi, 0x3fffff
buffer_load_dwordx4 v17, s[12:15], s76 offen offset:1728 lds
s_mov_b32 exec_hi, -1
s_mov_b32 exec_hi, 0x3fffff
buffer_load_dwordx4 v18, s[12:15], s76 offen offset:2592 lds
s_mov_b32 exec_hi, -1
s_cmp_lg_u32 s2, 255
s_cbranch_scc1 L_noall
v_lshlrev_b32 v203, 7, v0
s_mov_b32 s77, 0x20000
L_poll2:
buffer_load_dword v204, v203, s[44:47], s5 offen sc1
s_waitcnt vmcnt(0)
v_cmp_ne_u32 vcc, v21, v204
s_nop 4
s_cbranch_vccz L_poll2d
s_sub_u32 s77, s77, 1
s_cmp_lg_u32 s77, 0
s_cbranch_scc1 L_poll2
L_poll2d:
L_noall:
s_mov_b32 exec_lo, 0x3ff
s_mov_b32 exec_hi, 0x0
s_mov_b32 s77, 0x20000
L_poll3:
buffer_load_dword v20, v26, s[44:47], s73 offen sc1
s_waitcnt vmcnt(0)
v_cmp_ne_u32 vcc, v21, v20
s_nop 4
s_cbranch_vccz L_poll3d
s_sub_u32 s77, s77, 1
s_cmp_lg_u32 s77, 0
s_cbranch_scc1 L_poll3
L_poll3d:
s_mov_b64 exec, -1
s_add_u32 m0, s71, 0
s_add_u32 s76, s67, 0
buffer_load_dwordx4 v9, s[44:47], s76 offen offset:0 sc1 lds
buffer_load_dwordx4 v9, s[44:47], s76 offen offset:1024 sc1 lds
s_add_u32 m0, s71, 18432
s_add_u32 s76, s68, 0
buffer_load_dwordx4 v9, s[44:47], s76 offen offset:0 sc1 lds
buffer_load_dwordx4 v9, s[44:47], s76 offen offset:1024 sc1 lds
s_add_u32 m0, s71, 36864
s_add_u32 s76, s68, 18432
buffer_load_dwordx4 v9, s[44:47], s76 offen offset:0 sc1 lds
buffer_load_dwordx4 v9, s[44:47], s76 offen offset:1024 sc1 lds
s_add_u32 m0, s71, 55296
s_add_u32 s76, s68, 36864
buffer_load_dwordx4 v9, s[44:47], s76 offen offset:0 sc1 lds
buffer_load_dwordx4 v9, s[44:47], s76 offen offset:1024 sc1 lds
s_add_u32 m0, s71, 73728
s_add_u32 s76, s68, 55296
buffer_load_dwordx4 v9, s[44:47], s76 offen offset:0 sc1 lds
buffer_load_dwordx4 v9, s[44:47], s76 offen offset:1024 sc1 lds
s_lshl_b32 s74, s48, 2
s_lshr_b32 s74, 43399, s74
s_and_b32 s74, s74, 15
s_mul_i32 s74, s74, 221184
s_add_u32 s74, s74, s75
buffer_load_dword v252, v27, s[12:15], s74 offen
s_barrier
ds_read_b64_tr_b16 a[160:161], v196 offset:0
ds_read_b64_tr_b16 a[162:163], v196 offset:6912
ds_read_b64_tr_b16 a[164:165], v196 offset:144
ds_read_b64_tr_b16 a[166:167], v196 offset:7056
ds_read_b64_tr_b16 a[168:169], v196 offset:288
ds_read_b64_tr_b16 a[170:171], v196 offset:7200
ds_read_b64_tr_b16 a[172:173], v197 offset:0
ds_read_b64_tr_b16 a[174:175], v197 offset:6912
ds_read_b64_tr_b16 a[176:177], v196 offset:13824
ds_read_b64_tr_b16 a[178:179], v196 offset:20736
ds_read_b64_tr_b16 a[180:181], v196 offset:13968
ds_read_b64_tr_b16 a[182:183], v196 offset:20880
ds_read_b64_tr_b16 a[184:185], v196 offset:14112
ds_read_b64_tr_b16 a[186:187], v196 offset:21024
ds_read_b64_tr_b16 a[188:189], v197 offset:13824
ds_read_b64_tr_b16 a[190:191], v197 offset:20736
ds_read_b64_tr_b16 a[192:193], v196 offset:27648
ds_read_b64_tr_b16 a[194:195], v196 offset:34560
ds_read_b64_tr_b16 a[196:197], v196 offset:27792
ds_read_b64_tr_b16 a[198:199], v196 offset:34704
ds_read_b64_tr_b16 a[200:201], v196 offset:27936
ds_read_b64_tr_b16 a[202:203], v196 offset:34848
ds_read_b64_tr_b16 a[204:205], v197 offset:27648
ds_read_b64_tr_b16 a[206:207], v197 offset:34560
ds_read_b64_tr_b16 a[208:209], v196 offset:41472
ds_read_b64_tr_b16 a[210:211], v196 offset:48384
ds_read_b64_tr_b16 a[212:213], v196 offset:41616
ds_read_b64_tr_b16 a[214:215], v196 offset:48528
ds_read_b64_tr_b16 a[216:217], v196 offset:41760
ds_read_b64_tr_b16 a[218:219], v196 offset:48672
ds_read_b64_tr_b16 a[220:221], v197 offset:41472
ds_read_b64_tr_b16 a[222:223], v197 offset:48384
s_cmp_lt_u32 s48, 2
s_cselect_b64 s[6:7], -1, 0
s_waitcnt lgkmcnt(0)
s_waitcnt vmcnt(1)
s_barrier
ds_read_b128 v[108:111], v215 offset:0
ds_read_b128 v[112:115], v215 offset:18432
ds_read_b128 v[116:119], v215 offset:36864
ds_read_b128 v[120:123], v214 offset:0
ds_read_b128 v[124:127], v214 offset:18432
s_waitcnt lgkmcnt(0)
v_mfma_f32_16x16x32_bf16 v[48:51], a[4:7], v[108:111], 0
ds_read_b128 v[128:131], v215 offset:1024
s_add_u32 m0, s71, 0
v_mfma_f32_16x16x32_bf16 v[68:71], v[108:111], a[8:11], 0
ds_read_b128 v[132:135], v215 offset:19456
s_add_u32 s76, s67, 0
v_mfma_f32_16x16x32_bf16 v[88:91], a[12:15], v[108:111], 0
ds_read_b128 v[136:139], v215 offset:37888
buffer_load_dwordx4 v9, s[44:47], s76 offen offset:2048 sc1 lds
v_mfma_f32_16x16x32_bf16 v[32:35], a[0:3], v[112:115], 0
ds_read_b128 v[140:143], v214 offset:1024
buffer_load_dwordx4 v9, s[44:47], s76 offen offset:3072 sc1 lds
v_mfma_f32_16x16x32_bf16 v[52:55], a[4:7], v[112:115], 0
ds_read_b128 v[144:147], v214 offset:19456
v_mfma_f32_16x16x32_bf16 v[72:75], v[112:115], a[8:11], 0
v_mfma_f32_16x16x32_bf16 v[92:95], a[12:15], v[112:115], 0
v_mfma_f32_16x16x32_bf16 v[36:39], a[0:3], v[116:119], 0
v_mfma_f32_16x16x32_bf16 v[56:59], a[4:7], v[116:119], 0
v_mfma_f32_16x16x32_bf16 v[76:79], v[116:119], a[8:11], 0
s_add_u32 m0, s71, 18432
s_add_u32 s76, s68, 0
v_mfma_f32_16x16x32_bf16 v[96:99], a[12:15], v[116:119], 0
buffer_load_dwordx4 v9, s[44:47], s76 offen offset:2048 sc1 lds
buffer_load_dwordx4 v9, s[44:47], s76 offen offset:3072 sc1 lds
v_mfma_f32_16x16x32_bf16 v[40:43], a[0:3], v[120:123], 0
v_mfma_f32_16x16x32_bf16 v[60:63], a[4:7], v[120:123], 0
v_mfma_f32_16x16x32_bf16 v[80:83], v[120:123], a[8:11], 0
v_mfma_f32_16x16x32_bf16 v[100:103], a[12:15], v[120:123], 0
v_mfma_f32_16x16x32_bf16 v[44:47], a[0:3], v[124:127], 0
v_mfma_f32_16x16x32_bf16 v[64:67], a[4:7], v[124:127], 0
v_mfma_f32_16x16x32_bf16 v[84:87], v[124:127], a[8:11], 0
v_mfma_f32_16x16x32_bf16 v[104:107], a[12:15], v[124:127], 0
s_waitcnt lgkmcnt(0)
s_cmp_lg_u32 s2, 255
s_cbranch_scc1 L_l0x
v_lshlrev_b32 v200, 4, v0
v_add_u32 v200, 4608, v200
v_add_u32 v201, 4096, v200
s_lshl_b32 s53, s48, 8
s_add_u32 s53, s53, 12800
v_lshl_add_u32 v202, v6, 4, s53
v_subrev_u32 v206, 32, v0
v_cmp_gt_u32 vcc, 144, v206
s_nop 1
v_cndmask_b32 v206, 0, 1.0, vcc
s_mov_b32 s53, 4096
buffer_load_dwordx4 v[148:151], v200, s[44:47], s53 offen sc1
s_mov_b32 s53, 17920
buffer_load_dwordx4 v[152:155], v200, s[44:47], s53 offen sc1
s_mov_b32 s53, 31744
buffer_load_dwordx4 v[156:159], v200, s[44:47], s53 offen sc1
s_mov_b32 s53, 45568
buffer_load_dwordx4 v[160:163], v200, s[44:47], s53 offen sc1
s_mov_b32 s53, 4096
buffer_load_dwordx4 v[180:183], v202, s[44:47], s53 offen sc1
s_mov_b32 s53, 17920
buffer_load_dwordx4 v[184:187], v202, s[44:47], s53 offen sc1
s_mov_b32 s53, 31744
buffer_load_dwordx4 v[188:191], v202, s[44:47], s53 offen sc1
s_mov_b32 s53, 45568
buffer_load_dwordx4 v[192:195], v202, s[44:47], s53 offen sc1
s_mov_b32 s53, 4096
buffer_load_dwordx4 v[164:167], v201, s[44:47], s53 offen sc1
s_mov_b32 s53, 17920
buffer_load_dwordx4 v[168:171], v201, s[44:47], s53 offen sc1
s_mov_b32 s53, 31744
buffer_load_dwordx4 v[172:175], v201, s[44:47], s53 offen sc1
s_mov_b32 s53, 45568
buffer_load_dwordx4 v[176:179], v201, s[44:47], s53 offen sc1
L_l0x:
v_mfma_f32_16x16x32_bf16 v[48:51], a[20:23], v[128:131], v[48:51]
ds_read_b128 v[108:111], v215 offset:4096
v_mul_u32_u24 v2, 7282, v1
v_mfma_f32_16x16x32_bf16 v[68:71], v[128:131], a[24:27], v[68:71]
ds_read_b128 v[112:115], v215 offset:22528
s_add_u32 m0, s71, 36864
v_mfma_f32_16x16x32_bf16 v[88:91], a[28:31], v[128:131], v[88:91]
ds_read_b128 v[116:119], v215 offset:40960
s_add_u32 s76, s68, 18432
v_mfma_f32_16x16x32_bf16 v[32:35], a[16:19], v[132:135], v[32:35]
ds_read_b128 v[120:123], v214 offset:4096
buffer_load_dwordx4 v9, s[44:47], s76 offen offset:2048 sc1 lds
v_mfma_f32_16x16x32_bf16 v[52:55], a[20:23], v[132:135], v[52:55]
ds_read_b128 v[124:127], v214 offset:22528
buffer_load_dwordx4 v9, s[44:47], s76 offen offset:3072 sc1 lds
v_mfma_f32_16x16x32_bf16 v[72:75], v[132:135], a[24:27], v[72:75]
v_lshrrev_b32 v2, 16, v2
v_mul_u32_u24 v3, 9, v2
v_mfma_f32_16x16x32_bf16 v[92:95], a[28:31], v[132:135], v[92:95]
v_sub_u32 v3, v1, v3
v_and_b32 v12, 1, v2
v_mfma_f32_16x16x32_bf16 v[36:39], a[16:19], v[136:139], v[36:39]
v_lshrrev_b32 v13, 1, v2
v_mfma_f32_16x16x32_bf16 v[56:59], a[20:23], v[136:139], v[56:59]
v_lshl_add_u32 v11, v12, 3, v13
v_mfma_f32_16x16x32_bf16 v[76:79], v[136:139], a[24:27], v[76:79]
s_add_u32 m0, s71, 55296
v_mul_u32_u24 v11, 1152, v11
v_mfma_f32_16x16x32_bf16 v[96:99], a[28:31], v[136:139], v[96:99]
s_add_u32 s76, s68, 36864
v_lshl_add_u32 v11, v3, 4, v11
v_mfma_f32_16x16x32_bf16 v[40:43], a[16:19], v[140:143], v[40:43]
buffer_load_dwordx4 v9, s[44:47], s76 offen offset:2048 sc1 lds
buffer_load_dwordx4 v9, s[44:47], s76 offen offset:3072 sc1 lds
v_mfma_f32_16x16x32_bf16 v[60:63], a[20:23], v[140:143], v[60:63]
v_mul_u32_u24 v212, 144, v12
v_add_u32 v212, v212, v13
v_mfma_f32_16x16x32_bf16 v[80:83], v[140:143], a[24:27], v[80:83]
v_mfma_f32_16x16x32_bf16 v[100:103], a[28:31], v[140:143], v[100:103]
v_mul_u32_u24 v212, 1152, v212
v_mfma_f32_16x16x32_bf16 v[44:47], a[16:19], v[144:147], v[44:47]
v_lshl_add_u32 v212, v3, 4, v212
v_mfma_f32_16x16x32_bf16 v[64:67], a[20:23], v[144:147], v[64:67]
v_add_u32 v210, 1728, v11
v_mfma_f32_16x16x32_bf16 v[84:87], v[144:147], a[24:27], v[84:87]
v_add_u32 v211, 1728, v212
v_mfma_f32_16x16x32_bf16 v[104:107], a[28:31], v[144:147], v[104:107]
s_waitcnt lgkmcnt(0)
v_mfma_f32_16x16x32_bf16 v[48:51], a[36:39], v[108:111], v[48:51]
ds_read_b128 v[128:131], v215 offset:5120
s_add_u32 m0, s71, 73728
v_mfma_f32_16x16x32_bf16 v[68:71], v[108:111], a[40:43], v[68:71]
ds_read_b128 v[132:135], v215 offset:23552
s_add_u32 s76, s68, 55296
v_mfma_f32_16x16x32_bf16 v[88:91], a[44:47], v[108:111], v[88:91]
ds_read_b128 v[136:139], v215 offset:41984
buffer_load_dwordx4 v9, s[44:47], s76 offen offset:2048 sc1 lds
v_mfma_f32_16x16x32_bf16 v[32:35], a[32:35], v[112:115], v[32:35]
ds_read_b128 v[140:143], v214 offset:5120
buffer_load_dwordx4 v9, s[44:47], s76 offen offset:3072 sc1 lds
v_mfma_f32_16x16x32_bf16 v[52:55], a[36:39], v[112:115], v[52:55]
ds_read_b128 v[144:147], v214 offset:23552
s_lshr_b32 s53, s48, 1
v_mfma_f32_16x16x32_bf16 v[72:75], v[112:115], a[40:43], v[72:75]
s_and_b32 s54, s48, 1
s_mul_i32 s62, s53, 20
v_mfma_f32_16x16x32_bf16 v[92:95], a[44:47], v[112:115], v[92:95]
s_lshl_b32 s55, s54, 2
s_add_u32 s62, s62, s55
v_mfma_f32_16x16x32_bf16 v[36:39], a[32:35], v[116:119], v[36:39]
s_mul_i32 s62, s62, 1152
s_mul_i32 s63, s54, 72
v_mfma_f32_16x16x32_bf16 v[56:59], a[36:39], v[116:119], v[56:59]
s_mul_i32 s55, s53, 36
v_mfma_f32_16x16x32_bf16 v[76:79], v[116:119], a[40:43], v[76:79]
s_add_u32 s63, s63, s55
s_add_u32 s63, s63, 16
v_mfma_f32_16x16x32_bf16 v[96:99], a[44:47], v[116:119], v[96:99]
s_mul_i32 s63, s63, 1152
v_mfma_f32_16x16x32_bf16 v[40:43], a[32:35], v[120:123], v[40:43]
v_mfma_f32_16x16x32_bf16 v[60:63], a[36:39], v[120:123], v[60:63]
v_mfma_f32_16x16x32_bf16 v[80:83], v[120:123], a[40:43], v[80:83]
v_mfma_f32_16x16x32_bf16 v[100:103], a[44:47], v[120:123], v[100:103]
s_mul_i32 s55, s50, 144
s_add_u32 s62, s62, s55
v_mfma_f32_16x16x32_bf16 v[44:47], a[32:35], v[124:127], v[44:47]
s_add_u32 s63, s63, s55
s_mul_i32 s3, s48, 1152
v_mfma_f32_16x16x32_bf16 v[64:67], a[36:39], v[124:127], v[64:67]
v_mfma_f32_16x16x32_bf16 v[84:87], v[124:127], a[40:43], v[84:87]
v_mfma_f32_16x16x32_bf16 v[104:107], a[44:47], v[124:127], v[104:107]
s_waitcnt lgkmcnt(0)
v_mfma_f32_16x16x32_bf16 v[48:51], a[52:55], v[128:131], v[48:51]
ds_read_b128 v[108:111], v215 offset:8192
s_add_u32 m0, s72, 0
v_mfma_f32_16x16x32_bf16 v[68:71], v[128:131], a[56:59], v[68:71]
ds_read_b128 v[112:115], v215 offset:26624
s_add_u32 s76, s69, 0
v_mfma_f32_16x16x32_bf16 v[88:91], a[60:63], v[128:131], v[88:91]
ds_read_b128 v[116:119], v215 offset:45056
s_mov_b64 exec, s[6:7]
v_mfma_f32_16x16x32_bf16 v[32:35], a[48:51], v[132:135], v[32:35]
buffer_load_dwordx4 v9, s[44:47], s76 offen offset:0 sc1 lds
s_mov_b64 exec, -1
v_mfma_f32_16x16x32_bf16 v[52:55], a[52:55], v[132:135], v[52:55]
ds_read_b128 v[120:123], v214 offset:8192
s_add_u32 m0, s72, 18432
v_mfma_f32_16x16x32_bf16 v[72:75], v[132:135], a[56:59], v[72:75]
ds_read_b128 v[124:127], v214 offset:26624
s_add_u32 s76, s70, 0
v_mfma_f32_16x16x32_bf16 v[92:95], a[60:63], v[132:135], v[92:95]
s_mov_b64 exec, s[6:7]
buffer_load_dwordx4 v9, s[44:47], s76 offen offset:0 sc1 lds
v_mfma_f32_16x16x32_bf16 v[36:39], a[48:51], v[136:139], v[36:39]
s_mov_b64 exec, -1
v_lshrrev_b32 v2, 2, v1
v_mfma_f32_16x16x32_bf16 v[56:59], a[52:55], v[136:139], v[56:59]
v_mul_u32_u24 v2, 1152, v2
v_lshl_add_u32 v2, v16, 3, v2
v_mfma_f32_16x16x32_bf16 v[76:79], v[136:139], a[56:59], v[76:79]
s_lshl_b32 s55, s49, 2
s_add_u32 s55, s55, s48
v_mfma_f32_16x16x32_bf16 v[96:99], a[60:63], v[136:139], v[96:99]
s_mul_i32 s55, s55, 18432
s_mul_i32 s54, s50, 144
v_mfma_f32_16x16x32_bf16 v[40:43], a[48:51], v[140:143], v[40:43]
s_add_u32 s55, s55, s54
buffer_load_dwordx2 v[22:23], v2, s[8:11], s55 offen offset:0
v_mfma_f32_16x16x32_bf16 v[60:63], a[52:55], v[140:143], v[60:63]
buffer_load_dwordx2 v[24:25], v2, s[8:11], s55 offen offset:32
v_mfma_f32_16x16x32_bf16 v[80:83], v[140:143], a[56:59], v[80:83]
v_mfma_f32_16x16x32_bf16 v[100:103], a[60:63], v[140:143], v[100:103]
buffer_load_dwordx2 v[26:27], v2, s[8:11], s55 offen offset:64
v_mfma_f32_16x16x32_bf16 v[44:47], a[48:51], v[144:147], v[44:47]
buffer_load_dwordx2 v[28:29], v2, s[8:11], s55 offen offset:96
v_mfma_f32_16x16x32_bf16 v[64:67], a[52:55], v[144:147], v[64:67]
v_mfma_f32_16x16x32_bf16 v[84:87], v[144:147], a[56:59], v[84:87]
buffer_load_dwordx2 v[30:31], v2, s[8:11], s55 offen offset:128
v_mfma_f32_16x16x32_bf16 v[104:107], a[60:63], v[144:147], v[104:107]
s_waitcnt lgkmcnt(0)
v_mfma_f32_16x16x32_bf16 v[48:51], a[68:71], v[108:111], v[48:51]
ds_read_b128 v[128:131], v215 offset:9216
v_lshl_add_u32 v207, v6, 2, v7
v_mfma_f32_16x16x32_bf16 v[68:71], v[108:111], a[72:75], v[68:71]
ds_read_b128 v[132:135], v215 offset:27648
s_add_u32 m0, s72, 36864
v_mfma_f32_16x16x32_bf16 v[88:91], a[76:79], v[108:111], v[88:91]
ds_read_b128 v[136:139], v215 offset:46080
s_add_u32 s76, s70, 18432
v_mfma_f32_16x16x32_bf16 v[32:35], a[64:67], v[112:115], v[32:35]
ds_read_b128 v[140:143], v214 offset:9216
s_mov_b64 exec, s[6:7]
v_mfma_f32_16x16x32_bf16 v[52:55], a[68:71], v[112:115], v[52:55]
buffer_load_dwordx4 v9, s[44:47], s76 offen offset:0 sc1 lds
s_mov_b64 exec, -1
v_mfma_f32_16x16x32_bf16 v[72:75], v[112:115], a[72:75], v[72:75]
ds_read_b128 v[144:147], v214 offset:27648
s_add_u32 m0, s72, 55296
v_mfma_f32_16x16x32_bf16 v[92:95], a[76:79], v[112:115], v[92:95]
s_add_u32 s76, s70, 36864
s_mov_b64 exec, s[6:7]
v_mfma_f32_16x16x32_bf16 v[36:39], a[64:67], v[116:119], v[36:39]
buffer_load_dwordx4 v9, s[44:47], s76 offen offset:0 sc1 lds
s_mov_b64 exec, -1
v_mfma_f32_16x16x32_bf16 v[56:59], a[68:71], v[116:119], v[56:59]
s_add_u32 m0, s72, 73728
s_add_u32 s76, s70, 55296
v_mfma_f32_16x16x32_bf16 v[76:79], v[116:119], a[72:75], v[76:79]
s_mov_b64 exec, s[6:7]
buffer_load_dwordx4 v9, s[44:47], s76 offen offset:0 sc1 lds
v_mfma_f32_16x16x32_bf16 v[96:99], a[76:79], v[116:119], v[96:99]
s_mov_b64 exec, -1
v_lshlrev_b32 v207, 2, v207
v_mfma_f32_16x16x32_bf16 v[40:43], a[64:67], v[120:123], v[40:43]
s_add_u32 m0, s61, 92160
s_add_u32 s76, s60, 1548288
v_mfma_f32_16x16x32_bf16 v[60:63], a[68:71], v[120:123], v[60:63]
s_mov_b32 exec_hi, 0x3fffff
buffer_load_dwordx4 v10, s[12:15], s76 offen offset:0 lds
v_mfma_f32_16x16x32_bf16 v[80:83], v[120:123], a[72:75], v[80:83]
buffer_load_dwordx4 v8, s[12:15], s76 offen offset:864 lds
s_mov_b32 exec_hi, -1
v_mfma_f32_16x16x32_bf16 v[100:103], a[76:79], v[120:123], v[100:103]
v_mfma_f32_16x16x32_bf16 v[44:47], a[64:67], v[124:127], v[44:47]
s_mov_b32 exec_hi, 0x3fffff
buffer_load_dwordx4 v17, s[12:15], s76 offen offset:1728 lds
v_mfma_f32_16x16x32_bf16 v[64:67], a[68:71], v[124:127], v[64:67]
buffer_load_dwordx4 v18, s[12:15], s76 offen offset:2592 lds
s_mov_b32 exec_hi, -1
v_mfma_f32_16x16x32_bf16 v[84:87], v[124:127], a[72:75], v[84:87]
v_mfma_f32_16x16x32_bf16 v[104:107], a[76:79], v[124:127], v[104:107]
s_waitcnt lgkmcnt(0)
v_mfma_f32_16x16x32_bf16 v[48:51], a[84:87], v[128:131], v[48:51]
ds_read_b128 v[108:111], v215 offset:12288
v_lshrrev_b32 v2, 1, v6
v_mfma_f32_16x16x32_bf16 v[68:71], v[128:131], a[88:91], v[68:71]
ds_read_b128 v[112:115], v215 offset:30720
s_add_u32 m0, s61, 105984
v_mfma_f32_16x16x32_bf16 v[88:91], a[92:95], v[128:131], v[88:91]
ds_read_b128 v[116:119], v215 offset:49152
s_add_u32 s76, s60, 1658880
v_mfma_f32_16x16x32_bf16 v[32:35], a[80:83], v[132:135], v[32:35]
ds_read_b128 v[120:123], v214 offset:12288
v_lshlrev_b32 v3, 1, v7
v_mfma_f32_16x16x32_bf16 v[52:55], a[84:87], v[132:135], v[52:55]
ds_read_b128 v[124:127], v214 offset:30720
v_add_u32 v4, 1, v3
v_mfma_f32_16x16x32_bf16 v[72:75], v[132:135], a[88:91], v[72:75]
v_cmp_le_u32 s[64:65], v3, v2
v_mfma_f32_16x16x32_bf16 v[92:95], a[92:95], v[132:135], v[92:95]
s_mov_b32 exec_hi, 0x3fffff
buffer_load_dwordx4 v10, s[12:15], s76 offen offset:0 lds
v_mfma_f32_16x16x32_bf16 v[36:39], a[80:83], v[136:139], v[36:39]
buffer_load_dwordx4 v8, s[12:15], s76 offen offset:864 lds
s_mov_b32 exec_hi, -1
v_mfma_f32_16x16x32_bf16 v[56:59], a[84:87], v[136:139], v[56:59]
v_cmp_le_u32 s[66:67], v4, v2
v_mov_b32 v2, 0xffff
v_mfma_f32_16x16x32_bf16 v[76:79], v[136:139], a[88:91], v[76:79]
v_mov_b32 v3, 0xffff0000
v_mfma_f32_16x16x32_bf16 v[96:99], a[92:95], v[136:139], v[96:99]
v_mfma_f32_16x16x32_bf16 v[40:43], a[80:83], v[140:143], v[40:43]
v_cndmask_b32 v2, v2, v3, s[56:57]
v_mfma_f32_16x16x32_bf16 v[60:63], a[84:87], v[140:143], v[60:63]
s_mov_b32 exec_hi, 0x3fffff
buffer_load_dwordx4 v17, s[12:15], s76 offen offset:1728 lds
v_mfma_f32_16x16x32_bf16 v[80:83], v[140:143], a[88:91], v[80:83]
buffer_load_dwordx4 v18, s[12:15], s76 offen offset:2592 lds
s_mov_b32 exec_hi, -1
v_mfma_f32_16x16x32_bf16 v[100:103], a[92:95], v[140:143], v[100:103]
v_cndmask_b32 v12, v2, 0, s[64:65]
v_cndmask_b32 v13, v2, 0, s[66:67]
v_mfma_f32_16x16x32_bf16 v[44:47], a[80:83], v[144:147], v[44:47]
v_cndmask_b32 v14, 0, v2, s[64:65]
v_mfma_f32_16x16x32_bf16 v[64:67], a[84:87], v[144:147], v[64:67]
v_mfma_f32_16x16x32_bf16 v[84:87], v[144:147], a[88:91], v[84:87]
v_cndmask_b32 v209, 0, v2, s[66:67]
v_mfma_f32_16x16x32_bf16 v[104:107], a[92:95], v[144:147], v[104:107]
s_waitcnt lgkmcnt(0)
v_mfma_f32_16x16x32_bf16 v[48:51], a[100:103], v[108:111], v[48:51]
ds_read_b128 v[128:131], v215 offset:13312
v_cmp_eq_u32 s[68:69], 1, v7
v_mfma_f32_16x16x32_bf16 v[68:71], v[108:111], a[104:107], v[68:71]
ds_read_b128 v[132:135], v215 offset:31744
s_add_u32 m0, s61, 119808
v_mfma_f32_16x16x32_bf16 v[88:91], a[108:111], v[108:111], v[88:91]
ds_read_b128 v[136:139], v215 offset:50176
s_add_u32 s76, s60, 1769472
v_mfma_f32_16x16x32_bf16 v[32:35], a[96:99], v[112:115], v[32:35]
ds_read_b128 v[140:143], v214 offset:13312
s_bfe_i32 s70, s48, 0x10000
v_mfma_f32_16x16x32_bf16 v[52:55], a[100:103], v[112:115], v[52:55]
ds_read_b128 v[144:147], v214 offset:31744
s_mov_b32 s71, s70
v_mfma_f32_16x16x32_bf16 v[72:75], v[112:115], a[104:107], v[72:75]
s_min_u32 s72, s49, 1
s_sub_u32 s72, s72, 1
v_mfma_f32_16x16x32_bf16 v[92:95], a[108:111], v[112:115], v[92:95]
s_mov_b32 exec_hi, 0x3fffff
buffer_load_dwordx4 v10, s[12:15], s76 offen offset:0 lds
v_mfma_f32_16x16x32_bf16 v[36:39], a[96:99], v[116:119], v[36:39]
buffer_load_dwordx4 v8, s[12:15], s76 offen offset:864 lds
s_mov_b32 exec_hi, -1
v_mfma_f32_16x16x32_bf16 v[56:59], a[100:103], v[116:119], v[56:59]
s_mov_b32 s73, s72
s_mul_i32 s53, s48, 640
v_mfma_f32_16x16x32_bf16 v[76:79], v[116:119], a[104:107], v[76:79]
s_add_u32 s53, s53, 161280
v_lshl_add_u32 v19, v6, 1, s53
v_mfma_f32_16x16x32_bf16 v[96:99], a[108:111], v[116:119], v[96:99]
v_min_u32 v2, 2, v16
v_mfma_f32_16x16x32_bf16 v[40:43], a[96:99], v[120:123], v[40:43]
v_mul_u32_u24 v2, 160, v2
v_mfma_f32_16x16x32_bf16 v[60:63], a[100:103], v[120:123], v[60:63]
s_mov_b32 exec_hi, 0x3fffff
buffer_load_dwordx4 v17, s[12:15], s76 offen offset:1728 lds
v_mfma_f32_16x16x32_bf16 v[80:83], v[120:123], a[104:107], v[80:83]
buffer_load_dwordx4 v18, s[12:15], s76 offen offset:2592 lds
s_mov_b32 exec_hi, -1
v_mfma_f32_16x16x32_bf16 v[100:103], a[108:111], v[120:123], v[100:103]
v_lshl_add_u32 v2, v7, 3, v2
v_add_u32 v20, s53, v2
v_mfma_f32_16x16x32_bf16 v[44:47], a[96:99], v[124:127], v[44:47]
v_lshl_add_u32 v3, v1, 2, s53
v_mfma_f32_16x16x32_bf16 v[64:67], a[100:103], v[124:127], v[64:67]
v_mov_b32 v4, 0x3f803f80
v_mfma_f32_16x16x32_bf16 v[84:87], v[124:127], a[104:107], v[84:87]
ds_write_b32 v3, v4 offset:320
v_mfma_f32_16x16x32_bf16 v[104:107], a[108:111], v[124:127], v[104:107]
s_waitcnt lgkmcnt(1)
s_cmp_lg_u32 s2, 255
s_cbranch_scc1 L_l1x
s_waitcnt vmcnt(0)
v_lshlrev_b32 v200, 4, v0
v_add_u32 v200, 4608, v200
v_add_u32 v201, 4096, v200
s_lshl_b32 s53, s48, 8
s_add_u32 s53, s53, 12800
v_lshl_add_u32 v202, v6, 4, s53
v_subrev_u32 v206, 32, v0
v_cmp_gt_u32 vcc, 144, v206
s_nop 1
v_cndmask_b32 v206, 0, 1.0, vcc
v_add_f32 v148, v148, v152
v_add_f32 v149, v149, v153
v_add_f32 v150, v150, v154
v_add_f32 v151, v151, v155
v_add_f32 v156, v156, v160
v_add_f32 v157, v157, v161
v_add_f32 v158, v158, v162
v_add_f32 v159, v159, v163
v_add_f32 v148, v148, v156
v_add_f32 v149, v149, v157
v_add_f32 v150, v150, v158
v_add_f32 v151, v151, v159
v_cvt_pk_bf16_f32 v152, v148, v149
v_cvt_pk_bf16_f32 v153, v150, v151
v_lshlrev_b32 v148, 16, v152
v_and_b32 v149, 0xffff0000, v152
v_lshlrev_b32 v150, 16, v153
v_and_b32 v151, 0xffff0000, v153
s_mov_b32 s53, 983040
buffer_store_dwordx4 v[148:151], v200, s[44:47], s53 offen sc1
v_add_f32 v180, v180, v184
v_add_f32 v181, v181, v185
v_add_f32 v182, v182, v186
v_add_f32 v183, v183, v187
v_add_f32 v188, v188, v192
v_add_f32 v189, v189, v193
v_add_f32 v190, v190, v194
v_add_f32 v191, v191, v195
v_add_f32 v180, v180, v188
v_add_f32 v181, v181, v189
v_add_f32 v182, v182, v190
v_add_f32 v183, v183, v191
v_cvt_pk_bf16_f32 v184, v180, v181
v_cvt_pk_bf16_f32 v185, v182, v183
v_lshlrev_b32 v180, 16, v184
v_and_b32 v181, 0xffff0000, v184
v_lshlrev_b32 v182, 16, v185
v_and_b32 v183, 0xffff0000, v185
s_mov_b32 s53, 983040
buffer_store_dwordx4 v[180:183], v202, s[44:47], s53 offen sc1
v_add_f32 v164, v164, v168
v_add_f32 v165, v165, v169
v_add_f32 v166, v166, v170
v_add_f32 v167, v167, v171
v_add_f32 v172, v172, v176
v_add_f32 v173, v173, v177
v_add_f32 v174, v174, v178
v_add_f32 v175, v175, v179
v_add_f32 v164, v164, v172
v_add_f32 v165, v165, v173
v_add_f32 v166, v166, v174
v_add_f32 v167, v167, v175
v_cvt_pk_bf16_f32 v168, v164, v165
v_cvt_pk_bf16_f32 v169, v166, v167
v_lshlrev_b32 v164, 16, v168
v_and_b32 v165, 0xffff0000, v168
v_lshlrev_b32 v166, 16, v169
v_and_b32 v167, 0xffff0000, v169
v_add_f32 v164, v206, v164
v_add_f32 v165, v206, v165
v_add_f32 v166, v206, v166
v_add_f32 v167, v206, v167
v_cvt_pk_bf16_f32 v168, v164, v165
v_cvt_pk_bf16_f32 v169, v166, v167
v_lshlrev_b32 v164, 16, v168
v_and_b32 v165, 0xffff0000, v168
v_lshlrev_b32 v166, 16, v169
v_and_b32 v167, 0xffff0000, v169
s_mov_b32 s53, 983040
buffer_store_dwordx4 v[164:167], v201, s[44:47], s53 offen sc1
L_l1x:
s_waitcnt vmcnt(22)
s_barrier
v_mfma_f32_16x16x32_bf16 v[48:51], a[116:119], v[128:131], v[48:51]
ds_read_b128 v[108:111], v215 offset:2048
s_add_u32 m0, s61, 133632
s_add_u32 s76, s60, 1880064
v_mfma_f32_16x16x32_bf16 v[68:71], v[128:131], a[120:123], v[68:71]
ds_read_b128 v[112:115], v215 offset:20480
s_waitcnt vmcnt(15)
s_mov_b32 exec_hi, 0x3fffff
v_mfma_f32_16x16x32_bf16 v[88:91], a[124:127], v[128:131], v[88:91]
buffer_load_dwordx4 v10, s[12:15], s76 offen offset:0 lds
buffer_load_dwordx4 v8, s[12:15], s76 offen offset:864 lds
v_mfma_f32_16x16x32_bf16 v[32:35], a[112:115], v[132:135], v[32:35]
s_mov_b32 exec_hi, -1
s_mov_b32 exec_hi, 0x3fffff
v_mfma_f32_16x16x32_bf16 v[52:55], a[116:119], v[132:135], v[52:55]
buffer_load_dwordx4 v17, s[12:15], s76 offen offset:1728 lds
buffer_load_dwordx4 v18, s[12:15], s76 offen offset:2592 lds
v_mfma_f32_16x16x32_bf16 v[72:75], v[132:135], a[120:123], v[72:75]
s_mov_b32 exec_hi, -1
ds_read_b128 v[116:119], v215 offset:38912
v_mfma_f32_16x16x32_bf16 v[92:95], a[124:127], v[132:135], v[92:95]
ds_read_b128 v[120:123], v214 offset:2048
ds_bpermute_b32 v22, v207, v22
v_mfma_f32_16x16x32_bf16 v[36:39], a[112:115], v[136:139], v[36:39]
ds_read_b128 v[124:127], v214 offset:20480
s_lshr_b32 s75, s50, 1
v_mfma_f32_16x16x32_bf16 v[56:59], a[116:119], v[136:139], v[56:59]
s_mul_i32 s75, s75, 288
s_and_b32 s75, s75, -128
v_mfma_f32_16x16x32_bf16 v[76:79], v[136:139], a[120:123], v[76:79]
s_lshr_b32 s74, s2, 3
s_mul_i32 s74, s74, 20736
v_mfma_f32_16x16x32_bf16 v[96:99], a[124:127], v[136:139], v[96:99]
s_add_u32 s75, s75, s74
s_add_u32 s75, s75, 0
v_mfma_f32_16x16x32_bf16 v[40:43], a[112:115], v[140:143], v[40:43]
s_mul_i32 s74, s48, 14
s_add_u32 s74, s74, 0
v_mfma_f32_16x16x32_bf16 v[60:63], a[116:119], v[140:143], v[60:63]
v_add_u32 v2, s74, v1
v_cmp_gt_u32 vcc, 14, v1
v_mfma_f32_16x16x32_bf16 v[80:83], v[140:143], a[120:123], v[80:83]
ds_bpermute_b32 v23, v207, v23
v_mul_u32_u24 v3, 21846, v2
v_mfma_f32_16x16x32_bf16 v[100:103], a[124:127], v[140:143], v[100:103]
ds_bpermute_b32 v24, v207, v24
v_lshrrev_b32 v3, 16, v3
v_mfma_f32_16x16x32_bf16 v[44:47], a[112:115], v[144:147], v[44:47]
v_mul_u32_u24 v3, 768, v3
v_lshl_add_u32 v2, v2, 7, v3
v_mfma_f32_16x16x32_bf16 v[64:67], a[116:119], v[144:147], v[64:67]
ds_bpermute_b32 v25, v207, v25
v_bfrev_b32 v4, -2
v_mfma_f32_16x16x32_bf16 v[84:87], v[144:147], a[120:123], v[84:87]
ds_bpermute_b32 v26, v207, v26
v_cndmask_b32 v2, v4, v2, vcc
v_mfma_f32_16x16x32_bf16 v[104:107], a[124:127], v[144:147], v[104:107]
buffer_load_dword v219, v2, s[16:19], s75 offen
s_waitcnt lgkmcnt(4)
v_mfma_f32_16x16x32_bf16 v[48:51], a[132:135], v[108:111], v[48:51]
ds_read_b128 v[128:131], v215 offset:3072
s_mul_i32 s75, s52, 1152
v_mfma_f32_16x16x32_bf16 v[68:71], v[108:111], a[136:139], v[68:71]
ds_read_b128 v[132:135], v215 offset:21504
s_lshr_b32 s74, s2, 4
v_mfma_f32_16x16x32_bf16 v[88:91], a[140:143], v[108:111], v[88:91]
ds_read_b128 v[136:139], v215 offset:39936
s_mul_i32 s74, s74, 331776
v_mfma_f32_16x16x32_bf16 v[32:35], a[128:131], v[112:115], v[32:35]
ds_read_b128 v[140:143], v214 offset:3072
s_add_u32 s75, s75, s74
v_mfma_f32_16x16x32_bf16 v[52:55], a[132:135], v[112:115], v[52:55]
ds_read_b128 v[144:147], v214 offset:21504
s_add_u32 s75, s75, 0
v_mfma_f32_16x16x32_bf16 v[72:75], v[112:115], a[136:139], v[72:75]
s_mul_i32 s74, s48, 27
v_mfma_f32_16x16x32_bf16 v[92:95], a[140:143], v[112:115], v[92:95]
s_add_u32 s74, s74, 0
v_add_u32 v220, s74, v1
v_mfma_f32_16x16x32_bf16 v[36:39], a[128:131], v[116:119], v[36:39]
ds_bpermute_b32 v27, v207, v27
v_cmp_gt_u32 vcc, 27, v1
v_mfma_f32_16x16x32_bf16 v[56:59], a[132:135], v[116:119], v[56:59]
v_mul_u32_u24 v221, 21846, v220
v_lshrrev_b32 v221, 16, v221
v_mfma_f32_16x16x32_bf16 v[76:79], v[116:119], a[136:139], v[76:79]
ds_bpermute_b32 v28, v207, v28
v_mul_u32_u24 v221, 8832, v221
v_mfma_f32_16x16x32_bf16 v[96:99], a[140:143], v[116:119], v[96:99]
ds_bpermute_b32 v29, v207, v29
v_mfma_f32_16x16x32_bf16 v[40:43], a[128:131], v[120:123], v[40:43]
v_lshl_add_u32 v220, v220, 7, v221
v_mfma_f32_16x16x32_bf16 v[60:63], a[132:135], v[120:123], v[60:63]
ds_bpermute_b32 v30, v207, v30
v_mfma_f32_16x16x32_bf16 v[80:83], v[120:123], a[136:139], v[80:83]
v_bfrev_b32 v222, -2
v_mfma_f32_16x16x32_bf16 v[100:103], a[140:143], v[120:123], v[100:103]
v_mfma_f32_16x16x32_bf16 v[44:47], a[128:131], v[124:127], v[44:47]
ds_bpermute_b32 v31, v207, v31
v_cndmask_b32 v220, v222, v220, vcc
v_mfma_f32_16x16x32_bf16 v[64:67], a[132:135], v[124:127], v[64:67]
v_mfma_f32_16x16x32_bf16 v[84:87], v[124:127], a[136:139], v[84:87]
buffer_load_dword v216, v220, s[20:23], s75 offen
v_mfma_f32_16x16x32_bf16 v[104:107], a[140:143], v[124:127], v[104:107]
s_waitcnt lgkmcnt(5)
v_mfma_f32_16x16x32_bf16 v[48:51], a[148:151], v[128:131], v[48:51]
ds_read_b128 v[108:111], v215 offset:6144
s_mul_i32 s75, s52, 1152
v_mfma_f32_16x16x32_bf16 v[68:71], v[128:131], a[152:155], v[68:71]
ds_read_b128 v[112:115], v215 offset:24576
s_lshr_b32 s74, s2, 4
v_mfma_f32_16x16x32_bf16 v[88:91], a[156:159], v[128:131], v[88:91]
ds_read_b128 v[116:119], v215 offset:43008
s_mul_i32 s74, s74, 331776
v_mfma_f32_16x16x32_bf16 v[32:35], a[144:147], v[132:135], v[32:35]
ds_read_b128 v[120:123], v214 offset:6144
s_add_u32 s75, s75, s74
v_mfma_f32_16x16x32_bf16 v[52:55], a[148:151], v[132:135], v[52:55]
ds_read_b128 v[124:127], v214 offset:24576
s_add_u32 s75, s75, 384
v_mfma_f32_16x16x32_bf16 v[72:75], v[132:135], a[152:155], v[72:75]
s_mul_i32 s74, s48, 27
s_add_u32 s74, s74, 0
v_mfma_f32_16x16x32_bf16 v[92:95], a[156:159], v[132:135], v[92:95]
v_add_u32 v220, s74, v1
v_cmp_gt_u32 vcc, 27, v1
v_mfma_f32_16x16x32_bf16 v[36:39], a[144:147], v[136:139], v[36:39]
v_mul_u32_u24 v221, 21846, v220
v_mfma_f32_16x16x32_bf16 v[56:59], a[148:151], v[136:139], v[56:59]
v_lshrrev_b32 v221, 16, v221
v_mfma_f32_16x16x32_bf16 v[76:79], v[136:139], a[152:155], v[76:79]
v_mul_u32_u24 v221, 8832, v221
v_mfma_f32_16x16x32_bf16 v[96:99], a[156:159], v[136:139], v[96:99]
v_mfma_f32_16x16x32_bf16 v[40:43], a[144:147], v[140:143], v[40:43]
v_lshl_add_u32 v220, v220, 7, v221
v_mfma_f32_16x16x32_bf16 v[60:63], a[148:151], v[140:143], v[60:63]
v_mfma_f32_16x16x32_bf16 v[80:83], v[140:143], a[152:155], v[80:83]
v_bfrev_b32 v222, -2
v_mfma_f32_16x16x32_bf16 v[100:103], a[156:159], v[140:143], v[100:103]
v_mfma_f32_16x16x32_bf16 v[44:47], a[144:147], v[144:147], v[44:47]
v_cndmask_b32 v220, v222, v220, vcc
v_mfma_f32_16x16x32_bf16 v[64:67], a[148:151], v[144:147], v[64:67]
v_mfma_f32_16x16x32_bf16 v[84:87], v[144:147], a[152:155], v[84:87]
buffer_load_dword v217, v220, s[20:23], s75 offen
v_mfma_f32_16x16x32_bf16 v[104:107], a[156:159], v[144:147], v[104:107]
s_waitcnt lgkmcnt(0)
s_cmp_lg_u32 s2, 255
s_cbranch_scc1 L_l2x
s_waitcnt vmcnt(0)
L_l2x:
s_waitcnt vmcnt(3)
s_barrier
s_cmp_lg_u32 s2, 255
s_cbranch_scc1 L_l3x
s_cmp_lg_u32 s48, 0
s_cbranch_scc1 L_l3x
s_mov_b64 exec, 1
buffer_store_dword v21, v9, s[44:47], 0 offen sc1
s_mov_b64 exec, -1
L_l3x:
v_mfma_f32_16x16x32_bf16 v[48:51], a[164:167], v[108:111], v[48:51]
ds_read_b64_tr_b16 a[224:225], v196 offset:0
s_mul_i32 s75, s52, 1152
v_mfma_f32_16x16x32_bf16 v[68:71], v[108:111], a[168:171], v[68:71]
ds_read_b64_tr_b16 a[226:227], v196 offset:6912
s_lshr_b32 s74, s2, 4
v_mfma_f32_16x16x32_bf16 v[88:91], a[172:175], v[108:111], v[88:91]
ds_read_b64_tr_b16 a[228:229], v196 offset:144
s_mul_i32 s74, s74, 331776
v_mfma_f32_16x16x32_bf16 v[32:35], a[160:163], v[112:115], v[32:35]
ds_read_b64_tr_b16 a[230:231], v196 offset:7056
s_add_u32 s75, s75, s74
v_mfma_f32_16x16x32_bf16 v[52:55], a[164:167], v[112:115], v[52:55]
ds_read_b64_tr_b16 a[232:233], v196 offset:288
s_add_u32 s75, s75, 768
v_mfma_f32_16x16x32_bf16 v[72:75], v[112:115], a[168:171], v[72:75]
ds_read_b64_tr_b16 a[234:235], v196 offset:7200
s_mul_i32 s74, s48, 27
v_mfma_f32_16x16x32_bf16 v[92:95], a[172:175], v[112:115], v[92:95]
ds_read_b64_tr_b16 a[236:237], v197 offset:0
s_add_u32 s74, s74, 0
v_mfma_f32_16x16x32_bf16 v[36:39], a[160:163], v[116:119], v[36:39]
ds_read_b64_tr_b16 a[238:239], v197 offset:6912
v_add_u32 v220, s74, v1
v_mfma_f32_16x16x32_bf16 v[56:59], a[164:167], v[116:119], v[56:59]
ds_read_b64_tr_b16 a[240:241], v196 offset:13824
v_cmp_gt_u32 vcc, 27, v1
v_mfma_f32_16x16x32_bf16 v[76:79], v[116:119], a[168:171], v[76:79]
ds_read_b64_tr_b16 a[242:243], v196 offset:20736
v_mul_u32_u24 v221, 21846, v220
v_mfma_f32_16x16x32_bf16 v[96:99], a[172:175], v[116:119], v[96:99]
ds_read_b64_tr_b16 a[244:245], v196 offset:13968
v_lshrrev_b32 v221, 16, v221
v_mfma_f32_16x16x32_bf16 v[40:43], a[160:163], v[120:123], v[40:43]
ds_read_b64_tr_b16 a[246:247], v196 offset:20880
v_mul_u32_u24 v221, 8832, v221
v_mfma_f32_16x16x32_bf16 v[60:63], a[164:167], v[120:123], v[60:63]
ds_read_b64_tr_b16 a[248:249], v196 offset:14112
v_lshl_add_u32 v220, v220, 7, v221
v_mfma_f32_16x16x32_bf16 v[80:83], v[120:123], a[168:171], v[80:83]
ds_read_b64_tr_b16 a[250:251], v196 offset:21024
v_bfrev_b32 v222, -2
v_mfma_f32_16x16x32_bf16 v[100:103], a[172:175], v[120:123], v[100:103]
ds_read_b64_tr_b16 a[252:253], v197 offset:13824
v_cndmask_b32 v220, v222, v220, vcc
v_mfma_f32_16x16x32_bf16 v[44:47], a[160:163], v[124:127], v[44:47]
ds_read_b64_tr_b16 a[254:255], v197 offset:20736
ds_read_b128 v[128:131], v215 offset:7168
v_mfma_f32_16x16x32_bf16 v[64:67], a[164:167], v[124:127], v[64:67]
ds_read_b128 v[132:135], v215 offset:25600
buffer_load_dword v217, v220, s[20:23], s75 offen
v_mfma_f32_16x16x32_bf16 v[84:87], v[124:127], a[168:171], v[84:87]
ds_read_b128 v[136:139], v215 offset:44032
ds_read_b128 v[140:143], v214 offset:7168
v_mfma_f32_16x16x32_bf16 v[104:107], a[172:175], v[124:127], v[104:107]
ds_read_b128 v[144:147], v214 offset:25600
s_waitcnt lgkmcnt(0)
v_mfma_f32_16x16x32_bf16 v[48:51], a[180:183], v[128:131], v[48:51]
ds_read_b64_tr_b16 v[224:225], v196 offset:27648
v_mfma_f32_16x16x32_bf16 v[68:71], v[128:131], a[184:187], v[68:71]
ds_read_b64_tr_b16 v[226:227], v196 offset:34560
v_mfma_f32_16x16x32_bf16 v[88:91], a[188:191], v[128:131], v[88:91]
ds_read_b64_tr_b16 v[228:229], v196 offset:27792
v_mfma_f32_16x16x32_bf16 v[32:35], a[176:179], v[132:135], v[32:35]
ds_read_b64_tr_b16 v[230:231], v196 offset:34704
v_mfma_f32_16x16x32_bf16 v[52:55], a[180:183], v[132:135], v[52:55]
ds_read_b64_tr_b16 v[232:233], v196 offset:27936
v_mfma_f32_16x16x32_bf16 v[72:75], v[132:135], a[184:187], v[72:75]
ds_read_b64_tr_b16 v[234:235], v196 offset:34848
v_mfma_f32_16x16x32_bf16 v[92:95], a[188:191], v[132:135], v[92:95]
ds_read_b64_tr_b16 v[236:237], v197 offset:27648
v_mfma_f32_16x16x32_bf16 v[36:39], a[176:179], v[136:139], v[36:39]
ds_read_b64_tr_b16 v[238:239], v197 offset:34560
v_mfma_f32_16x16x32_bf16 v[56:59], a[180:183], v[136:139], v[56:59]
ds_read_b64_tr_b16 v[240:241], v196 offset:41472
v_mfma_f32_16x16x32_bf16 v[76:79], v[136:139], a[184:187], v[76:79]
ds_read_b64_tr_b16 v[242:243], v196 offset:48384
v_mfma_f32_16x16x32_bf16 v[96:99], a[188:191], v[136:139], v[96:99]
ds_read_b64_tr_b16 v[244:245], v196 offset:41616
v_mfma_f32_16x16x32_bf16 v[40:43], a[176:179], v[140:143], v[40:43]
ds_read_b64_tr_b16 v[246:247], v196 offset:48528
v_mfma_f32_16x16x32_bf16 v[60:63], a[180:183], v[140:143], v[60:63]
ds_read_b64_tr_b16 v[248:249], v196 offset:41760
v_mfma_f32_16x16x32_bf16 v[80:83], v[140:143], a[184:187], v[80:83]
ds_read_b64_tr_b16 v[250:251], v196 offset:48672
v_mfma_f32_16x16x32_bf16 v[100:103], a[188:191], v[140:143], v[100:103]
ds_read_b64_tr_b16 v[252:253], v197 offset:41472
ds_read_b64_tr_b16 v[254:255], v197 offset:48384
v_mfma_f32_16x16x32_bf16 v[44:47], a[176:179], v[144:147], v[44:47]
ds_read_b128 v[108:111], v215 offset:10240
ds_read_b128 v[112:115], v215 offset:28672
v_mfma_f32_16x16x32_bf16 v[64:67], a[180:183], v[144:147], v[64:67]
ds_read_b128 v[116:119], v215 offset:47104
ds_read_b128 v[120:123], v214 offset:10240
v_mfma_f32_16x16x32_bf16 v[84:87], v[144:147], a[184:187], v[84:87]
ds_read_b128 v[124:127], v214 offset:28672
v_mfma_f32_16x16x32_bf16 v[104:107], a[188:191], v[144:147], v[104:107]
s_waitcnt lgkmcnt(0)
s_barrier
v_mfma_f32_16x16x32_bf16 v[48:51], a[196:199], v[108:111], v[48:51]
ds_read_b128 v[128:131], v215 offset:11264
s_add_u32 m0, s3, 92160
v_mfma_f32_16x16x32_bf16 v[68:71], v[108:111], a[200:203], v[68:71]
ds_read_b128 v[132:135], v215 offset:29696
s_add_u32 s76, s62, 0
v_mfma_f32_16x16x32_bf16 v[88:91], a[204:207], v[108:111], v[88:91]
ds_read_b128 v[136:139], v215 offset:48128
s_mov_b32 exec_hi, 15
v_mfma_f32_16x16x32_bf16 v[32:35], a[192:195], v[112:115], v[32:35]
buffer_load_dwordx4 v11, s[16:19], s76 offen lds
buffer_load_dwordx4 v210, s[16:19], s76 offen offset:576 lds
v_mfma_f32_16x16x32_bf16 v[52:55], a[196:199], v[112:115], v[52:55]
s_mov_b32 exec_hi, -1
ds_read_b128 v[140:143], v214 offset:11264
v_mfma_f32_16x16x32_bf16 v[72:75], v[112:115], a[200:203], v[72:75]
ds_read_b128 v[144:147], v214 offset:29696
v_mfma_f32_16x16x32_bf16 v[92:95], a[204:207], v[112:115], v[92:95]
v_mfma_f32_16x16x32_bf16 v[36:39], a[192:195], v[116:119], v[36:39]
v_mfma_f32_16x16x32_bf16 v[56:59], a[196:199], v[116:119], v[56:59]
v_mfma_f32_16x16x32_bf16 v[76:79], v[116:119], a[200:203], v[76:79]
s_add_u32 m0, s3, 96768
s_add_u32 s76, s62, 41472
v_mfma_f32_16x16x32_bf16 v[96:99], a[204:207], v[116:119], v[96:99]
s_mov_b32 exec_hi, 15
buffer_load_dwordx4 v11, s[16:19], s76 offen lds
v_mfma_f32_16x16x32_bf16 v[40:43], a[192:195], v[120:123], v[40:43]
buffer_load_dwordx4 v210, s[16:19], s76 offen offset:576 lds
s_mov_b32 exec_hi, -1
v_mfma_f32_16x16x32_bf16 v[60:63], a[196:199], v[120:123], v[60:63]
v_mfma_f32_16x16x32_bf16 v[80:83], v[120:123], a[200:203], v[80:83]
v_mfma_f32_16x16x32_bf16 v[100:103], a[204:207], v[120:123], v[100:103]
v_mfma_f32_16x16x32_bf16 v[44:47], a[192:195], v[124:127], v[44:47]
v_mfma_f32_16x16x32_bf16 v[64:67], a[196:199], v[124:127], v[64:67]
v_mfma_f32_16x16x32_bf16 v[84:87], v[124:127], a[200:203], v[84:87]
v_mfma_f32_16x16x32_bf16 v[104:107], a[204:207], v[124:127], v[104:107]
s_waitcnt lgkmcnt(0)
v_mfma_f32_16x16x32_bf16 v[48:51], a[212:215], v[128:131], v[48:51]
ds_read_b128 v[108:111], v215 offset:14336
s_add_u32 m0, s3, 101376
v_mfma_f32_16x16x32_bf16 v[68:71], v[128:131], a[216:219], v[68:71]
ds_read_b128 v[112:115], v215 offset:32768
s_add_u32 s76, s62, 82944
v_mfma_f32_16x16x32_bf16 v[88:91], a[220:223], v[128:131], v[88:91]
ds_read_b128 v[116:119], v215 offset:51200
s_mov_b32 exec_hi, 15
v_mfma_f32_16x16x32_bf16 v[32:35], a[208:211], v[132:135], v[32:35]
buffer_load_dwordx4 v11, s[16:19], s76 offen lds
buffer_load_dwordx4 v210, s[16:19], s76 offen offset:576 lds
v_mfma_f32_16x16x32_bf16 v[52:55], a[212:215], v[132:135], v[52:55]
s_mov_b32 exec_hi, -1
ds_read_b128 v[120:123], v214 offset:14336
v_mfma_f32_16x16x32_bf16 v[72:75], v[132:135], a[216:219], v[72:75]
ds_read_b128 v[124:127], v214 offset:32768
v_mfma_f32_16x16x32_bf16 v[92:95], a[220:223], v[132:135], v[92:95]
v_mfma_f32_16x16x32_bf16 v[36:39], a[208:211], v[136:139], v[36:39]
v_mfma_f32_16x16x32_bf16 v[56:59], a[212:215], v[136:139], v[56:59]
v_mfma_f32_16x16x32_bf16 v[76:79], v[136:139], a[216:219], v[76:79]
s_add_u32 m0, s3, 105984
s_add_u32 s76, s62, 124416
v_mfma_f32_16x16x32_bf16 v[96:99], a[220:223], v[136:139], v[96:99]
s_mov_b32 exec_hi, 15
buffer_load_dwordx4 v11, s[16:19], s76 offen lds
v_mfma_f32_16x16x32_bf16 v[40:43], a[208:211], v[140:143], v[40:43]
buffer_load_dwordx4 v210, s[16:19], s76 offen offset:576 lds
s_mov_b32 exec_hi, -1
v_mfma_f32_16x16x32_bf16 v[60:63], a[212:215], v[140:143], v[60:63]
v_mfma_f32_16x16x32_bf16 v[80:83], v[140:143], a[216:219], v[80:83]
v_mfma_f32_16x16x32_bf16 v[100:103], a[220:223], v[140:143], v[100:103]
v_mfma_f32_16x16x32_bf16 v[44:47], a[208:211], v[144:147], v[44:47]
v_mfma_f32_16x16x32_bf16 v[64:67], a[212:215], v[144:147], v[64:67]
v_mfma_f32_16x16x32_bf16 v[84:87], v[144:147], a[216:219], v[84:87]
v_mfma_f32_16x16x32_bf16 v[104:107], a[220:223], v[144:147], v[104:107]
s_waitcnt lgkmcnt(0)
v_mfma_f32_16x16x32_bf16 v[48:51], a[228:231], v[108:111], v[48:51]
ds_read_b128 v[128:131], v215 offset:15360
s_add_u32 m0, s3, 110592
v_mfma_f32_16x16x32_bf16 v[68:71], v[108:111], a[232:235], v[68:71]
ds_read_b128 v[132:135], v215 offset:33792
s_add_u32 s76, s62, 165888
v_mfma_f32_16x16x32_bf16 v[88:91], a[236:239], v[108:111], v[88:91]
ds_read_b128 v[136:139], v215 offset:52224
s_mov_b32 exec_hi, 15
v_mfma_f32_16x16x32_bf16 v[32:35], a[224:227], v[112:115], v[32:35]
buffer_load_dwordx4 v11, s[16:19], s76 offen lds
buffer_load_dwordx4 v210, s[16:19], s76 offen offset:576 lds
v_mfma_f32_16x16x32_bf16 v[52:55], a[228:231], v[112:115], v[52:55]
s_mov_b32 exec_hi, -1
ds_read_b128 v[140:143], v214 offset:15360
v_mfma_f32_16x16x32_bf16 v[72:75], v[112:115], a[232:235], v[72:75]
ds_read_b128 v[144:147], v214 offset:33792
v_mfma_f32_16x16x32_bf16 v[92:95], a[236:239], v[112:115], v[92:95]
v_mfma_f32_16x16x32_bf16 v[36:39], a[224:227], v[116:119], v[36:39]
v_mfma_f32_16x16x32_bf16 v[56:59], a[228:231], v[116:119], v[56:59]
v_mfma_f32_16x16x32_bf16 v[76:79], v[116:119], a[232:235], v[76:79]
s_add_u32 m0, s3, 115200
s_add_u32 s76, s62, 207360
v_mfma_f32_16x16x32_bf16 v[96:99], a[236:239], v[116:119], v[96:99]
s_mov_b32 exec_hi, 15
buffer_load_dwordx4 v11, s[16:19], s76 offen lds
v_mfma_f32_16x16x32_bf16 v[40:43], a[224:227], v[120:123], v[40:43]
buffer_load_dwordx4 v210, s[16:19], s76 offen offset:576 lds
s_mov_b32 exec_hi, -1
v_mfma_f32_16x16x32_bf16 v[60:63], a[228:231], v[120:123], v[60:63]
v_mfma_f32_16x16x32_bf16 v[80:83], v[120:123], a[232:235], v[80:83]
v_mfma_f32_16x16x32_bf16 v[100:103], a[236:239], v[120:123], v[100:103]
v_mfma_f32_16x16x32_bf16 v[44:47], a[224:227], v[124:127], v[44:47]
v_mfma_f32_16x16x32_bf16 v[64:67], a[228:231], v[124:127], v[64:67]
v_mfma_f32_16x16x32_bf16 v[84:87], v[124:127], a[232:235], v[84:87]
v_mfma_f32_16x16x32_bf16 v[104:107], a[236:239], v[124:127], v[104:107]
s_waitcnt lgkmcnt(0)
v_mfma_f32_16x16x32_bf16 v[48:51], a[244:247], v[128:131], v[48:51]
ds_read_b128 v[108:111], v215 offset:16384
s_add_u32 m0, s3, 119808
v_mfma_f32_16x16x32_bf16 v[68:71], v[128:131], a[248:251], v[68:71]
ds_read_b128 v[112:115], v215 offset:34816
s_add_u32 s76, s62, 248832
v_mfma_f32_16x16x32_bf16 v[88:91], a[252:255], v[128:131], v[88:91]
ds_read_b128 v[116:119], v215 offset:53248
s_mov_b32 exec_hi, 15
v_mfma_f32_16x16x32_bf16 v[32:35], a[240:243], v[132:135], v[32:35]
buffer_load_dwordx4 v11, s[16:19], s76 offen lds
buffer_load_dwordx4 v210, s[16:19], s76 offen offset:576 lds
v_mfma_f32_16x16x32_bf16 v[52:55], a[244:247], v[132:135], v[52:55]
s_mov_b32 exec_hi, -1
ds_read_b128 v[120:123], v214 offset:16384
v_mfma_f32_16x16x32_bf16 v[72:75], v[132:135], a[248:251], v[72:75]
ds_read_b128 v[124:127], v214 offset:34816
v_mfma_f32_16x16x32_bf16 v[92:95], a[252:255], v[132:135], v[92:95]
v_mfma_f32_16x16x32_bf16 v[36:39], a[240:243], v[136:139], v[36:39]
v_mfma_f32_16x16x32_bf16 v[56:59], a[244:247], v[136:139], v[56:59]
v_mfma_f32_16x16x32_bf16 v[76:79], v[136:139], a[248:251], v[76:79]
s_add_u32 m0, s3, 124416
s_add_u32 s76, s62, 290304
v_mfma_f32_16x16x32_bf16 v[96:99], a[252:255], v[136:139], v[96:99]
s_mov_b32 exec_hi, 15
buffer_load_dwordx4 v11, s[16:19], s76 offen lds
v_mfma_f32_16x16x32_bf16 v[40:43], a[240:243], v[140:143], v[40:43]
buffer_load_dwordx4 v210, s[16:19], s76 offen offset:576 lds
s_mov_b32 exec_hi, -1
v_mfma_f32_16x16x32_bf16 v[60:63], a[244:247], v[140:143], v[60:63]
v_mfma_f32_16x16x32_bf16 v[80:83], v[140:143], a[248:251], v[80:83]
v_mfma_f32_16x16x32_bf16 v[100:103], a[252:255], v[140:143], v[100:103]
v_mfma_f32_16x16x32_bf16 v[44:47], a[240:243], v[144:147], v[44:47]
v_mfma_f32_16x16x32_bf16 v[64:67], a[244:247], v[144:147], v[64:67]
v_mfma_f32_16x16x32_bf16 v[84:87], v[144:147], a[248:251], v[84:87]
v_mfma_f32_16x16x32_bf16 v[104:107], a[252:255], v[144:147], v[104:107]
s_waitcnt lgkmcnt(0)
v_mfma_f32_16x16x32_bf16 v[48:51], v[228:231], v[108:111], v[48:51]
ds_read_b128 v[128:131], v215 offset:17408
s_add_u32 m0, s3, 129024
v_mfma_f32_16x16x32_bf16 v[68:71], v[108:111], v[232:235], v[68:71]
ds_read_b128 v[132:135], v215 offset:35840
s_add_u32 s76, s62, 331776
v_mfma_f32_16x16x32_bf16 v[88:91], v[236:239], v[108:111], v[88:91]
ds_read_b128 v[136:139], v215 offset:54272
s_mov_b32 exec_hi, 15
v_mfma_f32_16x16x32_bf16 v[32:35], v[224:227], v[112:115], v[32:35]
buffer_load_dwordx4 v11, s[16:19], s76 offen lds
buffer_load_dwordx4 v210, s[16:19], s76 offen offset:576 lds
v_mfma_f32_16x16x32_bf16 v[52:55], v[228:231], v[112:115], v[52:55]
s_mov_b32 exec_hi, -1
ds_read_b128 v[140:143], v214 offset:17408
v_mfma_f32_16x16x32_bf16 v[72:75], v[112:115], v[232:235], v[72:75]
ds_read_b128 v[144:147], v214 offset:35840
v_mfma_f32_16x16x32_bf16 v[92:95], v[236:239], v[112:115], v[92:95]
v_mfma_f32_16x16x32_bf16 v[36:39], v[224:227], v[116:119], v[36:39]
v_mfma_f32_16x16x32_bf16 v[56:59], v[228:231], v[116:119], v[56:59]
v_mfma_f32_16x16x32_bf16 v[76:79], v[116:119], v[232:235], v[76:79]
s_add_u32 m0, s3, 133632
s_add_u32 s76, s62, 373248
v_mfma_f32_16x16x32_bf16 v[96:99], v[236:239], v[116:119], v[96:99]
s_mov_b32 exec_hi, 15
buffer_load_dwordx4 v11, s[16:19], s76 offen lds
v_mfma_f32_16x16x32_bf16 v[40:43], v[224:227], v[120:123], v[40:43]
buffer_load_dwordx4 v210, s[16:19], s76 offen offset:576 lds
s_mov_b32 exec_hi, -1
v_mfma_f32_16x16x32_bf16 v[60:63], v[228:231], v[120:123], v[60:63]
v_mfma_f32_16x16x32_bf16 v[80:83], v[120:123], v[232:235], v[80:83]
v_mfma_f32_16x16x32_bf16 v[100:103], v[236:239], v[120:123], v[100:103]
v_mfma_f32_16x16x32_bf16 v[44:47], v[224:227], v[124:127], v[44:47]
v_mfma_f32_16x16x32_bf16 v[64:67], v[228:231], v[124:127], v[64:67]
v_mfma_f32_16x16x32_bf16 v[84:87], v[124:127], v[232:235], v[84:87]
v_mfma_f32_16x16x32_bf16 v[104:107], v[236:239], v[124:127], v[104:107]
s_waitcnt lgkmcnt(0)
v_mfma_f32_16x16x32_bf16 v[48:51], v[244:247], v[128:131], v[48:51]
s_mov_b64 exec, 1
buffer_load_dword v213, v9, s[44:47], 0 offen sc1
v_mfma_f32_16x16x32_bf16 v[68:71], v[128:131], v[248:251], v[68:71]
s_mov_b64 exec, -1
v_mfma_f32_16x16x32_bf16 v[88:91], v[252:255], v[128:131], v[88:91]
v_mfma_f32_16x16x32_bf16 v[32:35], v[240:243], v[132:135], v[32:35]
v_mfma_f32_16x16x32_bf16 v[52:55], v[244:247], v[132:135], v[52:55]
v_mfma_f32_16x16x32_bf16 v[72:75], v[132:135], v[248:251], v[72:75]
v_mfma_f32_16x16x32_bf16 v[92:95], v[252:255], v[132:135], v[92:95]
s_add_u32 m0, s3, 138240
s_add_u32 s76, s62, 414720
v_mfma_f32_16x16x32_bf16 v[36:39], v[240:243], v[136:139], v[36:39]
s_mov_b32 exec_hi, 15
buffer_load_dwordx4 v11, s[16:19], s76 offen lds
v_mfma_f32_16x16x32_bf16 v[56:59], v[244:247], v[136:139], v[56:59]
buffer_load_dwordx4 v210, s[16:19], s76 offen offset:576 lds
s_mov_b32 exec_hi, -1
v_mfma_f32_16x16x32_bf16 v[76:79], v[136:139], v[248:251], v[76:79]
v_mfma_f32_16x16x32_bf16 v[96:99], v[252:255], v[136:139], v[96:99]
v_mfma_f32_16x16x32_bf16 v[40:43], v[240:243], v[140:143], v[40:43]
v_mfma_f32_16x16x32_bf16 v[60:63], v[244:247], v[140:143], v[60:63]
s_add_u32 m0, s3, 142848
s_add_u32 s76, s62, 456192
v_mfma_f32_16x16x32_bf16 v[80:83], v[140:143], v[248:251], v[80:83]
s_mov_b32 exec_hi, 15
buffer_load_dwordx4 v11, s[16:19], s76 offen lds
v_mfma_f32_16x16x32_bf16 v[100:103], v[252:255], v[140:143], v[100:103]
buffer_load_dwordx4 v210, s[16:19], s76 offen offset:576 lds
s_mov_b32 exec_hi, -1
v_mfma_f32_16x16x32_bf16 v[44:47], v[240:243], v[144:147], v[44:47]
v_mfma_f32_16x16x32_bf16 v[64:67], v[244:247], v[144:147], v[64:67]
v_mfma_f32_16x16x32_bf16 v[84:87], v[144:147], v[248:251], v[84:87]
v_mfma_f32_16x16x32_bf16 v[104:107], v[252:255], v[144:147], v[104:107]
s_barrier
v_cvt_pk_bf16_f32 v88, v88, v89
s_add_u32 m0, s3, 16384
s_add_u32 s76, s62, 497664
s_mov_b32 exec_hi, 15
buffer_load_dwordx4 v11, s[16:19], s76 offen lds
buffer_load_dwordx4 v210, s[16:19], s76 offen offset:576 lds
s_mov_b32 exec_hi, -1
v_cvt_pk_bf16_f32 v89, v90, v91
v_cndmask_b32 v88, v88, v89, s[70:71]
v_cvt_pk_bf16_f32 v92, v92, v93
v_cvt_pk_bf16_f32 v93, v94, v95
v_cndmask_b32 v92, v92, v93, s[70:71]
v_cvt_pk_bf16_f32 v96, v96, v97
v_cvt_pk_bf16_f32 v97, v98, v99
v_cndmask_b32 v96, v96, v97, s[70:71]
v_cvt_pk_bf16_f32 v100, v100, v101
v_cvt_pk_bf16_f32 v101, v102, v103
v_cndmask_b32 v100, v100, v101, s[70:71]
v_cvt_pk_bf16_f32 v104, v104, v105
v_cvt_pk_bf16_f32 v105, v106, v107
v_cndmask_b32 v104, v104, v105, s[70:71]
s_mov_b32 exec_lo, 0
s_mov_b32 exec_hi, 0xffff
ds_write_b16 v19, v88 offset:0
ds_write_b16_d16_hi v19, v88 offset:160
ds_write_b16 v19, v92 offset:32
ds_write_b16_d16_hi v19, v92 offset:192
ds_write_b16 v19, v96 offset:64
ds_write_b16_d16_hi v19, v96 offset:224
ds_write_b16 v19, v100 offset:96
ds_write_b16_d16_hi v19, v100 offset:256
ds_write_b16 v19, v104 offset:128
ds_write_b16_d16_hi v19, v104 offset:288
s_mov_b64 exec, -1
s_add_u32 m0, s3, 20992
s_add_u32 s76, s62, 539136
s_mov_b32 exec_hi, 15
buffer_load_dwordx4 v11, s[16:19], s76 offen lds
buffer_load_dwordx4 v210, s[16:19], s76 offen offset:576 lds
s_mov_b32 exec_hi, -1
ds_read_b64 v[158:159], v20 offset:0
ds_read_b64 v[160:161], v20 offset:32
ds_read_b64 v[162:163], v20 offset:64
ds_read_b64 v[164:165], v20 offset:96
s_add_u32 m0, s3, 25600
s_add_u32 s76, s62, 580608
s_mov_b32 exec_hi, 15
buffer_load_dwordx4 v11, s[16:19], s76 offen lds
buffer_load_dwordx4 v210, s[16:19], s76 offen offset:576 lds
s_mov_b32 exec_hi, -1
ds_read_b64 v[166:167], v20 offset:128
v_cvt_pk_bf16_f32 v48, v48, v49
v_cvt_pk_bf16_f32 v49, v50, v51
v_cndmask_b32 v50, 0, v88, s[68:69]
v_mov_b32 v51, 0
v_cvt_pk_bf16_f32 v52, v52, v53
v_cvt_pk_bf16_f32 v53, v54, v55
v_cndmask_b32 v54, 0, v92, s[68:69]
v_mov_b32 v55, 0
v_cvt_pk_bf16_f32 v56, v56, v57
v_cvt_pk_bf16_f32 v57, v58, v59
v_cndmask_b32 v58, 0, v96, s[68:69]
v_mov_b32 v59, 0
v_cvt_pk_bf16_f32 v60, v60, v61
v_cvt_pk_bf16_f32 v61, v62, v63
v_cndmask_b32 v62, 0, v100, s[68:69]
s_add_u32 m0, s3, 30208
s_add_u32 s76, s62, 622080
s_mov_b32 exec_hi, 15
buffer_load_dwordx4 v11, s[16:19], s76 offen lds
buffer_load_dwordx4 v210, s[16:19], s76 offen offset:576 lds
s_mov_b32 exec_hi, -1
v_mov_b32 v63, 0
v_cvt_pk_bf16_f32 v64, v64, v65
v_cvt_pk_bf16_f32 v65, v66, v67
v_cndmask_b32 v66, 0, v104, s[68:69]
v_mov_b32 v67, 0
v_cvt_pk_bf16_f32 v32, v32, v33
v_cvt_pk_bf16_f32 v33, v34, v35
v_mov_b32 v34, 0
v_mov_b32 v35, 0
v_cvt_pk_bf16_f32 v36, v36, v37
v_cvt_pk_bf16_f32 v37, v38, v39
v_mov_b32 v38, 0
v_mov_b32 v39, 0
v_cvt_pk_bf16_f32 v40, v40, v41
v_cvt_pk_bf16_f32 v41, v42, v43
s_add_u32 m0, s3, 34816
s_add_u32 s76, s63, 0
s_mov_b32 exec_hi, 15
buffer_load_dwordx4 v212, s[16:19], s76 offen lds
buffer_load_dwordx4 v211, s[16:19], s76 offen offset:576 lds
s_mov_b32 exec_hi, -1
v_mov_b32 v42, 0
v_mov_b32 v43, 0
v_cvt_pk_bf16_f32 v44, v44, v45
v_cvt_pk_bf16_f32 v45, v46, v47
v_mov_b32 v46, 0
v_mov_b32 v47, 0
s_waitcnt lgkmcnt(0)
v_permlane16_swap_b32 v34, v92
v_permlane16_swap_b32 v38, v96
v_permlane16_swap_b32 v42, v100
v_permlane16_swap_b32 v46, v104
v_mfma_f32_16x16x32_bf16 v[168:171], v[48:51], v[32:35], 0
v_cvt_pk_bf16_f32 v148, v68, v69
v_cvt_pk_bf16_f32 v149, v70, v71
v_mfma_f32_16x16x32_bf16 v[172:175], v[52:55], v[32:35], 0
v_cvt_pk_bf16_f32 v150, v72, v73
s_add_u32 m0, s3, 39424
s_add_u32 s76, s63, 331776
s_mov_b32 exec_hi, 15
buffer_load_dwordx4 v212, s[16:19], s76 offen lds
buffer_load_dwordx4 v211, s[16:19], s76 offen offset:576 lds
s_mov_b32 exec_hi, -1
v_cvt_pk_bf16_f32 v151, v74, v75
v_mfma_f32_16x16x32_bf16 v[176:179], v[52:55], v[36:39], 0
v_cvt_pk_bf16_f32 v152, v76, v77
v_cvt_pk_bf16_f32 v153, v78, v79
v_mfma_f32_16x16x32_bf16 v[180:183], v[56:59], v[36:39], 0
v_cvt_pk_bf16_f32 v154, v80, v81
v_cvt_pk_bf16_f32 v155, v82, v83
v_mfma_f32_16x16x32_bf16 v[184:187], v[56:59], v[40:43], 0
v_cvt_pk_bf16_f32 v156, v84, v85
v_cvt_pk_bf16_f32 v157, v86, v87
v_mfma_f32_16x16x32_bf16 v[188:191], v[60:63], v[40:43], 0
v_mov_b32 v4, 0xf149f2ca
s_mov_b32 s53, 0x3eae1a93
v_mfma_f32_16x16x32_bf16 v[192:195], v[60:63], v[44:47], 0
v_mfma_f32_16x16x32_bf16 v[196:199], v[64:67], v[44:47], 0
s_mov_b32 exec_lo, 0x1
s_mov_b32 exec_hi, 0x0
s_waitcnt vmcnt(16)
v_cmp_ne_u32 vcc, v21, v213
s_nop 4
s_cbranch_vccz L_poll4d
s_mov_b32 s77, 0x20000
L_poll4:
buffer_load_dword v213, v9, s[44:47], 0 offen sc1
s_waitcnt vmcnt(0)
v_cmp_ne_u32 vcc, v21, v213
s_nop 4
s_cbranch_vccz L_poll4d
s_sub_u32 s77, s77, 1
s_cmp_lg_u32 s77, 0
s_cbranch_scc1 L_poll4
L_poll4d:
s_mov_b64 exec, -1
s_lshl_b32 s76, s48, 11
s_add_u32 m0, s76, 152064
s_add_u32 s76, s76, 987648
buffer_load_dwordx4 v9, s[44:47], s76 offen sc1 lds
buffer_load_dwordx4 v9, s[44:47], s76 offen offset:1024 sc1 lds
s_lshl_b32 s76, s48, 8
s_add_u32 m0, s76, 160256
s_add_u32 s76, s76, 995840
s_mov_b32 exec_lo, 0xffff
s_mov_b32 exec_hi, 0x0
buffer_load_dwordx4 v9, s[44:47], s76 offen sc1 lds
s_mov_b64 exec, -1
v_cndmask_b32 v168, v168, v169, s[56:57]
v_cndmask_b32 v170, v170, v171, s[56:57]
v_cndmask_b32 v172, v172, v173, s[56:57]
v_cndmask_b32 v174, v174, v175, s[56:57]
v_cndmask_b32 v176, v176, v177, s[56:57]
v_cndmask_b32 v178, v178, v179, s[56:57]
v_cndmask_b32 v180, v180, v181, s[56:57]
v_cndmask_b32 v182, v182, v183, s[56:57]
v_cndmask_b32 v184, v184, v185, s[56:57]
v_cndmask_b32 v186, v186, v187, s[56:57]
v_cndmask_b32 v188, v188, v189, s[56:57]
v_cndmask_b32 v190, v190, v191, s[56:57]
v_cndmask_b32 v192, v192, v193, s[56:57]
v_cndmask_b32 v194, v194, v195, s[56:57]
v_cndmask_b32 v196, v196, v197, s[56:57]
v_cndmask_b32 v198, v198, v199, s[56:57]
v_cndmask_b32 v168, v168, v4, s[72:73]
v_cndmask_b32 v170, v170, v4, s[72:73]
v_cndmask_b32 v172, v168, v172, s[64:65]
v_cndmask_b32 v174, v170, v174, s[66:67]
v_cndmask_b32 v180, v176, v180, s[64:65]
v_cndmask_b32 v182, v178, v182, s[66:67]
v_cndmask_b32 v188, v184, v188, s[64:65]
v_cndmask_b32 v190, v186, v190, s[66:67]
v_cndmask_b32 v196, v192, v196, s[64:65]
v_cndmask_b32 v198, v194, v198, s[66:67]
v_max_f32 v168, v172, v174
v_max_f32 v176, v180, v182
v_max_f32 v184, v188, v190
v_max_f32 v192, v196, v198
v_mov_b32 v169, v168
v_mov_b32 v177, v176
v_mov_b32 v185, v184
v_mov_b32 v193, v192
v_permlane16_swap_b32 v169, v168
v_permlane16_swap_b32 v177, v176
v_permlane16_swap_b32 v185, v184
v_permlane16_swap_b32 v193, v192
v_max_f32 v168, v168, v169
v_max_f32 v176, v176, v177
v_max_f32 v184, v184, v185
v_max_f32 v192, v192, v193
v_mov_b32 v169, v168
v_mov_b32 v177, v176
v_mov_b32 v185, v184
v_mov_b32 v193, v192
v_permlane32_swap_b32 v169, v168
v_permlane32_swap_b32 v177, v176
v_permlane32_swap_b32 v185, v184
v_permlane32_swap_b32 v193, v192
v_max_f32 v168, v168, v169
v_max_f32 v176, v176, v177
v_max_f32 v184, v184, v185
v_max_f32 v192, v192, v193
v_sub_f32 v172, v172, v168
v_sub_f32 v174, v174, v168
v_sub_f32 v180, v180, v176
v_sub_f32 v182, v182, v176
v_sub_f32 v188, v188, v184
v_sub_f32 v190, v190, v184
v_sub_f32 v196, v196, v192
v_sub_f32 v198, v198, v192
v_mul_f32 v172, s53, v172
v_mul_f32 v174, s53, v174
v_mul_f32 v180, s53, v180
v_mul_f32 v182, s53, v182
v_mul_f32 v188, s53, v188
v_mul_f32 v190, s53, v190
v_mul_f32 v196, s53, v196
v_mul_f32 v198, s53, v198
v_exp_f32 v172, v172
v_exp_f32 v174, v174
v_exp_f32 v180, v180
v_exp_f32 v182, v182
v_exp_f32 v188, v188
v_exp_f32 v190, v190
v_exp_f32 v196, v196
v_exp_f32 v198, v198
v_cvt_pk_bf16_f32 v172, v172, v172
v_cvt_pk_bf16_f32 v174, v174, v174
v_cvt_pk_bf16_f32 v180, v180, v180
v_cvt_pk_bf16_f32 v182, v182, v182
v_cvt_pk_bf16_f32 v188, v188, v188
v_cvt_pk_bf16_f32 v190, v190, v190
v_cvt_pk_bf16_f32 v196, v196, v196
v_cvt_pk_bf16_f32 v198, v198, v198
v_and_b32 v168, v12, v172
v_and_b32 v169, v13, v174
v_and_b32 v170, v14, v172
v_and_b32 v171, v209, v174
v_and_b32 v176, v12, v180
v_and_b32 v177, v13, v182
v_and_b32 v178, v14, v180
v_and_b32 v179, v209, v182
v_and_b32 v184, v12, v188
v_and_b32 v185, v13, v190
v_and_b32 v186, v14, v188
v_and_b32 v187, v209, v190
v_and_b32 v192, v12, v196
v_and_b32 v193, v13, v198
v_and_b32 v194, v14, v196
v_and_b32 v195, v209, v198
v_mfma_f32_16x16x32_bf16 v[52:55], v[158:161], v[168:171], 0
v_mfma_f32_16x16x32_bf16 v[32:35], v[148:151], v[168:171], 0
v_mfma_f32_16x16x32_bf16 v[56:59], v[160:163], v[176:179], 0
v_mfma_f32_16x16x32_bf16 v[36:39], v[150:153], v[176:179], 0
v_mfma_f32_16x16x32_bf16 v[60:63], v[162:165], v[184:187], 0
v_mfma_f32_16x16x32_bf16 v[40:43], v[152:155], v[184:187], 0
v_mfma_f32_16x16x32_bf16 v[64:67], v[164:167], v[192:195], 0
v_mfma_f32_16x16x32_bf16 v[44:47], v[154:157], v[192:195], 0
s_lshr_b32 s53, s48, 1
s_lshl_b32 s53, s53, 10
s_and_b32 s54, s48, 1
s_lshl_b32 s54, s54, 3
s_add_u32 s53, s53, s54
v_add_u32 v2, s53, v9
s_lshl_b32 s53, s48, 2
v_add_u32 v3, s53, v9
v_rcp_f32 v54, v54
v_rcp_f32 v58, v58
v_rcp_f32 v62, v62
v_rcp_f32 v66, v66
v_pk_mul_f32 v[32:33], v[32:33], v[54:55] op_sel_hi:[1,0]
v_pk_mul_f32 v[34:35], v[34:35], v[54:55] op_sel_hi:[1,0]
v_pk_mul_f32 v[52:53], v[52:53], v[54:55] op_sel_hi:[1,0]
v_cvt_pk_bf16_f32 v32, v32, v33
v_cvt_pk_bf16_f32 v33, v34, v35
v_cvt_pk_bf16_f32 v52, v52, v53
ds_write_b64 v2, v[32:33] offset:0
v_pk_mul_f32 v[36:37], v[36:37], v[58:59] op_sel_hi:[1,0]
v_pk_mul_f32 v[38:39], v[38:39], v[58:59] op_sel_hi:[1,0]
v_pk_mul_f32 v[56:57], v[56:57], v[58:59] op_sel_hi:[1,0]
v_cvt_pk_bf16_f32 v36, v36, v37
v_cvt_pk_bf16_f32 v37, v38, v39
v_cvt_pk_bf16_f32 v56, v56, v57
ds_write_b64 v2, v[36:37] offset:2304
v_pk_mul_f32 v[40:41], v[40:41], v[62:63] op_sel_hi:[1,0]
v_pk_mul_f32 v[42:43], v[42:43], v[62:63] op_sel_hi:[1,0]
v_pk_mul_f32 v[60:61], v[60:61], v[62:63] op_sel_hi:[1,0]
v_cvt_pk_bf16_f32 v40, v40, v41
v_cvt_pk_bf16_f32 v41, v42, v43
v_cvt_pk_bf16_f32 v60, v60, v61
ds_write_b64 v2, v[40:41] offset:4608
v_pk_mul_f32 v[44:45], v[44:45], v[66:67] op_sel_hi:[1,0]
v_pk_mul_f32 v[46:47], v[46:47], v[66:67] op_sel_hi:[1,0]
v_pk_mul_f32 v[64:65], v[64:65], v[66:67] op_sel_hi:[1,0]
v_cvt_pk_bf16_f32 v44, v44, v45
v_cvt_pk_bf16_f32 v45, v46, v47
v_cvt_pk_bf16_f32 v64, v64, v65
ds_write_b64 v2, v[44:45] offset:6912
s_mov_b32 exec_lo, 0xffff
s_mov_b32 exec_hi, 0x0
ds_write_b32 v3, v52 offset:2048
ds_write_b32 v3, v56 offset:4352
ds_write_b32 v3, v60 offset:6656
ds_write_b32 v3, v64 offset:8960
s_mov_b64 exec, -1
s_mul_i32 s53, s48, 2304
v_add_u32 v2, s53, v9
s_waitcnt vmcnt(0)
s_waitcnt lgkmcnt(0)
s_barrier
ds_read_b128 v[32:35], v2 offset:0
ds_read_b128 v[36:39], v2 offset:1024
ds_read_b128 v[40:43], v2 offset:2048
s_mul_i32 s53, s49, 608256
s_mul_i32 s42, s48, 18432
s_add_u32 s53, s53, s42
s_add_u32 s53, s53, 3672064
s_lshl_b32 s42, s50, 11
s_add_u32 s42, s42, s53
s_lshl_b32 s43, s50, 8
s_add_u32 s43, s43, s53
s_add_u32 s43, s43, 16384
s_waitcnt lgkmcnt(2)
buffer_store_dwordx4 v[32:35], v9, s[44:47], s42 offen sc1
s_waitcnt lgkmcnt(1)
buffer_store_dwordx4 v[36:39], v9, s[44:47], s42 offen offset:1024 sc1
s_waitcnt lgkmcnt(0)
s_mov_b32 exec_lo, 0xffff
s_mov_b32 exec_hi, 0x0
buffer_store_dwordx4 v[40:43], v9, s[44:47], s43 offen sc1
s_mov_b64 exec, -1
v_mul_u32_u24 v2, 144, v15
v_lshl_add_u32 v2, v16, 3, v2
v_add_u32 v3, 92160, v2
s_mul_i32 s53, s50, 288
s_add_u32 s53, s53, 152064
v_lshl_add_u32 v4, v7, 4, s53
v_add_u32 v5, 16384, v2
ds_read_b64_tr_b16 a[0:1], v3 offset:0
ds_read_b64_tr_b16 a[2:3], v3 offset:2304
ds_read_b64_tr_b16 a[4:5], v3 offset:32
ds_read_b64_tr_b16 a[6:7], v3 offset:2336
ds_read_b64_tr_b16 a[8:9], v3 offset:64
ds_read_b64_tr_b16 a[10:11], v3 offset:2368
ds_read_b64_tr_b16 a[12:13], v3 offset:96
ds_read_b64_tr_b16 a[14:15], v3 offset:2400
ds_read_b64_tr_b16 a[16:17], v3 offset:128
ds_read_b64_tr_b16 a[18:19], v3 offset:2432
ds_read_b64_tr_b16 a[20:21], v3 offset:4608
ds_read_b64_tr_b16 a[22:23], v3 offset:6912
ds_read_b64_tr_b16 a[24:25], v3 offset:4640
ds_read_b64_tr_b16 a[26:27], v3 offset:6944
ds_read_b64_tr_b16 a[28:29], v3 offset:4672
ds_read_b64_tr_b16 a[30:31], v3 offset:6976
ds_read_b64_tr_b16 a[32:33], v3 offset:4704
ds_read_b64_tr_b16 a[34:35], v3 offset:7008
ds_read_b64_tr_b16 a[36:37], v3 offset:4736
ds_read_b64_tr_b16 a[38:39], v3 offset:7040
ds_read_b64_tr_b16 a[40:41], v3 offset:9216
ds_read_b64_tr_b16 a[42:43], v3 offset:11520
ds_read_b64_tr_b16 a[44:45], v3 offset:9248
ds_read_b64_tr_b16 a[46:47], v3 offset:11552
ds_read_b64_tr_b16 a[48:49], v3 offset:9280
ds_read_b64_tr_b16 a[50:51], v3 offset:11584
ds_read_b64_tr_b16 a[52:53], v3 offset:9312
ds_read_b64_tr_b16 a[54:55], v3 offset:11616
ds_read_b64_tr_b16 a[56:57], v3 offset:9344
ds_read_b64_tr_b16 a[58:59], v3 offset:11648
ds_read_b64_tr_b16 a[60:61], v3 offset:13824
ds_read_b64_tr_b16 a[62:63], v3 offset:16128
ds_read_b64_tr_b16 a[64:65], v3 offset:13856
ds_read_b64_tr_b16 a[66:67], v3 offset:16160
ds_read_b64_tr_b16 a[68:69], v3 offset:13888
ds_read_b64_tr_b16 a[70:71], v3 offset:16192
ds_read_b64_tr_b16 a[72:73], v3 offset:13920
ds_read_b64_tr_b16 a[74:75], v3 offset:16224
ds_read_b64_tr_b16 a[76:77], v3 offset:13952
ds_read_b64_tr_b16 a[78:79], v3 offset:16256
ds_read_b64_tr_b16 a[80:81], v3 offset:18432
ds_read_b64_tr_b16 a[82:83], v3 offset:20736
ds_read_b64_tr_b16 a[84:85], v3 offset:18464
ds_read_b64_tr_b16 a[86:87], v3 offset:20768
ds_read_b64_tr_b16 a[88:89], v3 offset:18496
s_waitcnt vmcnt(0)
s_mul_i32 s53, s49, 24
s_add_u32 s53, s53, s48
s_lshl_b32 s53, s53, 3
s_add_u32 s53, s53, s50
s_lshl_b32 s53, s53, 7
s_add_u32 s53, s53, 196608
s_mov_b64 exec, 1
buffer_store_dword v21, v9, s[44:47], s53 offen sc1
s_mov_b64 exec, -1
ds_read_b64_tr_b16 a[90:91], v3 offset:20800
ds_read_b64_tr_b16 a[92:93], v3 offset:18528
ds_read_b64_tr_b16 a[94:95], v3 offset:20832
ds_read_b64_tr_b16 a[96:97], v3 offset:18560
ds_read_b64_tr_b16 a[98:99], v3 offset:20864
ds_read_b64_tr_b16 a[100:101], v3 offset:23040
ds_read_b64_tr_b16 a[102:103], v3 offset:25344
ds_read_b64_tr_b16 a[104:105], v3 offset:23072
ds_read_b64_tr_b16 a[106:107], v3 offset:25376
ds_read_b64_tr_b16 a[108:109], v3 offset:23104
ds_read_b64_tr_b16 a[110:111], v3 offset:25408
ds_read_b64_tr_b16 a[112:113], v3 offset:23136
ds_read_b64_tr_b16 a[114:115], v3 offset:25440
ds_read_b64_tr_b16 a[116:117], v3 offset:23168
ds_read_b64_tr_b16 a[118:119], v3 offset:25472
ds_read_b64_tr_b16 a[120:121], v3 offset:27648
ds_read_b64_tr_b16 a[122:123], v3 offset:29952
ds_read_b64_tr_b16 a[124:125], v3 offset:27680
ds_read_b64_tr_b16 a[126:127], v3 offset:29984
ds_read_b64_tr_b16 a[128:129], v3 offset:27712
ds_read_b64_tr_b16 a[130:131], v3 offset:30016
ds_read_b64_tr_b16 a[132:133], v3 offset:27744
ds_read_b64_tr_b16 a[134:135], v3 offset:30048
ds_read_b64_tr_b16 a[136:137], v3 offset:27776
ds_read_b64_tr_b16 a[138:139], v3 offset:30080
ds_read_b64_tr_b16 a[140:141], v3 offset:32256
ds_read_b64_tr_b16 a[142:143], v3 offset:34560
ds_read_b64_tr_b16 a[144:145], v3 offset:32288
ds_read_b64_tr_b16 a[146:147], v3 offset:34592
ds_read_b64_tr_b16 a[148:149], v3 offset:32320
ds_read_b64_tr_b16 a[150:151], v3 offset:34624
ds_read_b64_tr_b16 a[152:153], v3 offset:32352
ds_read_b64_tr_b16 a[154:155], v3 offset:34656
ds_read_b64_tr_b16 a[156:157], v3 offset:32384
ds_read_b64_tr_b16 a[158:159], v3 offset:34688
ds_read_b64_tr_b16 a[160:161], v3 offset:36864
ds_read_b64_tr_b16 a[162:163], v3 offset:39168
ds_read_b64_tr_b16 a[164:165], v3 offset:36896
ds_read_b64_tr_b16 a[166:167], v3 offset:39200
ds_read_b64_tr_b16 a[168:169], v3 offset:36928
ds_read_b64_tr_b16 a[170:171], v3 offset:39232
ds_read_b64_tr_b16 a[172:173], v3 offset:36960
ds_read_b64_tr_b16 a[174:175], v3 offset:39264
ds_read_b64_tr_b16 a[176:177], v3 offset:36992
ds_read_b64_tr_b16 a[178:179], v3 offset:39296
ds_read_b64_tr_b16 a[180:181], v3 offset:41472
ds_read_b64_tr_b16 a[182:183], v3 offset:43776
ds_read_b64_tr_b16 a[184:185], v3 offset:41504
ds_read_b64_tr_b16 a[186:187], v3 offset:43808
ds_read_b64_tr_b16 a[188:189], v3 offset:41536
ds_read_b64_tr_b16 a[190:191], v3 offset:43840
ds_read_b64_tr_b16 a[192:193], v3 offset:41568
ds_read_b64_tr_b16 a[194:195], v3 offset:43872
ds_read_b64_tr_b16 a[196:197], v3 offset:41600
ds_read_b64_tr_b16 a[198:199], v3 offset:43904
ds_read_b64_tr_b16 a[200:201], v3 offset:46080
ds_read_b64_tr_b16 a[202:203], v3 offset:48384
ds_read_b64_tr_b16 a[204:205], v3 offset:46112
ds_read_b64_tr_b16 a[206:207], v3 offset:48416
ds_read_b64_tr_b16 a[208:209], v3 offset:46144
ds_read_b64_tr_b16 a[210:211], v3 offset:48448
ds_read_b64_tr_b16 a[212:213], v3 offset:46176
ds_read_b64_tr_b16 a[214:215], v3 offset:48480
ds_read_b64_tr_b16 a[216:217], v3 offset:46208
ds_read_b64_tr_b16 a[218:219], v3 offset:48512
ds_read_b64_tr_b16 a[220:221], v3 offset:50688
ds_read_b64_tr_b16 a[222:223], v3 offset:52992
ds_read_b64_tr_b16 a[224:225], v3 offset:50720
ds_read_b64_tr_b16 a[226:227], v3 offset:53024
ds_read_b64_tr_b16 a[228:229], v3 offset:50752
ds_read_b64_tr_b16 a[230:231], v3 offset:53056
ds_read_b64_tr_b16 a[232:233], v3 offset:50784
ds_read_b64_tr_b16 a[234:235], v3 offset:53088
ds_read_b64_tr_b16 a[236:237], v3 offset:50816
ds_read_b64_tr_b16 a[238:239], v3 offset:53120
ds_read_b128 v[124:127], v4 offset:0
ds_read_b128 v[128:131], v4 offset:64
ds_read_b128 v[132:135], v4 offset:128
ds_read_b128 v[136:139], v4 offset:192
ds_read_b128 v[140:143], v4 offset:256
v_lshlrev_b32 v2, 7, v1
s_mul_i32 s53, s49, 24
s_add_u32 s53, s53, s48
s_lshl_b32 s53, s53, 10
s_add_u32 s53, s53, 196608
s_mov_b32 exec_lo, 0xff
s_mov_b32 exec_hi, 0x0
buffer_load_dword v149, v2, s[44:47], s53 offen sc1
s_mov_b64 exec, -1
s_mul_i32 s55, s49, 608256
s_mul_i32 s54, s48, 18432
s_add_u32 s55, s55, s54
s_add_u32 s55, s55, 3672064
s_mov_b32 exec_lo, 0xff
s_mov_b32 exec_hi, 0x0
s_waitcnt vmcnt(0)
v_cmp_ne_u32 vcc, v21, v149
s_nop 4
s_cbranch_vccz L_poll5d
s_mov_b32 s77, 0x20000
L_poll5:
buffer_load_dword v149, v2, s[44:47], s53 offen sc1
s_waitcnt vmcnt(0)
v_cmp_ne_u32 vcc, v21, v149
s_nop 4
s_cbranch_vccz L_poll5d
s_sub_u32 s77, s77, 1
s_cmp_lg_u32 s77, 0
s_cbranch_scc1 L_poll5
L_poll5d:
s_mov_b64 exec, -1
buffer_load_dwordx4 v[32:35], v9, s[44:47], s55 offen offset:0 sc1
buffer_load_dwordx4 v[36:39], v9, s[44:47], s55 offen offset:1024 sc1
buffer_load_dwordx4 v[40:43], v9, s[44:47], s55 offen offset:2048 sc1
buffer_load_dwordx4 v[44:47], v9, s[44:47], s55 offen offset:3072 sc1
s_add_u32 s55, s55, 4096
buffer_load_dwordx4 v[48:51], v9, s[44:47], s55 offen offset:0 sc1
buffer_load_dwordx4 v[52:55], v9, s[44:47], s55 offen offset:1024 sc1
buffer_load_dwordx4 v[56:59], v9, s[44:47], s55 offen offset:2048 sc1
buffer_load_dwordx4 v[60:63], v9, s[44:47], s55 offen offset:3072 sc1
s_add_u32 s55, s55, 4096
s_waitcnt lgkmcnt(0)
s_barrier
ds_read_b64_tr_b16 a[240:241], v5 offset:0
ds_read_b64_tr_b16 a[242:243], v5 offset:2304
ds_read_b64_tr_b16 a[244:245], v5 offset:32
ds_read_b64_tr_b16 a[246:247], v5 offset:2336
ds_read_b64_tr_b16 a[248:249], v5 offset:64
ds_read_b64_tr_b16 a[250:251], v5 offset:2368
ds_read_b64_tr_b16 a[252:253], v5 offset:96
ds_read_b64_tr_b16 a[254:255], v5 offset:2400
ds_read_b64_tr_b16 v[152:153], v5 offset:128
ds_read_b64_tr_b16 v[154:155], v5 offset:2432
ds_read_b64_tr_b16 v[156:157], v5 offset:4608
ds_read_b64_tr_b16 v[158:159], v5 offset:6912
ds_read_b64_tr_b16 v[160:161], v5 offset:4640
ds_read_b64_tr_b16 v[162:163], v5 offset:6944
ds_read_b64_tr_b16 v[164:165], v5 offset:4672
ds_read_b64_tr_b16 v[166:167], v5 offset:6976
ds_read_b64_tr_b16 v[168:169], v5 offset:4704
ds_read_b64_tr_b16 v[170:171], v5 offset:7008
ds_read_b64_tr_b16 v[172:173], v5 offset:4736
ds_read_b64_tr_b16 v[174:175], v5 offset:7040
ds_read_b64_tr_b16 v[176:177], v5 offset:9216
ds_read_b64_tr_b16 v[178:179], v5 offset:11520
ds_read_b64_tr_b16 v[180:181], v5 offset:9248
ds_read_b64_tr_b16 v[182:183], v5 offset:11552
ds_read_b64_tr_b16 v[184:185], v5 offset:9280
ds_read_b64_tr_b16 v[186:187], v5 offset:11584
ds_read_b64_tr_b16 v[188:189], v5 offset:9312
ds_read_b64_tr_b16 v[190:191], v5 offset:11616
ds_read_b64_tr_b16 v[192:193], v5 offset:9344
ds_read_b64_tr_b16 v[194:195], v5 offset:11648
ds_read_b64_tr_b16 v[196:197], v5 offset:13824
ds_read_b64_tr_b16 v[198:199], v5 offset:16128
ds_read_b64_tr_b16 v[200:201], v5 offset:13856
ds_read_b64_tr_b16 v[202:203], v5 offset:16160
ds_read_b64_tr_b16 v[204:205], v5 offset:13888
ds_read_b64_tr_b16 v[206:207], v5 offset:16192
ds_read_b64_tr_b16 v[208:209], v5 offset:13920
ds_read_b64_tr_b16 v[210:211], v5 offset:16224
ds_read_b64_tr_b16 v[212:213], v5 offset:13952
ds_read_b64_tr_b16 v[214:215], v5 offset:16256
ds_read_b64_tr_b16 v[216:217], v5 offset:18432
ds_read_b64_tr_b16 v[218:219], v5 offset:20736
ds_read_b64_tr_b16 v[220:221], v5 offset:18464
ds_read_b64_tr_b16 v[222:223], v5 offset:20768
ds_read_b64_tr_b16 v[224:225], v5 offset:18496
ds_read_b64_tr_b16 v[226:227], v5 offset:20800
ds_read_b64_tr_b16 v[228:229], v5 offset:18528
ds_read_b64_tr_b16 v[230:231], v5 offset:20832
ds_read_b64_tr_b16 v[232:233], v5 offset:18560
ds_read_b64_tr_b16 v[234:235], v5 offset:20864
ds_read_b64_tr_b16 v[236:237], v5 offset:23040
ds_read_b64_tr_b16 v[238:239], v5 offset:25344
ds_read_b64_tr_b16 v[240:241], v5 offset:23072
ds_read_b64_tr_b16 v[242:243], v5 offset:25376
ds_read_b64_tr_b16 v[244:245], v5 offset:23104
ds_read_b64_tr_b16 v[246:247], v5 offset:25408
ds_read_b64_tr_b16 v[248:249], v5 offset:23136
ds_read_b64_tr_b16 v[250:251], v5 offset:25440
ds_read_b64_tr_b16 v[252:253], v5 offset:23168
ds_read_b64_tr_b16 v[254:255], v5 offset:25472
s_waitcnt vmcnt(7)
v_mfma_f32_16x16x32_bf16 v[104:107], a[0:3], v[32:35], 0
buffer_load_dwordx4 v[64:67], v9, s[44:47], s55 offen offset:0 sc1
v_lshrrev_b32 v20, 2, v1
v_mfma_f32_16x16x32_bf16 v[108:111], a[4:7], v[32:35], 0
v_mul_u32_u24 v20, 96, v20
v_mfma_f32_16x16x32_bf16 v[112:115], a[8:11], v[32:35], 0
v_lshl_add_u32 v20, v16, 3, v20
s_mul_i32 s62, s48, 18432
v_mfma_f32_16x16x32_bf16 v[116:119], a[12:15], v[32:35], 0
s_add_u32 s62, s62, 73728
v_add_u32 v20, s62, v20
v_mfma_f32_16x16x32_bf16 v[120:123], a[16:19], v[32:35], 0
s_waitcnt vmcnt(7)
v_mfma_f32_16x16x32_bf16 v[104:107], a[20:23], v[36:39], v[104:107]
buffer_load_dwordx4 v[68:71], v9, s[44:47], s55 offen offset:1024 sc1
v_add_u32 v144, 0, v1
v_mfma_f32_16x16x32_bf16 v[108:111], a[24:27], v[36:39], v[108:111]
v_mul_u32_u24 v145, 10923, v144
v_mfma_f32_16x16x32_bf16 v[112:115], a[28:31], v[36:39], v[112:115]
v_lshrrev_b32 v145, 16, v145
v_mul_u32_u24 v146, 6, v145
v_mfma_f32_16x16x32_bf16 v[116:119], a[32:35], v[36:39], v[116:119]
v_sub_u32 v146, v144, v146
v_lshlrev_b32 v146, 4, v146
v_mfma_f32_16x16x32_bf16 v[120:123], a[36:39], v[36:39], v[120:123]
s_waitcnt vmcnt(7)
v_mfma_f32_16x16x32_bf16 v[104:107], a[40:43], v[40:43], v[104:107]
buffer_load_dwordx4 v[72:75], v9, s[44:47], s55 offen offset:2048 sc1
v_subrev_u32 v146, 0, v146
v_mfma_f32_16x16x32_bf16 v[108:111], a[44:47], v[40:43], v[108:111]
v_mul_u32_u24 v147, 9216, v145
v_mfma_f32_16x16x32_bf16 v[112:115], a[48:51], v[40:43], v[112:115]
v_add_u32 v10, v147, v146
v_mul_u32_u24 v147, 1152, v145
v_mfma_f32_16x16x32_bf16 v[116:119], a[52:55], v[40:43], v[116:119]
v_add_u32 v17, v147, v146
v_bfe_u32 v147, v145, 2, 2
v_mfma_f32_16x16x32_bf16 v[120:123], a[56:59], v[40:43], v[120:123]
s_waitcnt vmcnt(7)
v_mfma_f32_16x16x32_bf16 v[104:107], a[60:63], v[44:47], v[104:107]
buffer_load_dwordx4 v[76:79], v9, s[44:47], s55 offen offset:3072 sc1
v_mul_u32_u24 v147, 72, v147
v_mfma_f32_16x16x32_bf16 v[108:111], a[64:67], v[44:47], v[108:111]
s_add_u32 s55, s55, 4096
v_lshrrev_b32 v148, 4, v145
v_mfma_f32_16x16x32_bf16 v[112:115], a[68:71], v[44:47], v[112:115]
v_lshl_add_u32 v147, v148, 2, v147
v_and_b32 v148, 3, v145
v_mfma_f32_16x16x32_bf16 v[116:119], a[72:75], v[44:47], v[116:119]
v_add_u32 v147, v147, v148
v_mul_u32_u24 v147, 9216, v147
v_mfma_f32_16x16x32_bf16 v[120:123], a[76:79], v[44:47], v[120:123]
s_waitcnt vmcnt(7)
v_mfma_f32_16x16x32_bf16 v[104:107], a[80:83], v[48:51], v[104:107]
buffer_load_dwordx4 v[80:83], v9, s[44:47], s55 offen offset:0 sc1
v_add_u32 v13, v147, v146
v_mfma_f32_16x16x32_bf16 v[108:111], a[84:87], v[48:51], v[108:111]
v_add_u32 v144, 64, v1
v_mfma_f32_16x16x32_bf16 v[112:115], a[88:91], v[48:51], v[112:115]
v_mul_u32_u24 v145, 10923, v144
v_lshrrev_b32 v145, 16, v145
v_mfma_f32_16x16x32_bf16 v[116:119], a[92:95], v[48:51], v[116:119]
v_mul_u32_u24 v146, 6, v145
v_sub_u32 v146, v144, v146
v_mfma_f32_16x16x32_bf16 v[120:123], a[96:99], v[48:51], v[120:123]
s_waitcnt vmcnt(7)
v_mfma_f32_16x16x32_bf16 v[104:107], a[100:103], v[52:55], v[104:107]
buffer_load_dwordx4 v[84:87], v9, s[44:47], s55 offen offset:1024 sc1
v_lshlrev_b32 v146, 4, v146
v_mfma_f32_16x16x32_bf16 v[108:111], a[104:107], v[52:55], v[108:111]
v_subrev_u32 v146, 1024, v146
v_mfma_f32_16x16x32_bf16 v[112:115], a[108:111], v[52:55], v[112:115]
v_mul_u32_u24 v147, 9216, v145
v_add_u32 v11, v147, v146
v_mfma_f32_16x16x32_bf16 v[116:119], a[112:115], v[52:55], v[116:119]
v_mul_u32_u24 v147, 1152, v145
v_add_u32 v18, v147, v146
v_mfma_f32_16x16x32_bf16 v[120:123], a[116:119], v[52:55], v[120:123]
s_waitcnt vmcnt(7)
v_mfma_f32_16x16x32_bf16 v[104:107], a[120:123], v[56:59], v[104:107]
buffer_load_dwordx4 v[88:91], v9, s[44:47], s55 offen offset:2048 sc1
v_bfe_u32 v147, v145, 2, 2
v_mfma_f32_16x16x32_bf16 v[108:111], a[124:127], v[56:59], v[108:111]
v_mul_u32_u24 v147, 72, v147
v_mfma_f32_16x16x32_bf16 v[112:115], a[128:131], v[56:59], v[112:115]
v_lshrrev_b32 v148, 4, v145
v_lshl_add_u32 v147, v148, 2, v147
v_mfma_f32_16x16x32_bf16 v[116:119], a[132:135], v[56:59], v[116:119]
v_and_b32 v148, 3, v145
v_add_u32 v147, v147, v148
v_mfma_f32_16x16x32_bf16 v[120:123], a[136:139], v[56:59], v[120:123]
s_waitcnt vmcnt(7)
v_mfma_f32_16x16x32_bf16 v[104:107], a[140:143], v[60:63], v[104:107]
buffer_load_dwordx4 v[92:95], v9, s[44:47], s55 offen offset:3072 sc1
v_mul_u32_u24 v147, 9216, v147
v_mfma_f32_16x16x32_bf16 v[108:111], a[144:147], v[60:63], v[108:111]
s_add_u32 s55, s55, 4096
v_add_u32 v14, v147, v146
v_mfma_f32_16x16x32_bf16 v[112:115], a[148:151], v[60:63], v[112:115]
v_add_u32 v144, 128, v1
v_mul_u32_u24 v145, 10923, v144
v_mfma_f32_16x16x32_bf16 v[116:119], a[152:155], v[60:63], v[116:119]
v_lshrrev_b32 v145, 16, v145
v_mul_u32_u24 v146, 6, v145
v_mfma_f32_16x16x32_bf16 v[120:123], a[156:159], v[60:63], v[120:123]
s_waitcnt vmcnt(7)
v_mfma_f32_16x16x32_bf16 v[104:107], a[160:163], v[64:67], v[104:107]
buffer_load_dwordx4 v[96:99], v9, s[44:47], s55 offen offset:0 sc1
v_sub_u32 v146, v144, v146
v_mfma_f32_16x16x32_bf16 v[108:111], a[164:167], v[64:67], v[108:111]
v_lshlrev_b32 v146, 4, v146
v_mfma_f32_16x16x32_bf16 v[112:115], a[168:171], v[64:67], v[112:115]
v_subrev_u32 v146, 2048, v146
v_mul_u32_u24 v147, 9216, v145
v_mfma_f32_16x16x32_bf16 v[116:119], a[172:175], v[64:67], v[116:119]
v_add_u32 v12, v147, v146
v_mul_u32_u24 v147, 1152, v145
v_mfma_f32_16x16x32_bf16 v[120:123], a[176:179], v[64:67], v[120:123]
s_waitcnt vmcnt(7)
v_mfma_f32_16x16x32_bf16 v[104:107], a[180:183], v[68:71], v[104:107]
buffer_load_dwordx4 v[100:103], v9, s[44:47], s55 offen offset:1024 sc1
v_add_u32 v19, v147, v146
v_mfma_f32_16x16x32_bf16 v[108:111], a[184:187], v[68:71], v[108:111]
v_bfe_u32 v147, v145, 2, 2
v_mfma_f32_16x16x32_bf16 v[112:115], a[188:191], v[68:71], v[112:115]
v_mul_u32_u24 v147, 72, v147
v_lshrrev_b32 v148, 4, v145
v_mfma_f32_16x16x32_bf16 v[116:119], a[192:195], v[68:71], v[116:119]
v_lshl_add_u32 v147, v148, 2, v147
v_and_b32 v148, 3, v145
v_mfma_f32_16x16x32_bf16 v[120:123], a[196:199], v[68:71], v[120:123]
s_waitcnt vmcnt(7)
v_mfma_f32_16x16x32_bf16 v[104:107], a[200:203], v[72:75], v[104:107]
v_add_u32 v147, v147, v148
v_mfma_f32_16x16x32_bf16 v[108:111], a[204:207], v[72:75], v[108:111]
v_mul_u32_u24 v147, 9216, v147
v_mfma_f32_16x16x32_bf16 v[112:115], a[208:211], v[72:75], v[112:115]
v_add_u32 v15, v147, v146
s_mul_i32 s53, s48, 96
v_mfma_f32_16x16x32_bf16 v[116:119], a[212:215], v[72:75], v[116:119]
s_mul_i32 s60, s52, 1152
s_add_u32 s60, s60, s53
v_mfma_f32_16x16x32_bf16 v[120:123], a[216:219], v[72:75], v[120:123]
s_waitcnt vmcnt(6)
v_mfma_f32_16x16x32_bf16 v[104:107], a[220:223], v[76:79], v[104:107]
s_mul_i32 s61, s52, 663552
v_mfma_f32_16x16x32_bf16 v[108:111], a[224:227], v[76:79], v[108:111]
s_add_u32 s61, s61, s53
v_mfma_f32_16x16x32_bf16 v[112:115], a[228:231], v[76:79], v[112:115]
s_mul_i32 s53, s49, 73728
s_mul_i32 s42, s48, 18432
v_mfma_f32_16x16x32_bf16 v[116:119], a[232:235], v[76:79], v[116:119]
s_add_u32 s53, s53, s42
s_add_u32 s53, s53, 1048576
v_mfma_f32_16x16x32_bf16 v[120:123], a[236:239], v[76:79], v[120:123]
s_waitcnt vmcnt(5)
s_waitcnt lgkmcnt(0)
v_mfma_f32_16x16x32_bf16 v[104:107], a[240:243], v[80:83], v[104:107]
s_lshl_b32 s42, s50, 11
v_mfma_f32_16x16x32_bf16 v[108:111], a[244:247], v[80:83], v[108:111]
s_add_u32 s42, s42, s53
v_mfma_f32_16x16x32_bf16 v[112:115], a[248:251], v[80:83], v[112:115]
s_lshl_b32 s43, s50, 8
v_mfma_f32_16x16x32_bf16 v[116:119], a[252:255], v[80:83], v[116:119]
s_add_u32 s43, s43, s53
s_add_u32 s43, s43, 16384
v_mfma_f32_16x16x32_bf16 v[120:123], v[152:155], v[80:83], v[120:123]
s_waitcnt vmcnt(4)
v_mfma_f32_16x16x32_bf16 v[104:107], v[156:159], v[84:87], v[104:107]
v_lshlrev_b32 v32, 16, v22
v_mfma_f32_16x16x32_bf16 v[108:111], v[160:163], v[84:87], v[108:111]
v_and_b32 v33, 0xffff0000, v22
v_mfma_f32_16x16x32_bf16 v[112:115], v[164:167], v[84:87], v[112:115]
v_lshlrev_b32 v34, 16, v23
v_mfma_f32_16x16x32_bf16 v[116:119], v[168:171], v[84:87], v[116:119]
v_and_b32 v35, 0xffff0000, v23
v_mfma_f32_16x16x32_bf16 v[120:123], v[172:175], v[84:87], v[120:123]
s_waitcnt vmcnt(3)
v_mfma_f32_16x16x32_bf16 v[104:107], v[176:179], v[88:91], v[104:107]
s_add_u32 m0, s62, 0
v_lshlrev_b32 v36, 16, v24
v_mfma_f32_16x16x32_bf16 v[108:111], v[180:183], v[88:91], v[108:111]
s_add_u32 s76, s60, 0
v_and_b32 v37, 0xffff0000, v24
v_mfma_f32_16x16x32_bf16 v[112:115], v[184:187], v[88:91], v[112:115]
buffer_load_dwordx4 v10, s[20:23], s76 offen offset:0 lds
v_lshlrev_b32 v38, 16, v25
v_mfma_f32_16x16x32_bf16 v[116:119], v[188:191], v[88:91], v[116:119]
v_and_b32 v39, 0xffff0000, v25
v_mfma_f32_16x16x32_bf16 v[120:123], v[192:195], v[88:91], v[120:123]
s_waitcnt vmcnt(3)
v_mfma_f32_16x16x32_bf16 v[104:107], v[196:199], v[92:95], v[104:107]
buffer_load_dwordx4 v11, s[20:23], s76 offen offset:1024 lds
v_lshlrev_b32 v40, 16, v26
v_mfma_f32_16x16x32_bf16 v[108:111], v[200:203], v[92:95], v[108:111]
v_and_b32 v41, 0xffff0000, v26
v_mfma_f32_16x16x32_bf16 v[112:115], v[204:207], v[92:95], v[112:115]
v_lshlrev_b32 v42, 16, v27
v_mfma_f32_16x16x32_bf16 v[116:119], v[208:211], v[92:95], v[116:119]
v_and_b32 v43, 0xffff0000, v27
v_mfma_f32_16x16x32_bf16 v[120:123], v[212:215], v[92:95], v[120:123]
s_waitcnt vmcnt(3)
v_mfma_f32_16x16x32_bf16 v[104:107], v[216:219], v[96:99], v[104:107]
buffer_load_dwordx4 v12, s[20:23], s76 offen offset:2048 lds
v_lshlrev_b32 v44, 16, v28
v_mfma_f32_16x16x32_bf16 v[108:111], v[220:223], v[96:99], v[108:111]
v_and_b32 v45, 0xffff0000, v28
v_mfma_f32_16x16x32_bf16 v[112:115], v[224:227], v[96:99], v[112:115]
v_lshlrev_b32 v46, 16, v29
v_mfma_f32_16x16x32_bf16 v[116:119], v[228:231], v[96:99], v[116:119]
v_and_b32 v47, 0xffff0000, v29
v_mfma_f32_16x16x32_bf16 v[120:123], v[232:235], v[96:99], v[120:123]
s_waitcnt vmcnt(3)
v_mfma_f32_16x16x32_bf16 v[104:107], v[236:239], v[100:103], v[104:107]
s_add_u32 m0, s62, 3072
v_lshlrev_b32 v48, 16, v30
v_mfma_f32_16x16x32_bf16 v[108:111], v[240:243], v[100:103], v[108:111]
s_add_u32 s76, s60, 294912
v_and_b32 v49, 0xffff0000, v30
v_mfma_f32_16x16x32_bf16 v[112:115], v[244:247], v[100:103], v[112:115]
buffer_load_dwordx4 v10, s[20:23], s76 offen offset:0 lds
v_lshlrev_b32 v50, 16, v31
v_mfma_f32_16x16x32_bf16 v[116:119], v[248:251], v[100:103], v[116:119]
v_and_b32 v51, 0xffff0000, v31
v_mfma_f32_16x16x32_bf16 v[120:123], v[252:255], v[100:103], v[120:123]
v_pk_fma_f32 v[32:33], v[104:105], v[124:125], v[32:33]
v_pk_fma_f32 v[34:35], v[106:107], v[126:127], v[34:35]
v_pk_fma_f32 v[36:37], v[108:109], v[128:129], v[36:37]
v_pk_fma_f32 v[38:39], v[110:111], v[130:131], v[38:39]
v_pk_fma_f32 v[40:41], v[112:113], v[132:133], v[40:41]
v_pk_fma_f32 v[42:43], v[114:115], v[134:135], v[42:43]
v_pk_fma_f32 v[44:45], v[116:117], v[136:137], v[44:45]
v_pk_fma_f32 v[46:47], v[118:119], v[138:139], v[46:47]
v_pk_fma_f32 v[48:49], v[120:121], v[140:141], v[48:49]
v_pk_fma_f32 v[50:51], v[122:123], v[142:143], v[50:51]
v_cvt_pk_bf16_f32 v60, v48, v49
v_mov_b32 v62, v60
v_cvt_pk_bf16_f32 v61, v50, v51
v_mov_b32 v63, v61
v_cvt_pk_bf16_f32 v52, v32, v33
v_cvt_pk_bf16_f32 v53, v34, v35
v_cvt_pk_bf16_f32 v54, v36, v37
v_cvt_pk_bf16_f32 v55, v38, v39
v_cvt_pk_bf16_f32 v56, v40, v41
v_cvt_pk_bf16_f32 v57, v42, v43
v_cvt_pk_bf16_f32 v58, v44, v45
v_cvt_pk_bf16_f32 v59, v46, v47
v_permlane16_swap_b32 v60, v62
v_permlane16_swap_b32 v61, v63
buffer_store_dwordx4 v[52:55], v9, s[44:47], s42 offen sc1
buffer_store_dwordx4 v[56:59], v9, s[44:47], s42 offen offset:1024 sc1
s_mov_b32 exec_lo, 0xffff
s_mov_b32 exec_hi, 0x0
buffer_store_dwordx4 v[60:63], v9, s[44:47], s43 offen sc1
s_mov_b64 exec, -1
v_mov_b32 v248, 0x3f803f80
v_mov_b32 v249, 0x3f803f80
v_mov_b32 v250, 0x3f803f80
v_mov_b32 v251, 0x3f803f80
s_mul_i32 s53, s48, 576
s_add_u32 s53, s53, 154368
v_lshl_add_u32 v22, v7, 4, s53
s_and_b32 s54, s48, 1
s_mul_i32 s53, s54, 1152
s_add_u32 s53, s53, 154624
v_mul_u32_u24 v23, 288, v7
v_add_u32 v23, s53, v23
ds_read_b128 v[184:187], v22 offset:2304
ds_read_b128 v[188:191], v22 offset:2368
ds_read_b128 v[192:195], v22 offset:0
ds_read_b128 v[196:199], v22 offset:64
ds_read_b128 v[200:203], v22 offset:2432
ds_read_b128 v[204:207], v22 offset:2496
ds_read_b128 v[208:211], v22 offset:128
ds_read_b128 v[212:215], v22 offset:192
s_lshr_b32 s55, s48, 1
s_xor_b32 s55, s55, s52
s_and_b32 s55, s55, 1
s_mul_i32 s68, s55, 36864
s_sub_u32 s69, 36864, s68
s_lshl_b32 s53, s48, 12
v_add_u32 v255, s53, v9
v_add_u32 v252, s68, v255
v_add_u32 v253, s69, v255
s_lshl_b32 s54, s54, 10
s_add_u32 s54, s54, 16384
s_add_u32 s54, s54, s68
v_add_u32 v254, s54, v9
v_add_u32 v5, 36864, v9
s_mul_i32 s64, s51, 73728
s_add_u32 s64, s64, 1048576
s_add_u32 s65, s64, 18432
s_lshl_b32 s55, s55, 10
s_add_u32 s68, s55, 161280
s_sub_u32 s69, 161280, s55
v_lshlrev_b32 v2, 5, v6
v_add_u32 v4, s68, v2
v_add_u32 v170, s69, v2
s_lshl_b32 s53, s48, 3
v_add_u32 v8, s53, v4
v_add_u32 v171, s53, v170
s_waitcnt vmcnt(0)
s_mul_i32 s53, s49, 24
s_add_u32 s53, s53, s48
s_lshl_b32 s53, s53, 3
s_add_u32 s53, s53, s50
s_lshl_b32 s53, s53, 7
s_add_u32 s53, s53, 200704
s_mov_b64 exec, 1
buffer_store_dword v21, v9, s[44:47], s53 offen sc1
s_mov_b64 exec, -1
s_mul_i32 s75, s52, 663552
buffer_load_dwordx4 v11, s[20:23], s76 offen offset:1024 lds
s_lshr_b32 s74, s2, 4
s_mul_i32 s74, s74, 41472
s_add_u32 s75, s75, s74
buffer_load_dwordx4 v12, s[20:23], s76 offen offset:2048 lds
s_add_u32 s75, s75, 0
s_mul_i32 s74, s48, 27
s_add_u32 s74, s74, 0
s_add_u32 m0, s62, 6144
s_add_u32 s76, s60, 663552
buffer_load_dwordx4 v10, s[20:23], s76 offen offset:0 lds
v_add_u32 v175, s74, v1
v_cmp_gt_u32 vcc, 27, v1
v_mul_u32_u24 v2, 21846, v175
v_lshrrev_b32 v2, 16, v2
buffer_load_dwordx4 v11, s[20:23], s76 offen offset:1024 lds
v_mul_u32_u24 v2, 768, v2
v_lshl_add_u32 v175, v175, 7, v2
v_bfrev_b32 v3, -2
buffer_load_dwordx4 v12, s[20:23], s76 offen offset:2048 lds
v_cndmask_b32 v175, v3, v175, vcc
v_add_u32 v175, s75, v175
s_mul_i32 s75, s52, 663552
s_lshr_b32 s74, s2, 4
s_add_u32 m0, s62, 9216
s_add_u32 s76, s60, 958464
buffer_load_dwordx4 v10, s[20:23], s76 offen offset:0 lds
s_mul_i32 s74, s74, 41472
s_add_u32 s75, s75, s74
s_add_u32 s75, s75, 384
buffer_load_dwordx4 v11, s[20:23], s76 offen offset:1024 lds
s_mul_i32 s74, s48, 27
s_add_u32 s74, s74, 0
v_add_u32 v176, s74, v1
v_cmp_gt_u32 vcc, 27, v1
buffer_load_dwordx4 v12, s[20:23], s76 offen offset:2048 lds
v_mul_u32_u24 v2, 21846, v176
v_lshrrev_b32 v2, 16, v2
v_mul_u32_u24 v2, 768, v2
s_add_u32 m0, s62, 12288
s_add_u32 s76, s60, 1327104
buffer_load_dwordx4 v10, s[20:23], s76 offen offset:0 lds
v_lshl_add_u32 v176, v176, 7, v2
v_bfrev_b32 v3, -2
v_cndmask_b32 v176, v3, v176, vcc
buffer_load_dwordx4 v11, s[20:23], s76 offen offset:1024 lds
v_add_u32 v176, s75, v176
s_mul_i32 s75, s52, 663552
s_lshr_b32 s74, s2, 4
s_mul_i32 s74, s74, 41472
buffer_load_dwordx4 v12, s[20:23], s76 offen offset:2048 lds
s_add_u32 s75, s75, s74
s_add_u32 s75, s75, 768
s_mul_i32 s74, s48, 27
s_add_u32 m0, s62, 15360
s_add_u32 s76, s60, 1622016
buffer_load_dwordx4 v10, s[20:23], s76 offen offset:0 lds
s_add_u32 s74, s74, 0
v_add_u32 v177, s74, v1
v_cmp_gt_u32 vcc, 27, v1
v_mul_u32_u24 v2, 21846, v177
buffer_load_dwordx4 v11, s[20:23], s76 offen offset:1024 lds
v_lshrrev_b32 v2, 16, v2
v_mul_u32_u24 v2, 768, v2
v_lshl_add_u32 v177, v177, 7, v2
buffer_load_dwordx4 v12, s[20:23], s76 offen offset:2048 lds
v_bfrev_b32 v3, -2
v_cndmask_b32 v177, v3, v177, vcc
v_add_u32 v177, s75, v177
s_getpc_b64 s[6:7]
s_lshr_b32 s53, s2, 3
s_lshl_b32 s53, s53, 2
s_add_u32 s53, s53, s48
s_lshl_b32 s53, s53, 9
v_lshl_add_u32 v2, v1, 7, s53
v_min_u32 v2, (L_end-L_pc2), v2
v_mov_b32 v3, s7
v_add_co_u32 v2, vcc, s6, v2
s_nop 1
v_addc_co_u32 v3, vcc, 0, v3, vcc
s_mov_b64 exec, 15
global_load_dword v169, v[2:3], off
s_mov_b64 exec, -1
L_pc2:
v_lshlrev_b32 v2, 7, v1
s_mul_i32 s53, s51, 24
s_add_u32 s53, s53, s48
s_lshl_b32 s53, s53, 10
s_add_u32 s53, s53, 200704
s_mov_b32 exec_lo, 0xff
s_mov_b32 exec_hi, 0x0
s_mov_b32 s77, 0x20000
L_poll6:
buffer_load_dword v3, v2, s[44:47], s53 offen sc1
s_waitcnt vmcnt(0)
v_cmp_ne_u32 vcc, v21, v3
s_nop 4
s_cbranch_vccz L_poll6d
s_sub_u32 s77, s77, 1
s_cmp_lg_u32 s77, 0
s_cbranch_scc1 L_poll6
L_poll6d:
s_mov_b64 exec, -1
s_barrier
buffer_load_dwordx4 v[156:159], v254, s[44:47], s64 offen offset:0 sc1
buffer_load_dwordx4 v[164:167], v254, s[44:47], s65 offen offset:0 sc1
buffer_load_dwordx4 v[28:31], v252, s[44:47], s64 offen offset:0 sc1
buffer_load_dwordx4 v[36:39], v252, s[44:47], s65 offen offset:0 sc1
buffer_load_dwordx4 v[60:63], v252, s[44:47], s64 offen offset:1024 sc1
buffer_load_dwordx4 v[68:71], v252, s[44:47], s65 offen offset:1024 sc1
buffer_load_dwordx4 v[92:95], v252, s[44:47], s64 offen offset:2048 sc1
buffer_load_dwordx4 v[100:103], v252, s[44:47], s65 offen offset:2048 sc1
s_waitcnt vmcnt(7)
v_mfma_f32_16x16x32_bf16 v[232:235], v[248:251], v[156:159], 0
v_mfma_f32_16x16x32_bf16 v[216:219], v[156:159], v[156:159], 0
buffer_load_dwordx4 v[124:127], v252, s[44:47], s64 offen offset:3072 sc1
v_lshlrev_b32 v152, 16, v156
v_and_b32 v153, 0xffff0000, v156
v_lshlrev_b32 v154, 16, v157
v_and_b32 v155, 0xffff0000, v157
v_lshlrev_b32 v156, 16, v158
v_and_b32 v157, 0xffff0000, v158
v_lshlrev_b32 v158, 16, v159
v_and_b32 v159, 0xffff0000, v159
s_waitcnt vmcnt(7)
v_mfma_f32_16x16x32_bf16 v[236:239], v[248:251], v[164:167], 0
v_mfma_f32_16x16x32_bf16 v[220:223], v[164:167], v[164:167], 0
buffer_load_dwordx4 v[132:135], v252, s[44:47], s65 offen offset:3072 sc1
v_lshlrev_b32 v160, 16, v164
v_and_b32 v161, 0xffff0000, v164
v_lshlrev_b32 v162, 16, v165
v_and_b32 v163, 0xffff0000, v165
v_lshlrev_b32 v164, 16, v166
v_and_b32 v165, 0xffff0000, v166
v_lshlrev_b32 v166, 16, v167
v_and_b32 v167, 0xffff0000, v167
s_waitcnt vmcnt(7)
v_mfma_f32_16x16x32_bf16 v[232:235], v[248:251], v[28:31], v[232:235]
v_mfma_f32_16x16x32_bf16 v[216:219], v[28:31], v[28:31], v[216:219]
buffer_load_dwordx4 v[44:47], v253, s[44:47], s64 offen offset:0 sc1
v_lshlrev_b32 v24, 16, v28
v_and_b32 v25, 0xffff0000, v28
v_lshlrev_b32 v26, 16, v29
v_and_b32 v27, 0xffff0000, v29
v_lshlrev_b32 v28, 16, v30
v_and_b32 v29, 0xffff0000, v30
v_lshlrev_b32 v30, 16, v31
v_and_b32 v31, 0xffff0000, v31
s_waitcnt vmcnt(7)
v_mfma_f32_16x16x32_bf16 v[236:239], v[248:251], v[36:39], v[236:239]
v_mfma_f32_16x16x32_bf16 v[220:223], v[36:39], v[36:39], v[220:223]
buffer_load_dwordx4 v[52:55], v253, s[44:47], s65 offen offset:0 sc1
v_lshlrev_b32 v32, 16, v36
v_and_b32 v33, 0xffff0000, v36
v_lshlrev_b32 v34, 16, v37
v_and_b32 v35, 0xffff0000, v37
v_lshlrev_b32 v36, 16, v38
v_and_b32 v37, 0xffff0000, v38
v_lshlrev_b32 v38, 16, v39
v_and_b32 v39, 0xffff0000, v39
s_waitcnt vmcnt(7)
v_mfma_f32_16x16x32_bf16 v[232:235], v[248:251], v[60:63], v[232:235]
v_mfma_f32_16x16x32_bf16 v[216:219], v[60:63], v[60:63], v[216:219]
buffer_load_dwordx4 v[76:79], v253, s[44:47], s64 offen offset:1024 sc1
v_lshlrev_b32 v56, 16, v60
v_and_b32 v57, 0xffff0000, v60
v_lshlrev_b32 v58, 16, v61
v_and_b32 v59, 0xffff0000, v61
v_lshlrev_b32 v60, 16, v62
v_and_b32 v61, 0xffff0000, v62
v_lshlrev_b32 v62, 16, v63
v_and_b32 v63, 0xffff0000, v63
s_waitcnt vmcnt(7)
v_mfma_f32_16x16x32_bf16 v[236:239], v[248:251], v[68:71], v[236:239]
v_mfma_f32_16x16x32_bf16 v[220:223], v[68:71], v[68:71], v[220:223]
buffer_load_dwordx4 v[84:87], v253, s[44:47], s65 offen offset:1024 sc1
v_lshlrev_b32 v64, 16, v68
v_and_b32 v65, 0xffff0000, v68
v_lshlrev_b32 v66, 16, v69
v_and_b32 v67, 0xffff0000, v69
v_lshlrev_b32 v68, 16, v70
v_and_b32 v69, 0xffff0000, v70
v_lshlrev_b32 v70, 16, v71
v_and_b32 v71, 0xffff0000, v71
s_waitcnt vmcnt(7)
v_mfma_f32_16x16x32_bf16 v[232:235], v[248:251], v[92:95], v[232:235]
v_mfma_f32_16x16x32_bf16 v[216:219], v[92:95], v[92:95], v[216:219]
buffer_load_dwordx4 v[108:111], v253, s[44:47], s64 offen offset:2048 sc1
v_lshlrev_b32 v88, 16, v92
v_and_b32 v89, 0xffff0000, v92
v_lshlrev_b32 v90, 16, v93
v_and_b32 v91, 0xffff0000, v93
v_lshlrev_b32 v92, 16, v94
v_and_b32 v93, 0xffff0000, v94
v_lshlrev_b32 v94, 16, v95
v_and_b32 v95, 0xffff0000, v95
s_waitcnt vmcnt(7)
v_mfma_f32_16x16x32_bf16 v[236:239], v[248:251], v[100:103], v[236:239]
v_mfma_f32_16x16x32_bf16 v[220:223], v[100:103], v[100:103], v[220:223]
buffer_load_dwordx4 v[116:119], v253, s[44:47], s65 offen offset:2048 sc1
v_lshlrev_b32 v96, 16, v100
v_and_b32 v97, 0xffff0000, v100
v_lshlrev_b32 v98, 16, v101
v_and_b32 v99, 0xffff0000, v101
v_lshlrev_b32 v100, 16, v102
v_and_b32 v101, 0xffff0000, v102
v_lshlrev_b32 v102, 16, v103
v_and_b32 v103, 0xffff0000, v103
s_waitcnt vmcnt(7)
v_mfma_f32_16x16x32_bf16 v[232:235], v[248:251], v[124:127], v[232:235]
v_mfma_f32_16x16x32_bf16 v[216:219], v[124:127], v[124:127], v[216:219]
buffer_load_dwordx4 v[140:143], v253, s[44:47], s64 offen offset:3072 sc1
v_lshlrev_b32 v120, 16, v124
v_and_b32 v121, 0xffff0000, v124
v_lshlrev_b32 v122, 16, v125
v_and_b32 v123, 0xffff0000, v125
v_lshlrev_b32 v124, 16, v126
v_and_b32 v125, 0xffff0000, v126
v_lshlrev_b32 v126, 16, v127
v_and_b32 v127, 0xffff0000, v127
s_waitcnt vmcnt(7)
v_mfma_f32_16x16x32_bf16 v[236:239], v[248:251], v[132:135], v[236:239]
v_mfma_f32_16x16x32_bf16 v[220:223], v[132:135], v[132:135], v[220:223]
buffer_load_dwordx4 v[148:151], v253, s[44:47], s65 offen offset:3072 sc1
v_lshlrev_b32 v128, 16, v132
v_and_b32 v129, 0xffff0000, v132
v_lshlrev_b32 v130, 16, v133
v_and_b32 v131, 0xffff0000, v133
v_lshlrev_b32 v132, 16, v134
v_and_b32 v133, 0xffff0000, v134
v_lshlrev_b32 v134, 16, v135
v_and_b32 v135, 0xffff0000, v135
s_waitcnt vmcnt(7)
v_mfma_f32_16x16x32_bf16 v[240:243], v[248:251], v[44:47], 0
v_mfma_f32_16x16x32_bf16 v[224:227], v[44:47], v[44:47], 0
v_lshlrev_b32 v40, 16, v44
v_and_b32 v41, 0xffff0000, v44
v_lshlrev_b32 v42, 16, v45
v_and_b32 v43, 0xffff0000, v45
v_lshlrev_b32 v44, 16, v46
v_and_b32 v45, 0xffff0000, v46
v_lshlrev_b32 v46, 16, v47
v_and_b32 v47, 0xffff0000, v47
s_waitcnt vmcnt(6)
v_mfma_f32_16x16x32_bf16 v[244:247], v[248:251], v[52:55], 0
v_mfma_f32_16x16x32_bf16 v[228:231], v[52:55], v[52:55], 0
v_lshlrev_b32 v48, 16, v52
v_and_b32 v49, 0xffff0000, v52
v_lshlrev_b32 v50, 16, v53
v_and_b32 v51, 0xffff0000, v53
v_lshlrev_b32 v52, 16, v54
v_and_b32 v53, 0xffff0000, v54
v_lshlrev_b32 v54, 16, v55
v_and_b32 v55, 0xffff0000, v55
s_waitcnt vmcnt(5)
v_mfma_f32_16x16x32_bf16 v[240:243], v[248:251], v[76:79], v[240:243]
v_mfma_f32_16x16x32_bf16 v[224:227], v[76:79], v[76:79], v[224:227]
v_lshlrev_b32 v72, 16, v76
v_and_b32 v73, 0xffff0000, v76
v_lshlrev_b32 v74, 16, v77
v_and_b32 v75, 0xffff0000, v77
v_lshlrev_b32 v76, 16, v78
v_and_b32 v77, 0xffff0000, v78
v_lshlrev_b32 v78, 16, v79
v_and_b32 v79, 0xffff0000, v79
s_waitcnt vmcnt(4)
v_mfma_f32_16x16x32_bf16 v[244:247], v[248:251], v[84:87], v[244:247]
v_mfma_f32_16x16x32_bf16 v[228:231], v[84:87], v[84:87], v[228:231]
v_lshlrev_b32 v80, 16, v84
v_and_b32 v81, 0xffff0000, v84
v_lshlrev_b32 v82, 16, v85
v_and_b32 v83, 0xffff0000, v85
v_lshlrev_b32 v84, 16, v86
v_and_b32 v85, 0xffff0000, v86
v_lshlrev_b32 v86, 16, v87
v_and_b32 v87, 0xffff0000, v87
s_waitcnt vmcnt(3)
v_mfma_f32_16x16x32_bf16 v[240:243], v[248:251], v[108:111], v[240:243]
v_mfma_f32_16x16x32_bf16 v[224:227], v[108:111], v[108:111], v[224:227]
s_waitcnt vmcnt(2)
v_mfma_f32_16x16x32_bf16 v[244:247], v[248:251], v[116:119], v[244:247]
v_mfma_f32_16x16x32_bf16 v[228:231], v[116:119], v[116:119], v[228:231]
s_waitcnt vmcnt(1)
v_mfma_f32_16x16x32_bf16 v[240:243], v[248:251], v[140:143], v[240:243]
v_mfma_f32_16x16x32_bf16 v[224:227], v[140:143], v[140:143], v[224:227]
s_waitcnt vmcnt(0)
v_mfma_f32_16x16x32_bf16 v[244:247], v[248:251], v[148:151], v[244:247]
v_mfma_f32_16x16x32_bf16 v[228:231], v[148:151], v[148:151], v[228:231]
v_lshlrev_b32 v104, 16, v108
v_and_b32 v105, 0xffff0000, v108
v_lshlrev_b32 v106, 16, v109
v_and_b32 v107, 0xffff0000, v109
v_lshlrev_b32 v108, 16, v110
v_and_b32 v109, 0xffff0000, v110
v_lshlrev_b32 v110, 16, v111
v_and_b32 v111, 0xffff0000, v111
v_cndmask_b32 v216, v216, v217, s[56:57]
v_cndmask_b32 v218, v218, v219, s[56:57]
v_cndmask_b32 v233, v216, v218, s[58:59]
v_cndmask_b32 v220, v220, v221, s[56:57]
v_cndmask_b32 v222, v222, v223, s[56:57]
v_cndmask_b32 v237, v220, v222, s[58:59]
v_cndmask_b32 v224, v224, v225, s[56:57]
v_cndmask_b32 v226, v226, v227, s[56:57]
v_cndmask_b32 v241, v224, v226, s[58:59]
v_cndmask_b32 v228, v228, v229, s[56:57]
v_cndmask_b32 v230, v230, v231, s[56:57]
v_cndmask_b32 v245, v228, v230, s[58:59]
s_mov_b32 exec_lo, 0xf0000f
s_mov_b32 exec_hi, 0xf0000f00
ds_write_b64 v8, v[232:233] offset:0
ds_write_b64 v8, v[236:237] offset:512
ds_write_b64 v171, v[240:241] offset:1024
ds_write_b64 v171, v[244:245] offset:1536
s_mov_b64 exec, -1
buffer_load_dword v6, v175, s[24:27], 0 offen
buffer_load_dword v6, v176, s[24:27], 0 offen
buffer_load_dword v6, v177, s[24:27], 0 offen
v_lshlrev_b32 v112, 16, v116
v_and_b32 v113, 0xffff0000, v116
v_lshlrev_b32 v114, 16, v117
v_and_b32 v115, 0xffff0000, v117
v_lshlrev_b32 v116, 16, v118
v_and_b32 v117, 0xffff0000, v118
v_lshlrev_b32 v118, 16, v119
v_and_b32 v119, 0xffff0000, v119
v_lshlrev_b32 v136, 16, v140
v_and_b32 v137, 0xffff0000, v140
v_lshlrev_b32 v138, 16, v141
v_and_b32 v139, 0xffff0000, v141
v_lshlrev_b32 v140, 16, v142
v_and_b32 v141, 0xffff0000, v142
v_lshlrev_b32 v142, 16, v143
v_and_b32 v143, 0xffff0000, v143
v_lshlrev_b32 v144, 16, v148
v_and_b32 v145, 0xffff0000, v148
v_lshlrev_b32 v146, 16, v149
v_and_b32 v147, 0xffff0000, v149
v_lshlrev_b32 v148, 16, v150
v_and_b32 v149, 0xffff0000, v150
v_lshlrev_b32 v150, 16, v151
v_and_b32 v151, 0xffff0000, v151
s_waitcnt lgkmcnt(0)
s_barrier
ds_read_b128 v[216:219], v4 offset:0
ds_read_b128 v[220:223], v4 offset:16
ds_read_b128 v[224:227], v4 offset:512
ds_read_b128 v[228:231], v4 offset:528
ds_read_b128 v[232:235], v170 offset:1024
ds_read_b128 v[236:239], v170 offset:1040
ds_read_b128 v[240:243], v170 offset:1536
ds_read_b128 v[244:247], v170 offset:1552
s_waitcnt lgkmcnt(6)
v_pk_add_f32 v[216:217], v[216:217], v[218:219]
v_pk_add_f32 v[220:221], v[220:221], v[222:223]
v_pk_add_f32 v[216:217], v[216:217], v[220:221]
s_waitcnt lgkmcnt(4)
v_pk_add_f32 v[224:225], v[224:225], v[226:227]
v_pk_add_f32 v[228:229], v[228:229], v[230:231]
v_pk_add_f32 v[224:225], v[224:225], v[228:229]
s_waitcnt lgkmcnt(2)
v_pk_add_f32 v[232:233], v[232:233], v[234:235]
v_pk_add_f32 v[236:237], v[236:237], v[238:239]
v_pk_add_f32 v[232:233], v[232:233], v[236:237]
s_waitcnt lgkmcnt(0)
v_pk_add_f32 v[240:241], v[240:241], v[242:243]
v_pk_add_f32 v[244:245], v[244:245], v[246:247]
v_pk_add_f32 v[240:241], v[240:241], v[244:245]
v_mul_f32 v216, 0x3ae38e39, v216
v_mul_f32 v224, 0x3ae38e39, v224
v_mul_f32 v232, 0x3ae38e39, v232
v_mul_f32 v240, 0x3ae38e39, v240
v_mul_f32 v217, 0x3ae38e39, v217
v_mul_f32 v225, 0x3ae38e39, v225
v_mul_f32 v233, 0x3ae38e39, v233
v_mul_f32 v241, 0x3ae38e39, v241
v_fma_f32 v217, -v216, v216, v217
v_fma_f32 v225, -v224, v224, v225
v_fma_f32 v233, -v232, v232, v233
v_fma_f32 v241, -v240, v240, v241
v_max_f32 v217, 0, v217
v_max_f32 v225, 0, v225
v_max_f32 v233, 0, v233
v_max_f32 v241, 0, v241
v_add_f32 v217, 0x3727c5ac, v217
v_add_f32 v225, 0x3727c5ac, v225
v_add_f32 v233, 0x3727c5ac, v233
v_add_f32 v241, 0x3727c5ac, v241
v_rsq_f32 v218, v217
v_rsq_f32 v226, v225
v_rsq_f32 v234, v233
v_rsq_f32 v242, v241
v_mul_f32 v219, -v216, v218
v_mul_f32 v227, -v224, v226
v_mul_f32 v235, -v232, v234
v_mul_f32 v243, -v240, v242
v_pk_fma_f32 v[24:25], v[24:25], v[218:219], v[218:219] op_sel:[0,0,1] op_sel_hi:[1,0,1]
v_pk_fma_f32 v[26:27], v[26:27], v[218:219], v[218:219] op_sel:[0,0,1] op_sel_hi:[1,0,1]
v_pk_fma_f32 v[28:29], v[28:29], v[218:219], v[218:219] op_sel:[0,0,1] op_sel_hi:[1,0,1]
v_pk_fma_f32 v[30:31], v[30:31], v[218:219], v[218:219] op_sel:[0,0,1] op_sel_hi:[1,0,1]
v_pk_fma_f32 v[24:25], v[24:25], v[184:185], v[192:193]
v_pk_fma_f32 v[26:27], v[26:27], v[186:187], v[194:195]
v_pk_fma_f32 v[28:29], v[28:29], v[188:189], v[196:197]
v_pk_fma_f32 v[30:31], v[30:31], v[190:191], v[198:199]
v_cvt_pk_bf16_f32 v24, v24, v25
v_cvt_pk_bf16_f32 v25, v26, v27
v_cvt_pk_bf16_f32 v26, v28, v29
v_cvt_pk_bf16_f32 v27, v30, v31
ds_write_b128 v252, v[24:27] offset:0
v_pk_fma_f32 v[32:33], v[32:33], v[226:227], v[226:227] op_sel:[0,0,1] op_sel_hi:[1,0,1]
v_pk_fma_f32 v[34:35], v[34:35], v[226:227], v[226:227] op_sel:[0,0,1] op_sel_hi:[1,0,1]
v_pk_fma_f32 v[36:37], v[36:37], v[226:227], v[226:227] op_sel:[0,0,1] op_sel_hi:[1,0,1]
v_pk_fma_f32 v[38:39], v[38:39], v[226:227], v[226:227] op_sel:[0,0,1] op_sel_hi:[1,0,1]
v_pk_fma_f32 v[32:33], v[32:33], v[184:185], v[192:193]
v_pk_fma_f32 v[34:35], v[34:35], v[186:187], v[194:195]
v_pk_fma_f32 v[36:37], v[36:37], v[188:189], v[196:197]
v_pk_fma_f32 v[38:39], v[38:39], v[190:191], v[198:199]
v_cvt_pk_bf16_f32 v32, v32, v33
v_cvt_pk_bf16_f32 v33, v34, v35
v_cvt_pk_bf16_f32 v34, v36, v37
v_cvt_pk_bf16_f32 v35, v38, v39
ds_write_b128 v252, v[32:35] offset:18432
v_pk_fma_f32 v[40:41], v[40:41], v[234:235], v[234:235] op_sel:[0,0,1] op_sel_hi:[1,0,1]
v_pk_fma_f32 v[42:43], v[42:43], v[234:235], v[234:235] op_sel:[0,0,1] op_sel_hi:[1,0,1]
v_pk_fma_f32 v[44:45], v[44:45], v[234:235], v[234:235] op_sel:[0,0,1] op_sel_hi:[1,0,1]
v_pk_fma_f32 v[46:47], v[46:47], v[234:235], v[234:235] op_sel:[0,0,1] op_sel_hi:[1,0,1]
v_pk_fma_f32 v[40:41], v[40:41], v[184:185], v[192:193]
v_pk_fma_f32 v[42:43], v[42:43], v[186:187], v[194:195]
v_pk_fma_f32 v[44:45], v[44:45], v[188:189], v[196:197]
v_pk_fma_f32 v[46:47], v[46:47], v[190:191], v[198:199]
v_cvt_pk_bf16_f32 v40, v40, v41
v_cvt_pk_bf16_f32 v41, v42, v43
v_cvt_pk_bf16_f32 v42, v44, v45
v_cvt_pk_bf16_f32 v43, v46, v47
ds_write_b128 v253, v[40:43] offset:0
v_pk_fma_f32 v[48:49], v[48:49], v[242:243], v[242:243] op_sel:[0,0,1] op_sel_hi:[1,0,1]
v_pk_fma_f32 v[50:51], v[50:51], v[242:243], v[242:243] op_sel:[0,0,1] op_sel_hi:[1,0,1]
v_pk_fma_f32 v[52:53], v[52:53], v[242:243], v[242:243] op_sel:[0,0,1] op_sel_hi:[1,0,1]
v_pk_fma_f32 v[54:55], v[54:55], v[242:243], v[242:243] op_sel:[0,0,1] op_sel_hi:[1,0,1]
v_pk_fma_f32 v[48:49], v[48:49], v[184:185], v[192:193]
v_pk_fma_f32 v[50:51], v[50:51], v[186:187], v[194:195]
v_pk_fma_f32 v[52:53], v[52:53], v[188:189], v[196:197]
v_pk_fma_f32 v[54:55], v[54:55], v[190:191], v[198:199]
ds_read_b128 v[184:187], v22 offset:2592
ds_read_b128 v[188:191], v22 offset:2656
ds_read_b128 v[192:195], v22 offset:288
ds_read_b128 v[196:199], v22 offset:352
v_cvt_pk_bf16_f32 v48, v48, v49
v_cvt_pk_bf16_f32 v49, v50, v51
v_cvt_pk_bf16_f32 v50, v52, v53
v_cvt_pk_bf16_f32 v51, v54, v55
ds_write_b128 v253, v[48:51] offset:18432
v_pk_fma_f32 v[56:57], v[56:57], v[218:219], v[218:219] op_sel:[0,0,1] op_sel_hi:[1,0,1]
v_pk_fma_f32 v[58:59], v[58:59], v[218:219], v[218:219] op_sel:[0,0,1] op_sel_hi:[1,0,1]
v_pk_fma_f32 v[60:61], v[60:61], v[218:219], v[218:219] op_sel:[0,0,1] op_sel_hi:[1,0,1]
v_pk_fma_f32 v[62:63], v[62:63], v[218:219], v[218:219] op_sel:[0,0,1] op_sel_hi:[1,0,1]
v_pk_fma_f32 v[56:57], v[56:57], v[200:201], v[208:209]
v_pk_fma_f32 v[58:59], v[58:59], v[202:203], v[210:211]
v_pk_fma_f32 v[60:61], v[60:61], v[204:205], v[212:213]
v_pk_fma_f32 v[62:63], v[62:63], v[206:207], v[214:215]
v_cvt_pk_bf16_f32 v56, v56, v57
v_cvt_pk_bf16_f32 v57, v58, v59
v_cvt_pk_bf16_f32 v58, v60, v61
v_cvt_pk_bf16_f32 v59, v62, v63
ds_write_b128 v252, v[56:59] offset:1024
v_pk_fma_f32 v[64:65], v[64:65], v[226:227], v[226:227] op_sel:[0,0,1] op_sel_hi:[1,0,1]
v_pk_fma_f32 v[66:67], v[66:67], v[226:227], v[226:227] op_sel:[0,0,1] op_sel_hi:[1,0,1]
v_pk_fma_f32 v[68:69], v[68:69], v[226:227], v[226:227] op_sel:[0,0,1] op_sel_hi:[1,0,1]
v_pk_fma_f32 v[70:71], v[70:71], v[226:227], v[226:227] op_sel:[0,0,1] op_sel_hi:[1,0,1]
v_pk_fma_f32 v[64:65], v[64:65], v[200:201], v[208:209]
v_pk_fma_f32 v[66:67], v[66:67], v[202:203], v[210:211]
v_pk_fma_f32 v[68:69], v[68:69], v[204:205], v[212:213]
v_pk_fma_f32 v[70:71], v[70:71], v[206:207], v[214:215]
v_cvt_pk_bf16_f32 v64, v64, v65
v_cvt_pk_bf16_f32 v65, v66, v67
v_cvt_pk_bf16_f32 v66, v68, v69
v_cvt_pk_bf16_f32 v67, v70, v71
ds_write_b128 v252, v[64:67] offset:19456
v_pk_fma_f32 v[72:73], v[72:73], v[234:235], v[234:235] op_sel:[0,0,1] op_sel_hi:[1,0,1]
v_pk_fma_f32 v[74:75], v[74:75], v[234:235], v[234:235] op_sel:[0,0,1] op_sel_hi:[1,0,1]
v_pk_fma_f32 v[76:77], v[76:77], v[234:235], v[234:235] op_sel:[0,0,1] op_sel_hi:[1,0,1]
v_pk_fma_f32 v[78:79], v[78:79], v[234:235], v[234:235] op_sel:[0,0,1] op_sel_hi:[1,0,1]
v_pk_fma_f32 v[72:73], v[72:73], v[200:201], v[208:209]
v_pk_fma_f32 v[74:75], v[74:75], v[202:203], v[210:211]
v_pk_fma_f32 v[76:77], v[76:77], v[204:205], v[212:213]
v_pk_fma_f32 v[78:79], v[78:79], v[206:207], v[214:215]
v_cvt_pk_bf16_f32 v72, v72, v73
v_cvt_pk_bf16_f32 v73, v74, v75
v_cvt_pk_bf16_f32 v74, v76, v77
v_cvt_pk_bf16_f32 v75, v78, v79
ds_write_b128 v253, v[72:75] offset:1024
v_pk_fma_f32 v[80:81], v[80:81], v[242:243], v[242:243] op_sel:[0,0,1] op_sel_hi:[1,0,1]
v_pk_fma_f32 v[82:83], v[82:83], v[242:243], v[242:243] op_sel:[0,0,1] op_sel_hi:[1,0,1]
v_pk_fma_f32 v[84:85], v[84:85], v[242:243], v[242:243] op_sel:[0,0,1] op_sel_hi:[1,0,1]
v_pk_fma_f32 v[86:87], v[86:87], v[242:243], v[242:243] op_sel:[0,0,1] op_sel_hi:[1,0,1]
v_pk_fma_f32 v[80:81], v[80:81], v[200:201], v[208:209]
v_pk_fma_f32 v[82:83], v[82:83], v[202:203], v[210:211]
v_pk_fma_f32 v[84:85], v[84:85], v[204:205], v[212:213]
v_pk_fma_f32 v[86:87], v[86:87], v[206:207], v[214:215]
ds_read_b128 v[200:203], v22 offset:2720
ds_read_b128 v[204:207], v22 offset:2784
ds_read_b128 v[208:211], v22 offset:416
ds_read_b128 v[212:215], v22 offset:480
v_cvt_pk_bf16_f32 v80, v80, v81
v_cvt_pk_bf16_f32 v81, v82, v83
v_cvt_pk_bf16_f32 v82, v84, v85
v_cvt_pk_bf16_f32 v83, v86, v87
ds_write_b128 v253, v[80:83] offset:19456
s_waitcnt lgkmcnt(9)
v_pk_fma_f32 v[88:89], v[88:89], v[218:219], v[218:219] op_sel:[0,0,1] op_sel_hi:[1,0,1]
v_pk_fma_f32 v[90:91], v[90:91], v[218:219], v[218:219] op_sel:[0,0,1] op_sel_hi:[1,0,1]
v_pk_fma_f32 v[92:93], v[92:93], v[218:219], v[218:219] op_sel:[0,0,1] op_sel_hi:[1,0,1]
v_pk_fma_f32 v[94:95], v[94:95], v[218:219], v[218:219] op_sel:[0,0,1] op_sel_hi:[1,0,1]
v_pk_fma_f32 v[88:89], v[88:89], v[184:185], v[192:193]
v_pk_fma_f32 v[90:91], v[90:91], v[186:187], v[194:195]
v_pk_fma_f32 v[92:93], v[92:93], v[188:189], v[196:197]
v_pk_fma_f32 v[94:95], v[94:95], v[190:191], v[198:199]
v_cvt_pk_bf16_f32 v88, v88, v89
v_cvt_pk_bf16_f32 v89, v90, v91
v_cvt_pk_bf16_f32 v90, v92, v93
v_cvt_pk_bf16_f32 v91, v94, v95
ds_write_b128 v252, v[88:91] offset:2048
v_pk_fma_f32 v[96:97], v[96:97], v[226:227], v[226:227] op_sel:[0,0,1] op_sel_hi:[1,0,1]
v_pk_fma_f32 v[98:99], v[98:99], v[226:227], v[226:227] op_sel:[0,0,1] op_sel_hi:[1,0,1]
v_pk_fma_f32 v[100:101], v[100:101], v[226:227], v[226:227] op_sel:[0,0,1] op_sel_hi:[1,0,1]
v_pk_fma_f32 v[102:103], v[102:103], v[226:227], v[226:227] op_sel:[0,0,1] op_sel_hi:[1,0,1]
v_pk_fma_f32 v[96:97], v[96:97], v[184:185], v[192:193]
v_pk_fma_f32 v[98:99], v[98:99], v[186:187], v[194:195]
v_pk_fma_f32 v[100:101], v[100:101], v[188:189], v[196:197]
v_pk_fma_f32 v[102:103], v[102:103], v[190:191], v[198:199]
v_cvt_pk_bf16_f32 v96, v96, v97
v_cvt_pk_bf16_f32 v97, v98, v99
v_cvt_pk_bf16_f32 v98, v100, v101
v_cvt_pk_bf16_f32 v99, v102, v103
ds_write_b128 v252, v[96:99] offset:20480
v_pk_fma_f32 v[104:105], v[104:105], v[234:235], v[234:235] op_sel:[0,0,1] op_sel_hi:[1,0,1]
v_pk_fma_f32 v[106:107], v[106:107], v[234:235], v[234:235] op_sel:[0,0,1] op_sel_hi:[1,0,1]
v_pk_fma_f32 v[108:109], v[108:109], v[234:235], v[234:235] op_sel:[0,0,1] op_sel_hi:[1,0,1]
v_pk_fma_f32 v[110:111], v[110:111], v[234:235], v[234:235] op_sel:[0,0,1] op_sel_hi:[1,0,1]
v_pk_fma_f32 v[104:105], v[104:105], v[184:185], v[192:193]
v_pk_fma_f32 v[106:107], v[106:107], v[186:187], v[194:195]
v_pk_fma_f32 v[108:109], v[108:109], v[188:189], v[196:197]
v_pk_fma_f32 v[110:111], v[110:111], v[190:191], v[198:199]
v_cvt_pk_bf16_f32 v104, v104, v105
v_cvt_pk_bf16_f32 v105, v106, v107
v_cvt_pk_bf16_f32 v106, v108, v109
v_cvt_pk_bf16_f32 v107, v110, v111
ds_write_b128 v253, v[104:107] offset:2048
v_pk_fma_f32 v[112:113], v[112:113], v[242:243], v[242:243] op_sel:[0,0,1] op_sel_hi:[1,0,1]
v_pk_fma_f32 v[114:115], v[114:115], v[242:243], v[242:243] op_sel:[0,0,1] op_sel_hi:[1,0,1]
v_pk_fma_f32 v[116:117], v[116:117], v[242:243], v[242:243] op_sel:[0,0,1] op_sel_hi:[1,0,1]
v_pk_fma_f32 v[118:119], v[118:119], v[242:243], v[242:243] op_sel:[0,0,1] op_sel_hi:[1,0,1]
v_pk_fma_f32 v[112:113], v[112:113], v[184:185], v[192:193]
v_pk_fma_f32 v[114:115], v[114:115], v[186:187], v[194:195]
v_pk_fma_f32 v[116:117], v[116:117], v[188:189], v[196:197]
v_pk_fma_f32 v[118:119], v[118:119], v[190:191], v[198:199]
ds_read_b128 v[184:187], v23 offset:2304
ds_read_b128 v[188:191], v23 offset:2320
ds_read_b128 v[192:195], v23 offset:0
ds_read_b128 v[196:199], v23 offset:16
v_cvt_pk_bf16_f32 v112, v112, v113
v_cvt_pk_bf16_f32 v113, v114, v115
v_cvt_pk_bf16_f32 v114, v116, v117
v_cvt_pk_bf16_f32 v115, v118, v119
ds_write_b128 v253, v[112:115] offset:20480
s_waitcnt lgkmcnt(9)
v_pk_fma_f32 v[120:121], v[120:121], v[218:219], v[218:219] op_sel:[0,0,1] op_sel_hi:[1,0,1]
v_pk_fma_f32 v[122:123], v[122:123], v[218:219], v[218:219] op_sel:[0,0,1] op_sel_hi:[1,0,1]
v_pk_fma_f32 v[124:125], v[124:125], v[218:219], v[218:219] op_sel:[0,0,1] op_sel_hi:[1,0,1]
v_pk_fma_f32 v[126:127], v[126:127], v[218:219], v[218:219] op_sel:[0,0,1] op_sel_hi:[1,0,1]
v_pk_fma_f32 v[120:121], v[120:121], v[200:201], v[208:209]
v_pk_fma_f32 v[122:123], v[122:123], v[202:203], v[210:211]
v_pk_fma_f32 v[124:125], v[124:125], v[204:205], v[212:213]
v_pk_fma_f32 v[126:127], v[126:127], v[206:207], v[214:215]
v_cvt_pk_bf16_f32 v120, v120, v121
v_cvt_pk_bf16_f32 v121, v122, v123
v_cvt_pk_bf16_f32 v122, v124, v125
v_cvt_pk_bf16_f32 v123, v126, v127
ds_write_b128 v252, v[120:123] offset:3072
v_pk_fma_f32 v[128:129], v[128:129], v[226:227], v[226:227] op_sel:[0,0,1] op_sel_hi:[1,0,1]
v_pk_fma_f32 v[130:131], v[130:131], v[226:227], v[226:227] op_sel:[0,0,1] op_sel_hi:[1,0,1]
v_pk_fma_f32 v[132:133], v[132:133], v[226:227], v[226:227] op_sel:[0,0,1] op_sel_hi:[1,0,1]
v_pk_fma_f32 v[134:135], v[134:135], v[226:227], v[226:227] op_sel:[0,0,1] op_sel_hi:[1,0,1]
v_pk_fma_f32 v[128:129], v[128:129], v[200:201], v[208:209]
v_pk_fma_f32 v[130:131], v[130:131], v[202:203], v[210:211]
v_pk_fma_f32 v[132:133], v[132:133], v[204:205], v[212:213]
v_pk_fma_f32 v[134:135], v[134:135], v[206:207], v[214:215]
v_cvt_pk_bf16_f32 v128, v128, v129
v_cvt_pk_bf16_f32 v129, v130, v131
v_cvt_pk_bf16_f32 v130, v132, v133
v_cvt_pk_bf16_f32 v131, v134, v135
ds_write_b128 v252, v[128:131] offset:21504
v_pk_fma_f32 v[136:137], v[136:137], v[234:235], v[234:235] op_sel:[0,0,1] op_sel_hi:[1,0,1]
v_pk_fma_f32 v[138:139], v[138:139], v[234:235], v[234:235] op_sel:[0,0,1] op_sel_hi:[1,0,1]
v_pk_fma_f32 v[140:141], v[140:141], v[234:235], v[234:235] op_sel:[0,0,1] op_sel_hi:[1,0,1]
v_pk_fma_f32 v[142:143], v[142:143], v[234:235], v[234:235] op_sel:[0,0,1] op_sel_hi:[1,0,1]
v_pk_fma_f32 v[136:137], v[136:137], v[200:201], v[208:209]
v_pk_fma_f32 v[138:139], v[138:139], v[202:203], v[210:211]
v_pk_fma_f32 v[140:141], v[140:141], v[204:205], v[212:213]
v_pk_fma_f32 v[142:143], v[142:143], v[206:207], v[214:215]
v_cvt_pk_bf16_f32 v136, v136, v137
v_cvt_pk_bf16_f32 v137, v138, v139
v_cvt_pk_bf16_f32 v138, v140, v141
v_cvt_pk_bf16_f32 v139, v142, v143
ds_write_b128 v253, v[136:139] offset:3072
v_pk_fma_f32 v[144:145], v[144:145], v[242:243], v[242:243] op_sel:[0,0,1] op_sel_hi:[1,0,1]
v_pk_fma_f32 v[146:147], v[146:147], v[242:243], v[242:243] op_sel:[0,0,1] op_sel_hi:[1,0,1]
v_pk_fma_f32 v[148:149], v[148:149], v[242:243], v[242:243] op_sel:[0,0,1] op_sel_hi:[1,0,1]
v_pk_fma_f32 v[150:151], v[150:151], v[242:243], v[242:243] op_sel:[0,0,1] op_sel_hi:[1,0,1]
v_pk_fma_f32 v[144:145], v[144:145], v[200:201], v[208:209]
v_pk_fma_f32 v[146:147], v[146:147], v[202:203], v[210:211]
v_pk_fma_f32 v[148:149], v[148:149], v[204:205], v[212:213]
v_pk_fma_f32 v[150:151], v[150:151], v[206:207], v[214:215]
v_cvt_pk_bf16_f32 v144, v144, v145
v_cvt_pk_bf16_f32 v145, v146, v147
v_cvt_pk_bf16_f32 v146, v148, v149
v_cvt_pk_bf16_f32 v147, v150, v151
ds_write_b128 v253, v[144:147] offset:21504
s_waitcnt lgkmcnt(5)
v_pk_fma_f32 v[152:153], v[152:153], v[218:219], v[218:219] op_sel:[0,0,1] op_sel_hi:[1,0,1]
v_pk_fma_f32 v[154:155], v[154:155], v[218:219], v[218:219] op_sel:[0,0,1] op_sel_hi:[1,0,1]
v_pk_fma_f32 v[156:157], v[156:157], v[218:219], v[218:219] op_sel:[0,0,1] op_sel_hi:[1,0,1]
v_pk_fma_f32 v[158:159], v[158:159], v[218:219], v[218:219] op_sel:[0,0,1] op_sel_hi:[1,0,1]
v_pk_fma_f32 v[152:153], v[152:153], v[184:185], v[192:193]
v_pk_fma_f32 v[154:155], v[154:155], v[186:187], v[194:195]
v_pk_fma_f32 v[156:157], v[156:157], v[188:189], v[196:197]
v_pk_fma_f32 v[158:159], v[158:159], v[190:191], v[198:199]
v_cvt_pk_bf16_f32 v152, v152, v153
v_cvt_pk_bf16_f32 v153, v154, v155
v_cvt_pk_bf16_f32 v154, v156, v157
v_cvt_pk_bf16_f32 v155, v158, v159
ds_write_b128 v254, v[152:155] offset:0
v_pk_fma_f32 v[160:161], v[160:161], v[226:227], v[226:227] op_sel:[0,0,1] op_sel_hi:[1,0,1]
v_pk_fma_f32 v[162:163], v[162:163], v[226:227], v[226:227] op_sel:[0,0,1] op_sel_hi:[1,0,1]
v_pk_fma_f32 v[164:165], v[164:165], v[226:227], v[226:227] op_sel:[0,0,1] op_sel_hi:[1,0,1]
v_pk_fma_f32 v[166:167], v[166:167], v[226:227], v[226:227] op_sel:[0,0,1] op_sel_hi:[1,0,1]
v_pk_fma_f32 v[160:161], v[160:161], v[184:185], v[192:193]
v_pk_fma_f32 v[162:163], v[162:163], v[186:187], v[194:195]
v_pk_fma_f32 v[164:165], v[164:165], v[188:189], v[196:197]
v_pk_fma_f32 v[166:167], v[166:167], v[190:191], v[198:199]
v_cvt_pk_bf16_f32 v160, v160, v161
v_cvt_pk_bf16_f32 v161, v162, v163
v_cvt_pk_bf16_f32 v162, v164, v165
v_cvt_pk_bf16_f32 v163, v166, v167
ds_write_b128 v254, v[160:163] offset:18432
s_waitcnt lgkmcnt(0)
s_barrier
ds_read_b128 a[0:3], v9 offset:0
ds_read_b128 a[4:7], v9 offset:18432
ds_read_b128 a[8:11], v5 offset:0
ds_read_b128 a[12:15], v5 offset:18432
ds_read_b64_tr_b16 v[128:129], v20 offset:0
ds_read_b64_tr_b16 v[130:131], v20 offset:1536
ds_read_b64_tr_b16 v[132:133], v20 offset:32
ds_read_b64_tr_b16 v[134:135], v20 offset:1568
ds_read_b64_tr_b16 v[136:137], v20 offset:64
ds_read_b64_tr_b16 v[138:139], v20 offset:1600
s_waitcnt lgkmcnt(0)
v_mfma_f32_16x16x32_bf16 v[32:35], v[128:131], a[0:3], 0
ds_read_b128 a[16:19], v9 offset:1024
s_add_u32 m0, s62, 0
v_mfma_f32_16x16x32_bf16 v[44:47], v[128:131], a[4:7], 0
ds_read_b128 a[20:23], v9 offset:19456
s_add_u32 s76, s60, 1990656
v_mfma_f32_16x16x32_bf16 v[56:59], v[128:131], a[8:11], 0
ds_read_b128 a[24:27], v5 offset:1024
buffer_load_dwordx4 v10, s[20:23], s76 offen offset:0 lds
v_mfma_f32_16x16x32_bf16 v[68:71], v[128:131], a[12:15], 0
ds_read_b128 a[28:31], v5 offset:19456
v_mfma_f32_16x16x32_bf16 v[36:39], v[132:135], a[0:3], 0
s_lshl_b32 s54, s48, 10
v_mfma_f32_16x16x32_bf16 v[48:51], v[132:135], a[4:7], 0
ds_read_b64_tr_b16 v[140:141], v20 offset:3072
buffer_load_dwordx4 v11, s[20:23], s76 offen offset:1024 lds
v_mfma_f32_16x16x32_bf16 v[60:63], v[132:135], a[8:11], 0
ds_read_b64_tr_b16 v[142:143], v20 offset:4608
v_add_u32 v22, s54, v9
v_mfma_f32_16x16x32_bf16 v[72:75], v[132:135], a[12:15], 0
ds_read_b64_tr_b16 v[144:145], v20 offset:3104
v_mfma_f32_16x16x32_bf16 v[40:43], v[136:139], a[0:3], 0
ds_read_b64_tr_b16 v[146:147], v20 offset:4640
v_add_u32 v24, s54, v5
v_mfma_f32_16x16x32_bf16 v[52:55], v[136:139], a[4:7], 0
ds_read_b64_tr_b16 v[148:149], v20 offset:3136
s_lshr_b32 s54, s48, 1
v_mfma_f32_16x16x32_bf16 v[64:67], v[136:139], a[8:11], 0
ds_read_b64_tr_b16 v[150:151], v20 offset:4672
buffer_load_dwordx4 v12, s[20:23], s76 offen offset:2048 lds
v_mfma_f32_16x16x32_bf16 v[76:79], v[136:139], a[12:15], 0
s_waitcnt lgkmcnt(0)
v_mfma_f32_16x16x32_bf16 v[32:35], v[140:143], a[16:19], v[32:35]
ds_read_b128 a[32:35], v9 offset:2048
s_add_u32 m0, s62, 3072
v_mfma_f32_16x16x32_bf16 v[44:47], v[140:143], a[20:23], v[44:47]
ds_read_b128 a[36:39], v9 offset:20480
s_add_u32 s76, s60, 2285568
v_mfma_f32_16x16x32_bf16 v[56:59], v[140:143], a[24:27], v[56:59]
ds_read_b128 a[40:43], v5 offset:2048
buffer_load_dwordx4 v10, s[20:23], s76 offen offset:0 lds
v_mfma_f32_16x16x32_bf16 v[68:71], v[140:143], a[28:31], v[68:71]
ds_read_b128 a[44:47], v5 offset:20480
s_add_u32 s54, s54, 4
v_mfma_f32_16x16x32_bf16 v[36:39], v[144:147], a[16:19], v[36:39]
s_lshl_b32 s54, s54, 10
v_mfma_f32_16x16x32_bf16 v[48:51], v[144:147], a[20:23], v[48:51]
ds_read_b64_tr_b16 v[128:129], v20 offset:6144
buffer_load_dwordx4 v11, s[20:23], s76 offen offset:1024 lds
v_mfma_f32_16x16x32_bf16 v[60:63], v[144:147], a[24:27], v[60:63]
ds_read_b64_tr_b16 v[130:131], v20 offset:7680
s_and_b32 s55, s48, 1
v_mfma_f32_16x16x32_bf16 v[72:75], v[144:147], a[28:31], v[72:75]
ds_read_b64_tr_b16 v[132:133], v20 offset:6176
v_mfma_f32_16x16x32_bf16 v[40:43], v[148:151], a[16:19], v[40:43]
ds_read_b64_tr_b16 v[134:135], v20 offset:7712
buffer_load_dwordx4 v12, s[20:23], s76 offen offset:2048 lds
v_mfma_f32_16x16x32_bf16 v[52:55], v[148:151], a[20:23], v[52:55]
ds_read_b64_tr_b16 v[136:137], v20 offset:6208
s_lshl_b32 s55, s55, 3
v_mfma_f32_16x16x32_bf16 v[64:67], v[148:151], a[24:27], v[64:67]
ds_read_b64_tr_b16 v[138:139], v20 offset:7744
v_mfma_f32_16x16x32_bf16 v[76:79], v[148:151], a[28:31], v[76:79]
s_waitcnt lgkmcnt(0)
v_mfma_f32_16x16x32_bf16 v[32:35], v[128:131], a[32:35], v[32:35]
ds_read_b128 a[48:51], v9 offset:3072
s_add_u32 m0, s62, 6144
v_mfma_f32_16x16x32_bf16 v[44:47], v[128:131], a[36:39], v[44:47]
ds_read_b128 a[52:55], v9 offset:21504
s_add_u32 s76, s60, 2654208
v_mfma_f32_16x16x32_bf16 v[56:59], v[128:131], a[40:43], v[56:59]
ds_read_b128 a[56:59], v5 offset:3072
buffer_load_dwordx4 v10, s[20:23], s76 offen offset:0 lds
v_mfma_f32_16x16x32_bf16 v[68:71], v[128:131], a[44:47], v[68:71]
ds_read_b128 a[60:63], v5 offset:21504
s_add_u32 s54, s54, s55
v_mfma_f32_16x16x32_bf16 v[36:39], v[132:135], a[32:35], v[36:39]
v_add_u32 v23, s54, v9
v_mfma_f32_16x16x32_bf16 v[48:51], v[132:135], a[36:39], v[48:51]
ds_read_b64_tr_b16 v[140:141], v20 offset:9216
buffer_load_dwordx4 v11, s[20:23], s76 offen offset:1024 lds
v_mfma_f32_16x16x32_bf16 v[60:63], v[132:135], a[40:43], v[60:63]
ds_read_b64_tr_b16 v[142:143], v20 offset:10752
v_add_u32 v25, s54, v5
v_mfma_f32_16x16x32_bf16 v[72:75], v[132:135], a[44:47], v[72:75]
ds_read_b64_tr_b16 v[144:145], v20 offset:9248
v_mfma_f32_16x16x32_bf16 v[40:43], v[136:139], a[32:35], v[40:43]
ds_read_b64_tr_b16 v[146:147], v20 offset:10784
buffer_load_dwordx4 v12, s[20:23], s76 offen offset:2048 lds
v_mfma_f32_16x16x32_bf16 v[52:55], v[136:139], a[36:39], v[52:55]
ds_read_b64_tr_b16 v[148:149], v20 offset:9280
v_add_u32 v0, 36864, v19
v_mfma_f32_16x16x32_bf16 v[64:67], v[136:139], a[40:43], v[64:67]
ds_read_b64_tr_b16 v[150:151], v20 offset:10816
v_mfma_f32_16x16x32_bf16 v[76:79], v[136:139], a[44:47], v[76:79]
s_waitcnt lgkmcnt(0)
v_mfma_f32_16x16x32_bf16 v[32:35], v[140:143], a[48:51], v[32:35]
ds_read_b128 a[64:67], v9 offset:4096
s_add_u32 m0, s62, 9216
v_mfma_f32_16x16x32_bf16 v[44:47], v[140:143], a[52:55], v[44:47]
ds_read_b128 a[68:71], v9 offset:22528
v_lshrrev_b32 v2, 5, v1
v_mfma_f32_16x16x32_bf16 v[56:59], v[140:143], a[56:59], v[56:59]
ds_read_b128 a[72:75], v5 offset:4096
s_add_u32 s76, s60, 2949120
v_mfma_f32_16x16x32_bf16 v[68:71], v[140:143], a[60:63], v[68:71]
ds_read_b128 a[76:79], v5 offset:22528
buffer_load_dwordx4 v10, s[20:23], s76 offen offset:0 lds
v_mfma_f32_16x16x32_bf16 v[36:39], v[144:147], a[48:51], v[36:39]
v_mul_u32_u24 v2, 36864, v2
v_mfma_f32_16x16x32_bf16 v[48:51], v[144:147], a[52:55], v[48:51]
ds_read_b64_tr_b16 v[128:129], v20 offset:12288
buffer_load_dwordx4 v11, s[20:23], s76 offen offset:1024 lds
v_mfma_f32_16x16x32_bf16 v[60:63], v[144:147], a[56:59], v[60:63]
ds_read_b64_tr_b16 v[130:131], v20 offset:13824
v_add_u32 v8, v2, v18
v_mfma_f32_16x16x32_bf16 v[72:75], v[144:147], a[60:63], v[72:75]
ds_read_b64_tr_b16 v[132:133], v20 offset:12320
v_mfma_f32_16x16x32_bf16 v[40:43], v[148:151], a[48:51], v[40:43]
ds_read_b64_tr_b16 v[134:135], v20 offset:13856
buffer_load_dwordx4 v12, s[20:23], s76 offen offset:2048 lds
v_mfma_f32_16x16x32_bf16 v[52:55], v[148:151], a[52:55], v[52:55]
ds_read_b64_tr_b16 v[136:137], v20 offset:12352
v_bfe_u32 v2, v1, 2, 2
v_mfma_f32_16x16x32_bf16 v[64:67], v[148:151], a[56:59], v[64:67]
ds_read_b64_tr_b16 v[138:139], v20 offset:13888
v_mfma_f32_16x16x32_bf16 v[76:79], v[148:151], a[60:63], v[76:79]
s_waitcnt lgkmcnt(0)
v_mfma_f32_16x16x32_bf16 v[32:35], v[128:131], a[64:67], v[32:35]
ds_read_b128 a[80:83], v9 offset:5120
s_add_u32 m0, s62, 12288
v_mfma_f32_16x16x32_bf16 v[44:47], v[128:131], a[68:71], v[44:47]
ds_read_b128 a[84:87], v9 offset:23552
v_mul_u32_u24 v2, 24576, v2
v_mfma_f32_16x16x32_bf16 v[56:59], v[128:131], a[72:75], v[56:59]
ds_read_b128 a[88:91], v5 offset:5120
s_add_u32 s76, s60, 3317760
v_mfma_f32_16x16x32_bf16 v[68:71], v[128:131], a[76:79], v[68:71]
ds_read_b128 a[92:95], v5 offset:23552
buffer_load_dwordx4 v10, s[20:23], s76 offen offset:0 lds
v_mfma_f32_16x16x32_bf16 v[36:39], v[132:135], a[64:67], v[36:39]
v_lshl_add_u32 v3, v7, 2, v16
v_mfma_f32_16x16x32_bf16 v[48:51], v[132:135], a[68:71], v[48:51]
ds_read_b64_tr_b16 v[140:141], v20 offset:15360
buffer_load_dwordx4 v11, s[20:23], s76 offen offset:1024 lds
v_mfma_f32_16x16x32_bf16 v[60:63], v[132:135], a[72:75], v[60:63]
ds_read_b64_tr_b16 v[142:143], v20 offset:16896
v_lshl_add_u32 v26, v3, 4, v2
v_mfma_f32_16x16x32_bf16 v[72:75], v[132:135], a[76:79], v[72:75]
ds_read_b64_tr_b16 v[144:145], v20 offset:15392
v_mfma_f32_16x16x32_bf16 v[40:43], v[136:139], a[64:67], v[40:43]
ds_read_b64_tr_b16 v[146:147], v20 offset:16928
buffer_load_dwordx4 v12, s[20:23], s76 offen offset:2048 lds
v_mfma_f32_16x16x32_bf16 v[52:55], v[136:139], a[68:71], v[52:55]
ds_read_b64_tr_b16 v[148:149], v20 offset:15424
s_mul_i32 s63, s51, 608256
v_mfma_f32_16x16x32_bf16 v[64:67], v[136:139], a[72:75], v[64:67]
ds_read_b64_tr_b16 v[150:151], v20 offset:16960
v_mfma_f32_16x16x32_bf16 v[76:79], v[136:139], a[76:79], v[76:79]
s_waitcnt lgkmcnt(0)
v_mfma_f32_16x16x32_bf16 v[32:35], v[140:143], a[80:83], v[32:35]
ds_read_b128 a[96:99], v9 offset:6144
s_add_u32 m0, s62, 15360
v_mfma_f32_16x16x32_bf16 v[44:47], v[140:143], a[84:87], v[44:47]
ds_read_b128 a[100:103], v9 offset:24576
s_add_u32 s76, s60, 3612672
v_mfma_f32_16x16x32_bf16 v[56:59], v[140:143], a[88:91], v[56:59]
ds_read_b128 a[104:107], v5 offset:6144
buffer_load_dwordx4 v10, s[20:23], s76 offen offset:0 lds
v_mfma_f32_16x16x32_bf16 v[68:71], v[140:143], a[92:95], v[68:71]
ds_read_b128 a[108:111], v5 offset:24576
s_mul_i32 s53, s48, 6144
v_mfma_f32_16x16x32_bf16 v[36:39], v[144:147], a[80:83], v[36:39]
s_waitcnt vmcnt(13)
s_add_u32 s63, s63, s53
v_mfma_f32_16x16x32_bf16 v[48:51], v[144:147], a[84:87], v[48:51]
ds_read_b64_tr_b16 v[128:129], v20 offset:0
buffer_load_dwordx4 v11, s[20:23], s76 offen offset:1024 lds
v_mfma_f32_16x16x32_bf16 v[60:63], v[144:147], a[88:91], v[60:63]
ds_read_b64_tr_b16 v[130:131], v20 offset:1536
s_add_u32 s63, s63, 3407872
v_mfma_f32_16x16x32_bf16 v[72:75], v[144:147], a[92:95], v[72:75]
ds_read_b64_tr_b16 v[132:133], v20 offset:32
v_mfma_f32_16x16x32_bf16 v[40:43], v[148:151], a[80:83], v[40:43]
ds_read_b64_tr_b16 v[134:135], v20 offset:1568
buffer_load_dwordx4 v12, s[20:23], s76 offen offset:2048 lds
v_mfma_f32_16x16x32_bf16 v[52:55], v[148:151], a[84:87], v[52:55]
ds_read_b64_tr_b16 v[136:137], v20 offset:64
s_mul_i32 s53, s52, 768
v_mfma_f32_16x16x32_bf16 v[64:67], v[148:151], a[88:91], v[64:67]
ds_read_b64_tr_b16 v[138:139], v20 offset:1600
v_mfma_f32_16x16x32_bf16 v[76:79], v[148:151], a[92:95], v[76:79]
s_waitcnt lgkmcnt(0)
v_mfma_f32_16x16x32_bf16 v[32:35], v[128:131], a[96:99], v[32:35]
ds_read_b128 a[112:115], v9 offset:7168
s_add_u32 m0, s62, 0
v_mfma_f32_16x16x32_bf16 v[44:47], v[128:131], a[100:103], v[44:47]
ds_read_b128 a[116:119], v9 offset:25600
s_add_u32 s76, s60, 3981312
v_mfma_f32_16x16x32_bf16 v[56:59], v[128:131], a[104:107], v[56:59]
ds_read_b128 a[120:123], v5 offset:7168
buffer_load_dwordx4 v10, s[20:23], s76 offen offset:0 lds
v_mfma_f32_16x16x32_bf16 v[68:71], v[128:131], a[108:111], v[68:71]
ds_read_b128 a[124:127], v5 offset:25600
s_add_u32 s64, s63, s53
v_mfma_f32_16x16x32_bf16 v[36:39], v[132:135], a[96:99], v[36:39]
s_waitcnt vmcnt(13)
ds_read_b64_tr_b16 v[140:141], v20 offset:3072
v_mfma_f32_16x16x32_bf16 v[48:51], v[132:135], a[100:103], v[48:51]
ds_read_b64_tr_b16 v[142:143], v20 offset:4608
s_mul_i32 s53, s52, 24576
v_mfma_f32_16x16x32_bf16 v[60:63], v[132:135], a[104:107], v[60:63]
ds_read_b64_tr_b16 v[144:145], v20 offset:3104
buffer_load_dwordx4 v11, s[20:23], s76 offen offset:1024 lds
v_mfma_f32_16x16x32_bf16 v[72:75], v[132:135], a[108:111], v[72:75]
ds_read_b64_tr_b16 v[146:147], v20 offset:4640
v_mfma_f32_16x16x32_bf16 v[40:43], v[136:139], a[96:99], v[40:43]
ds_read_b64_tr_b16 v[148:149], v20 offset:3136
s_add_u32 s63, s63, s53
v_mfma_f32_16x16x32_bf16 v[52:55], v[136:139], a[100:103], v[52:55]
ds_read_b64_tr_b16 v[150:151], v20 offset:4672
buffer_load_dwordx4 v12, s[20:23], s76 offen offset:2048 lds
v_mfma_f32_16x16x32_bf16 v[64:67], v[136:139], a[104:107], v[64:67]
v_mfma_f32_16x16x32_bf16 v[76:79], v[136:139], a[108:111], v[76:79]
s_waitcnt lgkmcnt(0)
v_mfma_f32_16x16x32_bf16 v[32:35], v[140:143], a[112:115], v[32:35]
ds_read_b128 a[128:131], v9 offset:8192
s_add_u32 m0, s62, 3072
v_mfma_f32_16x16x32_bf16 v[44:47], v[140:143], a[116:119], v[44:47]
ds_read_b128 a[132:135], v9 offset:26624
s_add_u32 s76, s60, 4276224
v_mfma_f32_16x16x32_bf16 v[56:59], v[140:143], a[120:123], v[56:59]
ds_read_b128 a[136:139], v5 offset:8192
buffer_load_dwordx4 v10, s[20:23], s76 offen offset:0 lds
v_mfma_f32_16x16x32_bf16 v[68:71], v[140:143], a[124:127], v[68:71]
ds_read_b128 a[140:143], v5 offset:26624
v_mfma_f32_16x16x32_bf16 v[36:39], v[144:147], a[112:115], v[36:39]
s_waitcnt vmcnt(13)
ds_read_b64_tr_b16 v[128:129], v20 offset:6144
v_mfma_f32_16x16x32_bf16 v[48:51], v[144:147], a[116:119], v[48:51]
ds_read_b64_tr_b16 v[130:131], v20 offset:7680
buffer_load_dwordx4 v11, s[20:23], s76 offen offset:1024 lds
v_mfma_f32_16x16x32_bf16 v[60:63], v[144:147], a[120:123], v[60:63]
ds_read_b64_tr_b16 v[132:133], v20 offset:6176
v_mfma_f32_16x16x32_bf16 v[72:75], v[144:147], a[124:127], v[72:75]
ds_read_b64_tr_b16 v[134:135], v20 offset:7712
v_mfma_f32_16x16x32_bf16 v[40:43], v[148:151], a[112:115], v[40:43]
ds_read_b64_tr_b16 v[136:137], v20 offset:6208
buffer_load_dwordx4 v12, s[20:23], s76 offen offset:2048 lds
v_mfma_f32_16x16x32_bf16 v[52:55], v[148:151], a[116:119], v[52:55]
ds_read_b64_tr_b16 v[138:139], v20 offset:7744
v_mfma_f32_16x16x32_bf16 v[64:67], v[148:151], a[120:123], v[64:67]
v_mfma_f32_16x16x32_bf16 v[76:79], v[148:151], a[124:127], v[76:79]
s_waitcnt lgkmcnt(0)
v_mfma_f32_16x16x32_bf16 v[32:35], v[128:131], a[128:131], v[32:35]
ds_read_b128 a[144:147], v9 offset:9216
s_add_u32 m0, s62, 6144
v_mfma_f32_16x16x32_bf16 v[44:47], v[128:131], a[132:135], v[44:47]
ds_read_b128 a[148:151], v9 offset:27648
s_add_u32 s76, s60, 4644864
v_mfma_f32_16x16x32_bf16 v[56:59], v[128:131], a[136:139], v[56:59]
ds_read_b128 a[152:155], v5 offset:9216
buffer_load_dwordx4 v10, s[20:23], s76 offen offset:0 lds
v_mfma_f32_16x16x32_bf16 v[68:71], v[128:131], a[140:143], v[68:71]
ds_read_b128 a[156:159], v5 offset:27648
v_mfma_f32_16x16x32_bf16 v[36:39], v[132:135], a[128:131], v[36:39]
s_waitcnt vmcnt(13)
ds_read_b64_tr_b16 v[140:141], v20 offset:9216
v_mfma_f32_16x16x32_bf16 v[48:51], v[132:135], a[132:135], v[48:51]
ds_read_b64_tr_b16 v[142:143], v20 offset:10752
buffer_load_dwordx4 v11, s[20:23], s76 offen offset:1024 lds
v_mfma_f32_16x16x32_bf16 v[60:63], v[132:135], a[136:139], v[60:63]
ds_read_b64_tr_b16 v[144:145], v20 offset:9248
v_mfma_f32_16x16x32_bf16 v[72:75], v[132:135], a[140:143], v[72:75]
ds_read_b64_tr_b16 v[146:147], v20 offset:10784
v_mfma_f32_16x16x32_bf16 v[40:43], v[136:139], a[128:131], v[40:43]
ds_read_b64_tr_b16 v[148:149], v20 offset:9280
buffer_load_dwordx4 v12, s[20:23], s76 offen offset:2048 lds
v_mfma_f32_16x16x32_bf16 v[52:55], v[136:139], a[132:135], v[52:55]
ds_read_b64_tr_b16 v[150:151], v20 offset:10816
v_mfma_f32_16x16x32_bf16 v[64:67], v[136:139], a[136:139], v[64:67]
v_mfma_f32_16x16x32_bf16 v[76:79], v[136:139], a[140:143], v[76:79]
s_waitcnt lgkmcnt(0)
v_mfma_f32_16x16x32_bf16 v[32:35], v[140:143], a[144:147], v[32:35]
ds_read_b128 a[160:163], v9 offset:10240
s_add_u32 m0, s62, 9216
v_mfma_f32_16x16x32_bf16 v[44:47], v[140:143], a[148:151], v[44:47]
ds_read_b128 a[164:167], v9 offset:28672
s_add_u32 s76, s60, 4939776
v_mfma_f32_16x16x32_bf16 v[56:59], v[140:143], a[152:155], v[56:59]
ds_read_b128 a[168:171], v5 offset:10240
buffer_load_dwordx4 v10, s[20:23], s76 offen offset:0 lds
v_mfma_f32_16x16x32_bf16 v[68:71], v[140:143], a[156:159], v[68:71]
ds_read_b128 a[172:175], v5 offset:28672
v_mfma_f32_16x16x32_bf16 v[36:39], v[144:147], a[144:147], v[36:39]
s_waitcnt vmcnt(13)
ds_read_b64_tr_b16 v[128:129], v20 offset:12288
v_mfma_f32_16x16x32_bf16 v[48:51], v[144:147], a[148:151], v[48:51]
ds_read_b64_tr_b16 v[130:131], v20 offset:13824
buffer_load_dwordx4 v11, s[20:23], s76 offen offset:1024 lds
v_mfma_f32_16x16x32_bf16 v[60:63], v[144:147], a[152:155], v[60:63]
ds_read_b64_tr_b16 v[132:133], v20 offset:12320
v_mfma_f32_16x16x32_bf16 v[72:75], v[144:147], a[156:159], v[72:75]
ds_read_b64_tr_b16 v[134:135], v20 offset:13856
v_mfma_f32_16x16x32_bf16 v[40:43], v[148:151], a[144:147], v[40:43]
ds_read_b64_tr_b16 v[136:137], v20 offset:12352
buffer_load_dwordx4 v12, s[20:23], s76 offen offset:2048 lds
v_mfma_f32_16x16x32_bf16 v[52:55], v[148:151], a[148:151], v[52:55]
ds_read_b64_tr_b16 v[138:139], v20 offset:13888
v_mfma_f32_16x16x32_bf16 v[64:67], v[148:151], a[152:155], v[64:67]
v_mfma_f32_16x16x32_bf16 v[76:79], v[148:151], a[156:159], v[76:79]
s_waitcnt lgkmcnt(0)
v_mfma_f32_16x16x32_bf16 v[32:35], v[128:131], a[160:163], v[32:35]
ds_read_b128 a[176:179], v9 offset:11264
s_add_u32 m0, s62, 12288
v_mfma_f32_16x16x32_bf16 v[44:47], v[128:131], a[164:167], v[44:47]
ds_read_b128 a[180:183], v9 offset:29696
s_add_u32 s76, s60, 589824
v_mfma_f32_16x16x32_bf16 v[56:59], v[128:131], a[168:171], v[56:59]
ds_read_b128 a[184:187], v5 offset:11264
buffer_load_dwordx4 v13, s[20:23], s76 offen offset:0 lds
v_mfma_f32_16x16x32_bf16 v[68:71], v[128:131], a[172:175], v[68:71]
ds_read_b128 a[188:191], v5 offset:29696
v_mfma_f32_16x16x32_bf16 v[36:39], v[132:135], a[160:163], v[36:39]
s_waitcnt vmcnt(13)
ds_read_b64_tr_b16 v[140:141], v20 offset:15360
v_mfma_f32_16x16x32_bf16 v[48:51], v[132:135], a[164:167], v[48:51]
ds_read_b64_tr_b16 v[142:143], v20 offset:16896
buffer_load_dwordx4 v14, s[20:23], s76 offen offset:1024 lds
v_mfma_f32_16x16x32_bf16 v[60:63], v[132:135], a[168:171], v[60:63]
ds_read_b64_tr_b16 v[144:145], v20 offset:15392
v_mfma_f32_16x16x32_bf16 v[72:75], v[132:135], a[172:175], v[72:75]
ds_read_b64_tr_b16 v[146:147], v20 offset:16928
v_mfma_f32_16x16x32_bf16 v[40:43], v[136:139], a[160:163], v[40:43]
ds_read_b64_tr_b16 v[148:149], v20 offset:15424
buffer_load_dwordx4 v15, s[20:23], s76 offen offset:2048 lds
v_mfma_f32_16x16x32_bf16 v[52:55], v[136:139], a[164:167], v[52:55]
ds_read_b64_tr_b16 v[150:151], v20 offset:16960
v_mfma_f32_16x16x32_bf16 v[64:67], v[136:139], a[168:171], v[64:67]
v_mfma_f32_16x16x32_bf16 v[76:79], v[136:139], a[172:175], v[76:79]
s_waitcnt lgkmcnt(0)
v_mfma_f32_16x16x32_bf16 v[32:35], v[140:143], a[176:179], v[32:35]
ds_read_b128 a[192:195], v9 offset:12288
s_add_u32 m0, s62, 15360
v_mfma_f32_16x16x32_bf16 v[44:47], v[140:143], a[180:183], v[44:47]
ds_read_b128 a[196:199], v9 offset:30720
s_add_u32 s76, s60, 3244032
v_mfma_f32_16x16x32_bf16 v[56:59], v[140:143], a[184:187], v[56:59]
ds_read_b128 a[200:203], v5 offset:12288
buffer_load_dwordx4 v13, s[20:23], s76 offen offset:0 lds
v_mfma_f32_16x16x32_bf16 v[68:71], v[140:143], a[188:191], v[68:71]
ds_read_b128 a[204:207], v5 offset:30720
v_mfma_f32_16x16x32_bf16 v[36:39], v[144:147], a[176:179], v[36:39]
s_waitcnt vmcnt(13)
ds_read_b64_tr_b16 v[128:129], v20 offset:0
v_mfma_f32_16x16x32_bf16 v[48:51], v[144:147], a[180:183], v[48:51]
ds_read_b64_tr_b16 v[130:131], v20 offset:1536
buffer_load_dwordx4 v14, s[20:23], s76 offen offset:1024 lds
v_mfma_f32_16x16x32_bf16 v[60:63], v[144:147], a[184:187], v[60:63]
ds_read_b64_tr_b16 v[132:133], v20 offset:32
v_mfma_f32_16x16x32_bf16 v[72:75], v[144:147], a[188:191], v[72:75]
ds_read_b64_tr_b16 v[134:135], v20 offset:1568
v_mfma_f32_16x16x32_bf16 v[40:43], v[148:151], a[176:179], v[40:43]
ds_read_b64_tr_b16 v[136:137], v20 offset:64
buffer_load_dwordx4 v15, s[20:23], s76 offen offset:2048 lds
v_mfma_f32_16x16x32_bf16 v[52:55], v[148:151], a[180:183], v[52:55]
ds_read_b64_tr_b16 v[138:139], v20 offset:1600
v_mfma_f32_16x16x32_bf16 v[64:67], v[148:151], a[184:187], v[64:67]
v_mfma_f32_16x16x32_bf16 v[76:79], v[148:151], a[188:191], v[76:79]
s_waitcnt lgkmcnt(0)
v_mfma_f32_16x16x32_bf16 v[32:35], v[128:131], a[192:195], v[32:35]
ds_read_b128 a[208:211], v9 offset:13312
s_add_u32 m0, s62, 0
v_mfma_f32_16x16x32_bf16 v[44:47], v[128:131], a[196:199], v[44:47]
ds_read_b128 a[212:215], v9 offset:31744
s_add_u32 s76, s60, 384
v_mfma_f32_16x16x32_bf16 v[56:59], v[128:131], a[200:203], v[56:59]
ds_read_b128 a[216:219], v5 offset:13312
buffer_load_dwordx4 v10, s[20:23], s76 offen offset:0 lds
v_mfma_f32_16x16x32_bf16 v[68:71], v[128:131], a[204:207], v[68:71]
ds_read_b128 a[220:223], v5 offset:31744
v_mfma_f32_16x16x32_bf16 v[36:39], v[132:135], a[192:195], v[36:39]
s_waitcnt vmcnt(13)
ds_read_b64_tr_b16 v[140:141], v20 offset:3072
v_mfma_f32_16x16x32_bf16 v[48:51], v[132:135], a[196:199], v[48:51]
ds_read_b64_tr_b16 v[142:143], v20 offset:4608
buffer_load_dwordx4 v11, s[20:23], s76 offen offset:1024 lds
v_mfma_f32_16x16x32_bf16 v[60:63], v[132:135], a[200:203], v[60:63]
ds_read_b64_tr_b16 v[144:145], v20 offset:3104
v_mfma_f32_16x16x32_bf16 v[72:75], v[132:135], a[204:207], v[72:75]
ds_read_b64_tr_b16 v[146:147], v20 offset:4640
v_mfma_f32_16x16x32_bf16 v[40:43], v[136:139], a[192:195], v[40:43]
ds_read_b64_tr_b16 v[148:149], v20 offset:3136
buffer_load_dwordx4 v12, s[20:23], s76 offen offset:2048 lds
v_mfma_f32_16x16x32_bf16 v[52:55], v[136:139], a[196:199], v[52:55]
ds_read_b64_tr_b16 v[150:151], v20 offset:4672
v_mfma_f32_16x16x32_bf16 v[64:67], v[136:139], a[200:203], v[64:67]
v_mfma_f32_16x16x32_bf16 v[76:79], v[136:139], a[204:207], v[76:79]
s_waitcnt lgkmcnt(0)
v_mfma_f32_16x16x32_bf16 v[32:35], v[140:143], a[208:211], v[32:35]
ds_read_b128 a[224:227], v9 offset:14336
s_add_u32 m0, s62, 3072
v_mfma_f32_16x16x32_bf16 v[44:47], v[140:143], a[212:215], v[44:47]
ds_read_b128 a[228:231], v9 offset:32768
s_add_u32 s76, s60, 295296
v_mfma_f32_16x16x32_bf16 v[56:59], v[140:143], a[216:219], v[56:59]
ds_read_b128 a[232:235], v5 offset:14336
buffer_load_dwordx4 v10, s[20:23], s76 offen offset:0 lds
v_mfma_f32_16x16x32_bf16 v[68:71], v[140:143], a[220:223], v[68:71]
ds_read_b128 a[236:239], v5 offset:32768
v_mfma_f32_16x16x32_bf16 v[36:39], v[144:147], a[208:211], v[36:39]
s_waitcnt vmcnt(13)
ds_read_b64_tr_b16 v[128:129], v20 offset:6144
v_mfma_f32_16x16x32_bf16 v[48:51], v[144:147], a[212:215], v[48:51]
ds_read_b64_tr_b16 v[130:131], v20 offset:7680
buffer_load_dwordx4 v11, s[20:23], s76 offen offset:1024 lds
v_mfma_f32_16x16x32_bf16 v[60:63], v[144:147], a[216:219], v[60:63]
ds_read_b64_tr_b16 v[132:133], v20 offset:6176
v_mfma_f32_16x16x32_bf16 v[72:75], v[144:147], a[220:223], v[72:75]
ds_read_b64_tr_b16 v[134:135], v20 offset:7712
v_mfma_f32_16x16x32_bf16 v[40:43], v[148:151], a[208:211], v[40:43]
ds_read_b64_tr_b16 v[136:137], v20 offset:6208
buffer_load_dwordx4 v12, s[20:23], s76 offen offset:2048 lds
v_mfma_f32_16x16x32_bf16 v[52:55], v[148:151], a[212:215], v[52:55]
ds_read_b64_tr_b16 v[138:139], v20 offset:7744
v_mfma_f32_16x16x32_bf16 v[64:67], v[148:151], a[216:219], v[64:67]
v_mfma_f32_16x16x32_bf16 v[76:79], v[148:151], a[220:223], v[76:79]
s_waitcnt lgkmcnt(0)
v_mfma_f32_16x16x32_bf16 v[32:35], v[128:131], a[224:227], v[32:35]
ds_read_b128 a[240:243], v9 offset:15360
s_add_u32 m0, s62, 6144
v_mfma_f32_16x16x32_bf16 v[44:47], v[128:131], a[228:231], v[44:47]
ds_read_b128 a[244:247], v9 offset:33792
s_add_u32 s76, s60, 663936
v_mfma_f32_16x16x32_bf16 v[56:59], v[128:131], a[232:235], v[56:59]
ds_read_b128 a[248:251], v5 offset:15360
buffer_load_dwordx4 v10, s[20:23], s76 offen offset:0 lds
v_mfma_f32_16x16x32_bf16 v[68:71], v[128:131], a[236:239], v[68:71]
ds_read_b128 a[252:255], v5 offset:33792
v_mfma_f32_16x16x32_bf16 v[36:39], v[132:135], a[224:227], v[36:39]
s_waitcnt vmcnt(13)
ds_read_b64_tr_b16 v[140:141], v20 offset:9216
v_mfma_f32_16x16x32_bf16 v[48:51], v[132:135], a[228:231], v[48:51]
ds_read_b64_tr_b16 v[142:143], v20 offset:10752
buffer_load_dwordx4 v11, s[20:23], s76 offen offset:1024 lds
v_mfma_f32_16x16x32_bf16 v[60:63], v[132:135], a[232:235], v[60:63]
ds_read_b64_tr_b16 v[144:145], v20 offset:9248
v_mfma_f32_16x16x32_bf16 v[72:75], v[132:135], a[236:239], v[72:75]
ds_read_b64_tr_b16 v[146:147], v20 offset:10784
v_mfma_f32_16x16x32_bf16 v[40:43], v[136:139], a[224:227], v[40:43]
ds_read_b64_tr_b16 v[148:149], v20 offset:9280
buffer_load_dwordx4 v12, s[20:23], s76 offen offset:2048 lds
v_mfma_f32_16x16x32_bf16 v[52:55], v[136:139], a[228:231], v[52:55]
ds_read_b64_tr_b16 v[150:151], v20 offset:10816
v_mfma_f32_16x16x32_bf16 v[64:67], v[136:139], a[232:235], v[64:67]
v_mfma_f32_16x16x32_bf16 v[76:79], v[136:139], a[236:239], v[76:79]
s_waitcnt lgkmcnt(0)
v_mfma_f32_16x16x32_bf16 v[32:35], v[140:143], a[240:243], v[32:35]
ds_read_b128 v[224:227], v9 offset:16384
s_add_u32 m0, s62, 9216
v_mfma_f32_16x16x32_bf16 v[44:47], v[140:143], a[244:247], v[44:47]
ds_read_b128 v[228:231], v9 offset:34816
s_add_u32 s76, s60, 958848
v_mfma_f32_16x16x32_bf16 v[56:59], v[140:143], a[248:251], v[56:59]
ds_read_b128 v[232:235], v5 offset:16384
buffer_load_dwordx4 v10, s[20:23], s76 offen offset:0 lds
v_mfma_f32_16x16x32_bf16 v[68:71], v[140:143], a[252:255], v[68:71]
ds_read_b128 v[236:239], v5 offset:34816
v_mfma_f32_16x16x32_bf16 v[36:39], v[144:147], a[240:243], v[36:39]
s_waitcnt vmcnt(13)
ds_read_b64_tr_b16 v[128:129], v20 offset:12288
v_mfma_f32_16x16x32_bf16 v[48:51], v[144:147], a[244:247], v[48:51]
ds_read_b64_tr_b16 v[130:131], v20 offset:13824
buffer_load_dwordx4 v11, s[20:23], s76 offen offset:1024 lds
v_mfma_f32_16x16x32_bf16 v[60:63], v[144:147], a[248:251], v[60:63]
ds_read_b64_tr_b16 v[132:133], v20 offset:12320
v_mfma_f32_16x16x32_bf16 v[72:75], v[144:147], a[252:255], v[72:75]
ds_read_b64_tr_b16 v[134:135], v20 offset:13856
v_mfma_f32_16x16x32_bf16 v[40:43], v[148:151], a[240:243], v[40:43]
ds_read_b64_tr_b16 v[136:137], v20 offset:12352
buffer_load_dwordx4 v12, s[20:23], s76 offen offset:2048 lds
v_mfma_f32_16x16x32_bf16 v[52:55], v[148:151], a[244:247], v[52:55]
ds_read_b64_tr_b16 v[138:139], v20 offset:13888
v_mfma_f32_16x16x32_bf16 v[64:67], v[148:151], a[248:251], v[64:67]
v_mfma_f32_16x16x32_bf16 v[76:79], v[148:151], a[252:255], v[76:79]
s_waitcnt lgkmcnt(0)
v_mfma_f32_16x16x32_bf16 v[32:35], v[128:131], v[224:227], v[32:35]
ds_read_b128 v[240:243], v9 offset:17408
s_add_u32 m0, s62, 12288
v_mfma_f32_16x16x32_bf16 v[44:47], v[128:131], v[228:231], v[44:47]
ds_read_b128 v[244:247], v9 offset:35840
s_add_u32 s76, s60, 1327488
v_mfma_f32_16x16x32_bf16 v[56:59], v[128:131], v[232:235], v[56:59]
ds_read_b128 v[248:251], v5 offset:17408
buffer_load_dwordx4 v10, s[20:23], s76 offen offset:0 lds
v_mfma_f32_16x16x32_bf16 v[68:71], v[128:131], v[236:239], v[68:71]
ds_read_b128 v[252:255], v5 offset:35840
v_mfma_f32_16x16x32_bf16 v[36:39], v[132:135], v[224:227], v[36:39]
s_waitcnt vmcnt(13)
ds_read_b64_tr_b16 v[140:141], v20 offset:15360
v_mfma_f32_16x16x32_bf16 v[48:51], v[132:135], v[228:231], v[48:51]
ds_read_b64_tr_b16 v[142:143], v20 offset:16896
buffer_load_dwordx4 v11, s[20:23], s76 offen offset:1024 lds
v_mfma_f32_16x16x32_bf16 v[60:63], v[132:135], v[232:235], v[60:63]
ds_read_b64_tr_b16 v[144:145], v20 offset:15392
v_mfma_f32_16x16x32_bf16 v[72:75], v[132:135], v[236:239], v[72:75]
ds_read_b64_tr_b16 v[146:147], v20 offset:16928
v_mfma_f32_16x16x32_bf16 v[40:43], v[136:139], v[224:227], v[40:43]
ds_read_b64_tr_b16 v[148:149], v20 offset:15424
buffer_load_dwordx4 v12, s[20:23], s76 offen offset:2048 lds
v_mfma_f32_16x16x32_bf16 v[52:55], v[136:139], v[228:231], v[52:55]
ds_read_b64_tr_b16 v[150:151], v20 offset:16960
v_mfma_f32_16x16x32_bf16 v[64:67], v[136:139], v[232:235], v[64:67]
v_mfma_f32_16x16x32_bf16 v[76:79], v[136:139], v[236:239], v[76:79]
s_waitcnt lgkmcnt(0)
v_mfma_f32_16x16x32_bf16 v[32:35], v[140:143], v[240:243], v[32:35]
s_waitcnt vmcnt(12)
s_add_u32 m0, s62, 15360
v_mfma_f32_16x16x32_bf16 v[44:47], v[140:143], v[244:247], v[44:47]
ds_read_b64_tr_b16 v[128:129], v20 offset:0
s_add_u32 s76, s60, 1622400
v_mfma_f32_16x16x32_bf16 v[56:59], v[140:143], v[248:251], v[56:59]
ds_read_b64_tr_b16 v[130:131], v20 offset:1536
buffer_load_dwordx4 v10, s[20:23], s76 offen offset:0 lds
v_mfma_f32_16x16x32_bf16 v[68:71], v[140:143], v[252:255], v[68:71]
ds_read_b64_tr_b16 v[132:133], v20 offset:32
v_mfma_f32_16x16x32_bf16 v[36:39], v[144:147], v[240:243], v[36:39]
ds_read_b64_tr_b16 v[134:135], v20 offset:1568
buffer_load_dwordx4 v11, s[20:23], s76 offen offset:1024 lds
v_mfma_f32_16x16x32_bf16 v[48:51], v[144:147], v[244:247], v[48:51]
ds_read_b64_tr_b16 v[136:137], v20 offset:64
v_mfma_f32_16x16x32_bf16 v[60:63], v[144:147], v[248:251], v[60:63]
ds_read_b64_tr_b16 v[138:139], v20 offset:1600
v_mfma_f32_16x16x32_bf16 v[72:75], v[144:147], v[252:255], v[72:75]
v_mfma_f32_16x16x32_bf16 v[40:43], v[148:151], v[240:243], v[40:43]
buffer_load_dwordx4 v12, s[20:23], s76 offen offset:2048 lds
v_mfma_f32_16x16x32_bf16 v[52:55], v[148:151], v[244:247], v[52:55]
v_mfma_f32_16x16x32_bf16 v[64:67], v[148:151], v[248:251], v[64:67]
v_mfma_f32_16x16x32_bf16 v[76:79], v[148:151], v[252:255], v[76:79]
s_waitcnt lgkmcnt(0)
s_waitcnt lgkmcnt(0)
s_barrier
v_mfma_f32_16x16x32_bf16 v[80:83], v[128:131], a[0:3], 0
s_waitcnt vmcnt(12)
v_cvt_pk_bf16_f32 v32, v32, v33
v_cvt_pk_bf16_f32 v33, v34, v35
v_mfma_f32_16x16x32_bf16 v[92:95], v[128:131], a[4:7], 0
ds_read_b64_tr_b16 v[140:141], v20 offset:3072
v_pk_max_i16 v32, v32, 0
v_pk_max_i16 v33, v33, 0
v_mfma_f32_16x16x32_bf16 v[104:107], v[128:131], a[8:11], 0
ds_read_b64_tr_b16 v[142:143], v20 offset:4608
s_add_u32 m0, s62, 0
s_add_u32 s76, s60, 1991040
v_mfma_f32_16x16x32_bf16 v[116:119], v[128:131], a[12:15], 0
ds_read_b64_tr_b16 v[144:145], v20 offset:3104
buffer_load_dwordx4 v10, s[20:23], s76 offen offset:0 lds
v_cvt_pk_bf16_f32 v34, v36, v37
v_mfma_f32_16x16x32_bf16 v[84:87], v[132:135], a[0:3], 0
ds_read_b64_tr_b16 v[146:147], v20 offset:4640
v_cvt_pk_bf16_f32 v35, v38, v39
v_pk_max_i16 v34, v34, 0
v_mfma_f32_16x16x32_bf16 v[96:99], v[132:135], a[4:7], 0
ds_read_b64_tr_b16 v[148:149], v20 offset:3136
v_pk_max_i16 v35, v35, 0
v_mfma_f32_16x16x32_bf16 v[108:111], v[132:135], a[8:11], 0
ds_read_b64_tr_b16 v[150:151], v20 offset:4672
buffer_load_dwordx4 v11, s[20:23], s76 offen offset:1024 lds
v_mfma_f32_16x16x32_bf16 v[120:123], v[132:135], a[12:15], 0
buffer_load_dwordx4 v12, s[20:23], s76 offen offset:2048 lds
v_mfma_f32_16x16x32_bf16 v[88:91], v[136:139], a[0:3], 0
ds_write_b128 v22, v[32:35] offset:0
v_cvt_pk_bf16_f32 v40, v40, v41
v_mfma_f32_16x16x32_bf16 v[100:103], v[136:139], a[4:7], 0
v_cvt_pk_bf16_f32 v41, v42, v43
v_pk_max_i16 v40, v40, 0
v_mfma_f32_16x16x32_bf16 v[112:115], v[136:139], a[8:11], 0
v_pk_max_i16 v41, v41, 0
v_mfma_f32_16x16x32_bf16 v[124:127], v[136:139], a[12:15], 0
ds_write_b64 v23, v[40:41] offset:0
s_waitcnt lgkmcnt(2)
v_mfma_f32_16x16x32_bf16 v[80:83], v[140:143], a[16:19], v[80:83]
s_waitcnt vmcnt(12)
v_cvt_pk_bf16_f32 v44, v44, v45
v_cvt_pk_bf16_f32 v45, v46, v47
v_mfma_f32_16x16x32_bf16 v[92:95], v[140:143], a[20:23], v[92:95]
ds_read_b64_tr_b16 v[128:129], v20 offset:6144
v_pk_max_i16 v44, v44, 0
v_pk_max_i16 v45, v45, 0
v_mfma_f32_16x16x32_bf16 v[104:107], v[140:143], a[24:27], v[104:107]
ds_read_b64_tr_b16 v[130:131], v20 offset:7680
s_add_u32 m0, s62, 3072
s_add_u32 s76, s60, 2285952
v_mfma_f32_16x16x32_bf16 v[116:119], v[140:143], a[28:31], v[116:119]
ds_read_b64_tr_b16 v[132:133], v20 offset:6176
buffer_load_dwordx4 v10, s[20:23], s76 offen offset:0 lds
v_cvt_pk_bf16_f32 v46, v48, v49
v_mfma_f32_16x16x32_bf16 v[84:87], v[144:147], a[16:19], v[84:87]
ds_read_b64_tr_b16 v[134:135], v20 offset:7712
v_cvt_pk_bf16_f32 v47, v50, v51
v_pk_max_i16 v46, v46, 0
v_mfma_f32_16x16x32_bf16 v[96:99], v[144:147], a[20:23], v[96:99]
ds_read_b64_tr_b16 v[136:137], v20 offset:6208
v_pk_max_i16 v47, v47, 0
v_mfma_f32_16x16x32_bf16 v[108:111], v[144:147], a[24:27], v[108:111]
ds_read_b64_tr_b16 v[138:139], v20 offset:7744
buffer_load_dwordx4 v11, s[20:23], s76 offen offset:1024 lds
v_mfma_f32_16x16x32_bf16 v[120:123], v[144:147], a[28:31], v[120:123]
buffer_load_dwordx4 v12, s[20:23], s76 offen offset:2048 lds
v_mfma_f32_16x16x32_bf16 v[88:91], v[148:151], a[16:19], v[88:91]
ds_write_b128 v22, v[44:47] offset:18432
v_cvt_pk_bf16_f32 v52, v52, v53
v_mfma_f32_16x16x32_bf16 v[100:103], v[148:151], a[20:23], v[100:103]
v_cvt_pk_bf16_f32 v53, v54, v55
v_pk_max_i16 v52, v52, 0
v_mfma_f32_16x16x32_bf16 v[112:115], v[148:151], a[24:27], v[112:115]
v_pk_max_i16 v53, v53, 0
v_mfma_f32_16x16x32_bf16 v[124:127], v[148:151], a[28:31], v[124:127]
ds_write_b64 v23, v[52:53] offset:18432
s_waitcnt lgkmcnt(2)
v_mfma_f32_16x16x32_bf16 v[80:83], v[128:131], a[32:35], v[80:83]
s_waitcnt vmcnt(12)
v_cvt_pk_bf16_f32 v56, v56, v57
v_cvt_pk_bf16_f32 v57, v58, v59
v_mfma_f32_16x16x32_bf16 v[92:95], v[128:131], a[36:39], v[92:95]
ds_read_b64_tr_b16 v[140:141], v20 offset:9216
v_pk_max_i16 v56, v56, 0
v_pk_max_i16 v57, v57, 0
v_mfma_f32_16x16x32_bf16 v[104:107], v[128:131], a[40:43], v[104:107]
ds_read_b64_tr_b16 v[142:143], v20 offset:10752
s_add_u32 m0, s62, 6144
s_add_u32 s76, s60, 2654592
v_mfma_f32_16x16x32_bf16 v[116:119], v[128:131], a[44:47], v[116:119]
ds_read_b64_tr_b16 v[144:145], v20 offset:9248
buffer_load_dwordx4 v10, s[20:23], s76 offen offset:0 lds
v_cvt_pk_bf16_f32 v58, v60, v61
v_mfma_f32_16x16x32_bf16 v[84:87], v[132:135], a[32:35], v[84:87]
ds_read_b64_tr_b16 v[146:147], v20 offset:10784
v_cvt_pk_bf16_f32 v59, v62, v63
v_pk_max_i16 v58, v58, 0
v_mfma_f32_16x16x32_bf16 v[96:99], v[132:135], a[36:39], v[96:99]
ds_read_b64_tr_b16 v[148:149], v20 offset:9280
v_pk_max_i16 v59, v59, 0
v_mfma_f32_16x16x32_bf16 v[108:111], v[132:135], a[40:43], v[108:111]
ds_read_b64_tr_b16 v[150:151], v20 offset:10816
buffer_load_dwordx4 v11, s[20:23], s76 offen offset:1024 lds
v_mfma_f32_16x16x32_bf16 v[120:123], v[132:135], a[44:47], v[120:123]
buffer_load_dwordx4 v12, s[20:23], s76 offen offset:2048 lds
v_mfma_f32_16x16x32_bf16 v[88:91], v[136:139], a[32:35], v[88:91]
ds_write_b128 v24, v[56:59] offset:0
v_cvt_pk_bf16_f32 v64, v64, v65
v_mfma_f32_16x16x32_bf16 v[100:103], v[136:139], a[36:39], v[100:103]
v_cvt_pk_bf16_f32 v65, v66, v67
v_pk_max_i16 v64, v64, 0
v_mfma_f32_16x16x32_bf16 v[112:115], v[136:139], a[40:43], v[112:115]
v_pk_max_i16 v65, v65, 0
v_mfma_f32_16x16x32_bf16 v[124:127], v[136:139], a[44:47], v[124:127]
ds_write_b64 v25, v[64:65] offset:0
s_waitcnt lgkmcnt(2)
v_mfma_f32_16x16x32_bf16 v[80:83], v[140:143], a[48:51], v[80:83]
s_waitcnt vmcnt(12)
v_cvt_pk_bf16_f32 v68, v68, v69
v_cvt_pk_bf16_f32 v69, v70, v71
v_mfma_f32_16x16x32_bf16 v[92:95], v[140:143], a[52:55], v[92:95]
ds_read_b64_tr_b16 v[128:129], v20 offset:12288
v_pk_max_i16 v68, v68, 0
v_pk_max_i16 v69, v69, 0
v_mfma_f32_16x16x32_bf16 v[104:107], v[140:143], a[56:59], v[104:107]
ds_read_b64_tr_b16 v[130:131], v20 offset:13824
s_add_u32 m0, s62, 9216
s_add_u32 s76, s60, 2949504
v_mfma_f32_16x16x32_bf16 v[116:119], v[140:143], a[60:63], v[116:119]
ds_read_b64_tr_b16 v[132:133], v20 offset:12320
buffer_load_dwordx4 v10, s[20:23], s76 offen offset:0 lds
v_cvt_pk_bf16_f32 v70, v72, v73
v_mfma_f32_16x16x32_bf16 v[84:87], v[144:147], a[48:51], v[84:87]
ds_read_b64_tr_b16 v[134:135], v20 offset:13856
v_cvt_pk_bf16_f32 v71, v74, v75
v_pk_max_i16 v70, v70, 0
v_mfma_f32_16x16x32_bf16 v[96:99], v[144:147], a[52:55], v[96:99]
ds_read_b64_tr_b16 v[136:137], v20 offset:12352
v_pk_max_i16 v71, v71, 0
v_mfma_f32_16x16x32_bf16 v[108:111], v[144:147], a[56:59], v[108:111]
ds_read_b64_tr_b16 v[138:139], v20 offset:13888
buffer_load_dwordx4 v11, s[20:23], s76 offen offset:1024 lds
v_mfma_f32_16x16x32_bf16 v[120:123], v[144:147], a[60:63], v[120:123]
buffer_load_dwordx4 v12, s[20:23], s76 offen offset:2048 lds
v_mfma_f32_16x16x32_bf16 v[88:91], v[148:151], a[48:51], v[88:91]
ds_write_b128 v24, v[68:71] offset:18432
v_cvt_pk_bf16_f32 v76, v76, v77
v_mfma_f32_16x16x32_bf16 v[100:103], v[148:151], a[52:55], v[100:103]
v_cvt_pk_bf16_f32 v77, v78, v79
v_pk_max_i16 v76, v76, 0
v_mfma_f32_16x16x32_bf16 v[112:115], v[148:151], a[56:59], v[112:115]
v_pk_max_i16 v77, v77, 0
v_mfma_f32_16x16x32_bf16 v[124:127], v[148:151], a[60:63], v[124:127]
ds_write_b64 v25, v[76:77] offset:18432
s_waitcnt lgkmcnt(2)
v_mfma_f32_16x16x32_bf16 v[80:83], v[128:131], a[64:67], v[80:83]
s_waitcnt vmcnt(12)
s_add_u32 m0, s62, 12288
v_mfma_f32_16x16x32_bf16 v[92:95], v[128:131], a[68:71], v[92:95]
ds_read_b64_tr_b16 v[140:141], v20 offset:15360
s_add_u32 s76, s60, 3318144
v_mfma_f32_16x16x32_bf16 v[104:107], v[128:131], a[72:75], v[104:107]
ds_read_b64_tr_b16 v[142:143], v20 offset:16896
buffer_load_dwordx4 v10, s[20:23], s76 offen offset:0 lds
v_mfma_f32_16x16x32_bf16 v[116:119], v[128:131], a[76:79], v[116:119]
ds_read_b64_tr_b16 v[144:145], v20 offset:15392
v_mfma_f32_16x16x32_bf16 v[84:87], v[132:135], a[64:67], v[84:87]
ds_read_b64_tr_b16 v[146:147], v20 offset:16928
buffer_load_dwordx4 v11, s[20:23], s76 offen offset:1024 lds
v_mfma_f32_16x16x32_bf16 v[96:99], v[132:135], a[68:71], v[96:99]
ds_read_b64_tr_b16 v[148:149], v20 offset:15424
v_mfma_f32_16x16x32_bf16 v[108:111], v[132:135], a[72:75], v[108:111]
ds_read_b64_tr_b16 v[150:151], v20 offset:16960
v_mfma_f32_16x16x32_bf16 v[120:123], v[132:135], a[76:79], v[120:123]
v_mfma_f32_16x16x32_bf16 v[88:91], v[136:139], a[64:67], v[88:91]
buffer_load_dwordx4 v12, s[20:23], s76 offen offset:2048 lds
v_mfma_f32_16x16x32_bf16 v[100:103], v[136:139], a[68:71], v[100:103]
v_mfma_f32_16x16x32_bf16 v[112:115], v[136:139], a[72:75], v[112:115]
v_mfma_f32_16x16x32_bf16 v[124:127], v[136:139], a[76:79], v[124:127]
s_waitcnt lgkmcnt(0)
v_mfma_f32_16x16x32_bf16 v[80:83], v[140:143], a[80:83], v[80:83]
s_waitcnt vmcnt(12)
s_add_u32 m0, s62, 15360
v_mfma_f32_16x16x32_bf16 v[92:95], v[140:143], a[84:87], v[92:95]
ds_read_b64_tr_b16 v[128:129], v20 offset:0
s_add_u32 s76, s60, 3613056
v_mfma_f32_16x16x32_bf16 v[104:107], v[140:143], a[88:91], v[104:107]
ds_read_b64_tr_b16 v[130:131], v20 offset:1536
buffer_load_dwordx4 v10, s[20:23], s76 offen offset:0 lds
v_mfma_f32_16x16x32_bf16 v[116:119], v[140:143], a[92:95], v[116:119]
ds_read_b64_tr_b16 v[132:133], v20 offset:32
v_mfma_f32_16x16x32_bf16 v[84:87], v[144:147], a[80:83], v[84:87]
ds_read_b64_tr_b16 v[134:135], v20 offset:1568
buffer_load_dwordx4 v11, s[20:23], s76 offen offset:1024 lds
v_mfma_f32_16x16x32_bf16 v[96:99], v[144:147], a[84:87], v[96:99]
ds_read_b64_tr_b16 v[136:137], v20 offset:64
v_mfma_f32_16x16x32_bf16 v[108:111], v[144:147], a[88:91], v[108:111]
ds_read_b64_tr_b16 v[138:139], v20 offset:1600
v_mfma_f32_16x16x32_bf16 v[120:123], v[144:147], a[92:95], v[120:123]
v_mfma_f32_16x16x32_bf16 v[88:91], v[148:151], a[80:83], v[88:91]
buffer_load_dwordx4 v12, s[20:23], s76 offen offset:2048 lds
v_mfma_f32_16x16x32_bf16 v[100:103], v[148:151], a[84:87], v[100:103]
v_mfma_f32_16x16x32_bf16 v[112:115], v[148:151], a[88:91], v[112:115]
v_mfma_f32_16x16x32_bf16 v[124:127], v[148:151], a[92:95], v[124:127]
s_waitcnt lgkmcnt(0)
v_mfma_f32_16x16x32_bf16 v[80:83], v[128:131], a[96:99], v[80:83]
s_waitcnt vmcnt(12)
s_add_u32 m0, s62, 0
v_mfma_f32_16x16x32_bf16 v[92:95], v[128:131], a[100:103], v[92:95]
ds_read_b64_tr_b16 v[140:141], v20 offset:3072
s_add_u32 s76, s60, 3981696
v_mfma_f32_16x16x32_bf16 v[104:107], v[128:131], a[104:107], v[104:107]
ds_read_b64_tr_b16 v[142:143], v20 offset:4608
buffer_load_dwordx4 v10, s[20:23], s76 offen offset:0 lds
v_mfma_f32_16x16x32_bf16 v[116:119], v[128:131], a[108:111], v[116:119]
ds_read_b64_tr_b16 v[144:145], v20 offset:3104
v_mfma_f32_16x16x32_bf16 v[84:87], v[132:135], a[96:99], v[84:87]
ds_read_b64_tr_b16 v[146:147], v20 offset:4640
buffer_load_dwordx4 v11, s[20:23], s76 offen offset:1024 lds
v_mfma_f32_16x16x32_bf16 v[96:99], v[132:135], a[100:103], v[96:99]
ds_read_b64_tr_b16 v[148:149], v20 offset:3136
v_mfma_f32_16x16x32_bf16 v[108:111], v[132:135], a[104:107], v[108:111]
ds_read_b64_tr_b16 v[150:151], v20 offset:4672
v_mfma_f32_16x16x32_bf16 v[120:123], v[132:135], a[108:111], v[120:123]
v_mfma_f32_16x16x32_bf16 v[88:91], v[136:139], a[96:99], v[88:91]
buffer_load_dwordx4 v12, s[20:23], s76 offen offset:2048 lds
v_mfma_f32_16x16x32_bf16 v[100:103], v[136:139], a[100:103], v[100:103]
v_mfma_f32_16x16x32_bf16 v[112:115], v[136:139], a[104:107], v[112:115]
v_mfma_f32_16x16x32_bf16 v[124:127], v[136:139], a[108:111], v[124:127]
s_waitcnt lgkmcnt(0)
v_mfma_f32_16x16x32_bf16 v[80:83], v[140:143], a[112:115], v[80:83]
s_waitcnt vmcnt(12)
s_add_u32 m0, s62, 3072
v_mfma_f32_16x16x32_bf16 v[92:95], v[140:143], a[116:119], v[92:95]
ds_read_b64_tr_b16 v[128:129], v20 offset:6144
s_add_u32 s76, s60, 4276608
v_mfma_f32_16x16x32_bf16 v[104:107], v[140:143], a[120:123], v[104:107]
ds_read_b64_tr_b16 v[130:131], v20 offset:7680
buffer_load_dwordx4 v10, s[20:23], s76 offen offset:0 lds
v_mfma_f32_16x16x32_bf16 v[116:119], v[140:143], a[124:127], v[116:119]
ds_read_b64_tr_b16 v[132:133], v20 offset:6176
v_mfma_f32_16x16x32_bf16 v[84:87], v[144:147], a[112:115], v[84:87]
ds_read_b64_tr_b16 v[134:135], v20 offset:7712
buffer_load_dwordx4 v11, s[20:23], s76 offen offset:1024 lds
v_mfma_f32_16x16x32_bf16 v[96:99], v[144:147], a[116:119], v[96:99]
ds_read_b64_tr_b16 v[136:137], v20 offset:6208
v_mfma_f32_16x16x32_bf16 v[108:111], v[144:147], a[120:123], v[108:111]
ds_read_b64_tr_b16 v[138:139], v20 offset:7744
v_mfma_f32_16x16x32_bf16 v[120:123], v[144:147], a[124:127], v[120:123]
v_mfma_f32_16x16x32_bf16 v[88:91], v[148:151], a[112:115], v[88:91]
buffer_load_dwordx4 v12, s[20:23], s76 offen offset:2048 lds
v_mfma_f32_16x16x32_bf16 v[100:103], v[148:151], a[116:119], v[100:103]
v_mfma_f32_16x16x32_bf16 v[112:115], v[148:151], a[120:123], v[112:115]
v_mfma_f32_16x16x32_bf16 v[124:127], v[148:151], a[124:127], v[124:127]
s_waitcnt lgkmcnt(0)
v_mfma_f32_16x16x32_bf16 v[80:83], v[128:131], a[128:131], v[80:83]
s_waitcnt vmcnt(12)
s_add_u32 m0, s62, 6144
v_mfma_f32_16x16x32_bf16 v[92:95], v[128:131], a[132:135], v[92:95]
ds_read_b64_tr_b16 v[140:141], v20 offset:9216
s_add_u32 s76, s60, 4645248
v_mfma_f32_16x16x32_bf16 v[104:107], v[128:131], a[136:139], v[104:107]
ds_read_b64_tr_b16 v[142:143], v20 offset:10752
buffer_load_dwordx4 v10, s[20:23], s76 offen offset:0 lds
v_mfma_f32_16x16x32_bf16 v[116:119], v[128:131], a[140:143], v[116:119]
ds_read_b64_tr_b16 v[144:145], v20 offset:9248
v_mfma_f32_16x16x32_bf16 v[84:87], v[132:135], a[128:131], v[84:87]
ds_read_b64_tr_b16 v[146:147], v20 offset:10784
buffer_load_dwordx4 v11, s[20:23], s76 offen offset:1024 lds
v_mfma_f32_16x16x32_bf16 v[96:99], v[132:135], a[132:135], v[96:99]
ds_read_b64_tr_b16 v[148:149], v20 offset:9280
v_mfma_f32_16x16x32_bf16 v[108:111], v[132:135], a[136:139], v[108:111]
ds_read_b64_tr_b16 v[150:151], v20 offset:10816
v_mfma_f32_16x16x32_bf16 v[120:123], v[132:135], a[140:143], v[120:123]
v_mfma_f32_16x16x32_bf16 v[88:91], v[136:139], a[128:131], v[88:91]
buffer_load_dwordx4 v12, s[20:23], s76 offen offset:2048 lds
v_mfma_f32_16x16x32_bf16 v[100:103], v[136:139], a[132:135], v[100:103]
v_mfma_f32_16x16x32_bf16 v[112:115], v[136:139], a[136:139], v[112:115]
v_mfma_f32_16x16x32_bf16 v[124:127], v[136:139], a[140:143], v[124:127]
s_waitcnt lgkmcnt(0)
v_mfma_f32_16x16x32_bf16 v[80:83], v[140:143], a[144:147], v[80:83]
s_waitcnt vmcnt(12)
s_add_u32 m0, s62, 9216
v_mfma_f32_16x16x32_bf16 v[92:95], v[140:143], a[148:151], v[92:95]
ds_read_b64_tr_b16 v[128:129], v20 offset:12288
s_add_u32 s76, s60, 4940160
v_mfma_f32_16x16x32_bf16 v[104:107], v[140:143], a[152:155], v[104:107]
ds_read_b64_tr_b16 v[130:131], v20 offset:13824
buffer_load_dwordx4 v10, s[20:23], s76 offen offset:0 lds
v_mfma_f32_16x16x32_bf16 v[116:119], v[140:143], a[156:159], v[116:119]
ds_read_b64_tr_b16 v[132:133], v20 offset:12320
v_mfma_f32_16x16x32_bf16 v[84:87], v[144:147], a[144:147], v[84:87]
ds_read_b64_tr_b16 v[134:135], v20 offset:13856
buffer_load_dwordx4 v11, s[20:23], s76 offen offset:1024 lds
v_mfma_f32_16x16x32_bf16 v[96:99], v[144:147], a[148:151], v[96:99]
ds_read_b64_tr_b16 v[136:137], v20 offset:12352
v_mfma_f32_16x16x32_bf16 v[108:111], v[144:147], a[152:155], v[108:111]
ds_read_b64_tr_b16 v[138:139], v20 offset:13888
v_mfma_f32_16x16x32_bf16 v[120:123], v[144:147], a[156:159], v[120:123]
v_mfma_f32_16x16x32_bf16 v[88:91], v[148:151], a[144:147], v[88:91]
buffer_load_dwordx4 v12, s[20:23], s76 offen offset:2048 lds
v_mfma_f32_16x16x32_bf16 v[100:103], v[148:151], a[148:151], v[100:103]
v_mfma_f32_16x16x32_bf16 v[112:115], v[148:151], a[152:155], v[112:115]
v_mfma_f32_16x16x32_bf16 v[124:127], v[148:151], a[156:159], v[124:127]
s_waitcnt lgkmcnt(0)
v_mfma_f32_16x16x32_bf16 v[80:83], v[128:131], a[160:163], v[80:83]
s_waitcnt vmcnt(12)
s_add_u32 m0, s62, 12288
v_mfma_f32_16x16x32_bf16 v[92:95], v[128:131], a[164:167], v[92:95]
ds_read_b64_tr_b16 v[140:141], v20 offset:15360
s_add_u32 s76, s60, 590208
v_mfma_f32_16x16x32_bf16 v[104:107], v[128:131], a[168:171], v[104:107]
ds_read_b64_tr_b16 v[142:143], v20 offset:16896
buffer_load_dwordx4 v13, s[20:23], s76 offen offset:0 lds
v_mfma_f32_16x16x32_bf16 v[116:119], v[128:131], a[172:175], v[116:119]
ds_read_b64_tr_b16 v[144:145], v20 offset:15392
v_mfma_f32_16x16x32_bf16 v[84:87], v[132:135], a[160:163], v[84:87]
ds_read_b64_tr_b16 v[146:147], v20 offset:16928
buffer_load_dwordx4 v14, s[20:23], s76 offen offset:1024 lds
v_mfma_f32_16x16x32_bf16 v[96:99], v[132:135], a[164:167], v[96:99]
ds_read_b64_tr_b16 v[148:149], v20 offset:15424
v_mfma_f32_16x16x32_bf16 v[108:111], v[132:135], a[168:171], v[108:111]
ds_read_b64_tr_b16 v[150:151], v20 offset:16960
v_mfma_f32_16x16x32_bf16 v[120:123], v[132:135], a[172:175], v[120:123]
v_mfma_f32_16x16x32_bf16 v[88:91], v[136:139], a[160:163], v[88:91]
buffer_load_dwordx4 v15, s[20:23], s76 offen offset:2048 lds
v_mfma_f32_16x16x32_bf16 v[100:103], v[136:139], a[164:167], v[100:103]
v_mfma_f32_16x16x32_bf16 v[112:115], v[136:139], a[168:171], v[112:115]
v_mfma_f32_16x16x32_bf16 v[124:127], v[136:139], a[172:175], v[124:127]
s_waitcnt lgkmcnt(0)
v_mfma_f32_16x16x32_bf16 v[80:83], v[140:143], a[176:179], v[80:83]
s_waitcnt vmcnt(12)
s_add_u32 m0, s62, 15360
v_mfma_f32_16x16x32_bf16 v[92:95], v[140:143], a[180:183], v[92:95]
ds_read_b64_tr_b16 v[128:129], v20 offset:0
s_add_u32 s76, s60, 3244416
v_mfma_f32_16x16x32_bf16 v[104:107], v[140:143], a[184:187], v[104:107]
ds_read_b64_tr_b16 v[130:131], v20 offset:1536
buffer_load_dwordx4 v13, s[20:23], s76 offen offset:0 lds
v_mfma_f32_16x16x32_bf16 v[116:119], v[140:143], a[188:191], v[116:119]
ds_read_b64_tr_b16 v[132:133], v20 offset:32
v_mfma_f32_16x16x32_bf16 v[84:87], v[144:147], a[176:179], v[84:87]
ds_read_b64_tr_b16 v[134:135], v20 offset:1568
buffer_load_dwordx4 v14, s[20:23], s76 offen offset:1024 lds
v_mfma_f32_16x16x32_bf16 v[96:99], v[144:147], a[180:183], v[96:99]
ds_read_b64_tr_b16 v[136:137], v20 offset:64
v_mfma_f32_16x16x32_bf16 v[108:111], v[144:147], a[184:187], v[108:111]
ds_read_b64_tr_b16 v[138:139], v20 offset:1600
v_mfma_f32_16x16x32_bf16 v[120:123], v[144:147], a[188:191], v[120:123]
v_mfma_f32_16x16x32_bf16 v[88:91], v[148:151], a[176:179], v[88:91]
buffer_load_dwordx4 v15, s[20:23], s76 offen offset:2048 lds
v_mfma_f32_16x16x32_bf16 v[100:103], v[148:151], a[180:183], v[100:103]
v_mfma_f32_16x16x32_bf16 v[112:115], v[148:151], a[184:187], v[112:115]
v_mfma_f32_16x16x32_bf16 v[124:127], v[148:151], a[188:191], v[124:127]
s_waitcnt lgkmcnt(0)
v_mfma_f32_16x16x32_bf16 v[80:83], v[128:131], a[192:195], v[80:83]
s_waitcnt vmcnt(12)
s_add_u32 m0, s62, 0
v_mfma_f32_16x16x32_bf16 v[92:95], v[128:131], a[196:199], v[92:95]
ds_read_b64_tr_b16 v[140:141], v20 offset:3072
s_add_u32 s76, s60, 768
v_mfma_f32_16x16x32_bf16 v[104:107], v[128:131], a[200:203], v[104:107]
ds_read_b64_tr_b16 v[142:143], v20 offset:4608
buffer_load_dwordx4 v10, s[20:23], s76 offen offset:0 lds
v_mfma_f32_16x16x32_bf16 v[116:119], v[128:131], a[204:207], v[116:119]
ds_read_b64_tr_b16 v[144:145], v20 offset:3104
v_mfma_f32_16x16x32_bf16 v[84:87], v[132:135], a[192:195], v[84:87]
ds_read_b64_tr_b16 v[146:147], v20 offset:4640
buffer_load_dwordx4 v11, s[20:23], s76 offen offset:1024 lds
v_mfma_f32_16x16x32_bf16 v[96:99], v[132:135], a[196:199], v[96:99]
ds_read_b64_tr_b16 v[148:149], v20 offset:3136
v_mfma_f32_16x16x32_bf16 v[108:111], v[132:135], a[200:203], v[108:111]
ds_read_b64_tr_b16 v[150:151], v20 offset:4672
v_mfma_f32_16x16x32_bf16 v[120:123], v[132:135], a[204:207], v[120:123]
v_mfma_f32_16x16x32_bf16 v[88:91], v[136:139], a[192:195], v[88:91]
buffer_load_dwordx4 v12, s[20:23], s76 offen offset:2048 lds
v_mfma_f32_16x16x32_bf16 v[100:103], v[136:139], a[196:199], v[100:103]
v_mfma_f32_16x16x32_bf16 v[112:115], v[136:139], a[200:203], v[112:115]
v_mfma_f32_16x16x32_bf16 v[124:127], v[136:139], a[204:207], v[124:127]
s_waitcnt lgkmcnt(0)
v_mfma_f32_16x16x32_bf16 v[80:83], v[140:143], a[208:211], v[80:83]
s_waitcnt vmcnt(12)
s_add_u32 m0, s62, 3072
v_mfma_f32_16x16x32_bf16 v[92:95], v[140:143], a[212:215], v[92:95]
ds_read_b64_tr_b16 v[128:129], v20 offset:6144
s_add_u32 s76, s60, 295680
v_mfma_f32_16x16x32_bf16 v[104:107], v[140:143], a[216:219], v[104:107]
ds_read_b64_tr_b16 v[130:131], v20 offset:7680
buffer_load_dwordx4 v10, s[20:23], s76 offen offset:0 lds
v_mfma_f32_16x16x32_bf16 v[116:119], v[140:143], a[220:223], v[116:119]
ds_read_b64_tr_b16 v[132:133], v20 offset:6176
v_mfma_f32_16x16x32_bf16 v[84:87], v[144:147], a[208:211], v[84:87]
ds_read_b64_tr_b16 v[134:135], v20 offset:7712
buffer_load_dwordx4 v11, s[20:23], s76 offen offset:1024 lds
v_mfma_f32_16x16x32_bf16 v[96:99], v[144:147], a[212:215], v[96:99]
ds_read_b64_tr_b16 v[136:137], v20 offset:6208
v_mfma_f32_16x16x32_bf16 v[108:111], v[144:147], a[216:219], v[108:111]
ds_read_b64_tr_b16 v[138:139], v20 offset:7744
v_mfma_f32_16x16x32_bf16 v[120:123], v[144:147], a[220:223], v[120:123]
v_mfma_f32_16x16x32_bf16 v[88:91], v[148:151], a[208:211], v[88:91]
buffer_load_dwordx4 v12, s[20:23], s76 offen offset:2048 lds
v_mfma_f32_16x16x32_bf16 v[100:103], v[148:151], a[212:215], v[100:103]
v_mfma_f32_16x16x32_bf16 v[112:115], v[148:151], a[216:219], v[112:115]
v_mfma_f32_16x16x32_bf16 v[124:127], v[148:151], a[220:223], v[124:127]
s_waitcnt lgkmcnt(0)
v_mfma_f32_16x16x32_bf16 v[80:83], v[128:131], a[224:227], v[80:83]
s_waitcnt vmcnt(12)
s_add_u32 m0, s62, 6144
v_mfma_f32_16x16x32_bf16 v[92:95], v[128:131], a[228:231], v[92:95]
ds_read_b64_tr_b16 v[140:141], v20 offset:9216
s_add_u32 s76, s60, 664320
v_mfma_f32_16x16x32_bf16 v[104:107], v[128:131], a[232:235], v[104:107]
ds_read_b64_tr_b16 v[142:143], v20 offset:10752
buffer_load_dwordx4 v10, s[20:23], s76 offen offset:0 lds
v_mfma_f32_16x16x32_bf16 v[116:119], v[128:131], a[236:239], v[116:119]
ds_read_b64_tr_b16 v[144:145], v20 offset:9248
v_mfma_f32_16x16x32_bf16 v[84:87], v[132:135], a[224:227], v[84:87]
ds_read_b64_tr_b16 v[146:147], v20 offset:10784
buffer_load_dwordx4 v11, s[20:23], s76 offen offset:1024 lds
v_mfma_f32_16x16x32_bf16 v[96:99], v[132:135], a[228:231], v[96:99]
ds_read_b64_tr_b16 v[148:149], v20 offset:9280
v_mfma_f32_16x16x32_bf16 v[108:111], v[132:135], a[232:235], v[108:111]
ds_read_b64_tr_b16 v[150:151], v20 offset:10816
v_mfma_f32_16x16x32_bf16 v[120:123], v[132:135], a[236:239], v[120:123]
v_mfma_f32_16x16x32_bf16 v[88:91], v[136:139], a[224:227], v[88:91]
buffer_load_dwordx4 v12, s[20:23], s76 offen offset:2048 lds
v_mfma_f32_16x16x32_bf16 v[100:103], v[136:139], a[228:231], v[100:103]
v_mfma_f32_16x16x32_bf16 v[112:115], v[136:139], a[232:235], v[112:115]
v_mfma_f32_16x16x32_bf16 v[124:127], v[136:139], a[236:239], v[124:127]
s_waitcnt lgkmcnt(0)
v_mfma_f32_16x16x32_bf16 v[80:83], v[140:143], a[240:243], v[80:83]
s_waitcnt vmcnt(12)
s_add_u32 m0, s62, 9216
v_mfma_f32_16x16x32_bf16 v[92:95], v[140:143], a[244:247], v[92:95]
ds_read_b64_tr_b16 v[128:129], v20 offset:12288
s_add_u32 s76, s60, 959232
v_mfma_f32_16x16x32_bf16 v[104:107], v[140:143], a[248:251], v[104:107]
ds_read_b64_tr_b16 v[130:131], v20 offset:13824
buffer_load_dwordx4 v10, s[20:23], s76 offen offset:0 lds
v_mfma_f32_16x16x32_bf16 v[116:119], v[140:143], a[252:255], v[116:119]
ds_read_b64_tr_b16 v[132:133], v20 offset:12320
v_mfma_f32_16x16x32_bf16 v[84:87], v[144:147], a[240:243], v[84:87]
ds_read_b64_tr_b16 v[134:135], v20 offset:13856
buffer_load_dwordx4 v11, s[20:23], s76 offen offset:1024 lds
v_mfma_f32_16x16x32_bf16 v[96:99], v[144:147], a[244:247], v[96:99]
ds_read_b64_tr_b16 v[136:137], v20 offset:12352
v_mfma_f32_16x16x32_bf16 v[108:111], v[144:147], a[248:251], v[108:111]
ds_read_b64_tr_b16 v[138:139], v20 offset:13888
v_mfma_f32_16x16x32_bf16 v[120:123], v[144:147], a[252:255], v[120:123]
v_mfma_f32_16x16x32_bf16 v[88:91], v[148:151], a[240:243], v[88:91]
buffer_load_dwordx4 v12, s[20:23], s76 offen offset:2048 lds
v_mfma_f32_16x16x32_bf16 v[100:103], v[148:151], a[244:247], v[100:103]
v_mfma_f32_16x16x32_bf16 v[112:115], v[148:151], a[248:251], v[112:115]
v_mfma_f32_16x16x32_bf16 v[124:127], v[148:151], a[252:255], v[124:127]
s_waitcnt lgkmcnt(0)
v_mfma_f32_16x16x32_bf16 v[80:83], v[128:131], v[224:227], v[80:83]
s_waitcnt vmcnt(12)
s_add_u32 m0, s62, 12288
v_mfma_f32_16x16x32_bf16 v[92:95], v[128:131], v[228:231], v[92:95]
ds_read_b64_tr_b16 v[140:141], v20 offset:15360
s_add_u32 s76, s60, 1327872
v_mfma_f32_16x16x32_bf16 v[104:107], v[128:131], v[232:235], v[104:107]
ds_read_b64_tr_b16 v[142:143], v20 offset:16896
buffer_load_dwordx4 v10, s[20:23], s76 offen offset:0 lds
v_mfma_f32_16x16x32_bf16 v[116:119], v[128:131], v[236:239], v[116:119]
ds_read_b64_tr_b16 v[144:145], v20 offset:15392
v_mfma_f32_16x16x32_bf16 v[84:87], v[132:135], v[224:227], v[84:87]
ds_read_b64_tr_b16 v[146:147], v20 offset:16928
buffer_load_dwordx4 v11, s[20:23], s76 offen offset:1024 lds
v_mfma_f32_16x16x32_bf16 v[96:99], v[132:135], v[228:231], v[96:99]
ds_read_b64_tr_b16 v[148:149], v20 offset:15424
v_mfma_f32_16x16x32_bf16 v[108:111], v[132:135], v[232:235], v[108:111]
ds_read_b64_tr_b16 v[150:151], v20 offset:16960
v_mfma_f32_16x16x32_bf16 v[120:123], v[132:135], v[236:239], v[120:123]
v_mfma_f32_16x16x32_bf16 v[88:91], v[136:139], v[224:227], v[88:91]
buffer_load_dwordx4 v12, s[20:23], s76 offen offset:2048 lds
v_mfma_f32_16x16x32_bf16 v[100:103], v[136:139], v[228:231], v[100:103]
v_mfma_f32_16x16x32_bf16 v[112:115], v[136:139], v[232:235], v[112:115]
v_mfma_f32_16x16x32_bf16 v[124:127], v[136:139], v[236:239], v[124:127]
s_waitcnt lgkmcnt(0)
v_mfma_f32_16x16x32_bf16 v[80:83], v[140:143], v[240:243], v[80:83]
s_waitcnt vmcnt(12)
s_add_u32 m0, s62, 15360
v_mfma_f32_16x16x32_bf16 v[92:95], v[140:143], v[244:247], v[92:95]
ds_read_b64_tr_b16 v[128:129], v20 offset:0
s_add_u32 s76, s60, 1622784
v_mfma_f32_16x16x32_bf16 v[104:107], v[140:143], v[248:251], v[104:107]
ds_read_b64_tr_b16 v[130:131], v20 offset:1536
buffer_load_dwordx4 v10, s[20:23], s76 offen offset:0 lds
v_mfma_f32_16x16x32_bf16 v[116:119], v[140:143], v[252:255], v[116:119]
ds_read_b64_tr_b16 v[132:133], v20 offset:32
v_mfma_f32_16x16x32_bf16 v[84:87], v[144:147], v[240:243], v[84:87]
ds_read_b64_tr_b16 v[134:135], v20 offset:1568
buffer_load_dwordx4 v11, s[20:23], s76 offen offset:1024 lds
v_mfma_f32_16x16x32_bf16 v[96:99], v[144:147], v[244:247], v[96:99]
ds_read_b64_tr_b16 v[136:137], v20 offset:64
v_mfma_f32_16x16x32_bf16 v[108:111], v[144:147], v[248:251], v[108:111]
ds_read_b64_tr_b16 v[138:139], v20 offset:1600
v_mfma_f32_16x16x32_bf16 v[120:123], v[144:147], v[252:255], v[120:123]
v_mfma_f32_16x16x32_bf16 v[88:91], v[148:151], v[240:243], v[88:91]
buffer_load_dwordx4 v12, s[20:23], s76 offen offset:2048 lds
v_mfma_f32_16x16x32_bf16 v[100:103], v[148:151], v[244:247], v[100:103]
v_mfma_f32_16x16x32_bf16 v[112:115], v[148:151], v[248:251], v[112:115]
v_mfma_f32_16x16x32_bf16 v[124:127], v[148:151], v[252:255], v[124:127]
s_waitcnt lgkmcnt(0)
s_waitcnt lgkmcnt(0)
s_barrier
v_mfma_f32_16x16x32_bf16 v[32:35], v[128:131], a[0:3], 0
s_waitcnt vmcnt(12)
v_cvt_pk_bf16_f32 v80, v80, v81
v_cvt_pk_bf16_f32 v81, v82, v83
v_mfma_f32_16x16x32_bf16 v[44:47], v[128:131], a[4:7], 0
ds_read_b64_tr_b16 v[140:141], v20 offset:3072
v_pk_max_i16 v80, v80, 0
v_pk_max_i16 v81, v81, 0
v_mfma_f32_16x16x32_bf16 v[56:59], v[128:131], a[8:11], 0
ds_read_b64_tr_b16 v[142:143], v20 offset:4608
s_add_u32 m0, s62, 0
s_add_u32 s76, s60, 1991424
v_mfma_f32_16x16x32_bf16 v[68:71], v[128:131], a[12:15], 0
ds_read_b64_tr_b16 v[144:145], v20 offset:3104
buffer_load_dwordx4 v10, s[20:23], s76 offen offset:0 lds
v_cvt_pk_bf16_f32 v82, v84, v85
v_mfma_f32_16x16x32_bf16 v[36:39], v[132:135], a[0:3], 0
ds_read_b64_tr_b16 v[146:147], v20 offset:4640
v_cvt_pk_bf16_f32 v83, v86, v87
v_pk_max_i16 v82, v82, 0
v_mfma_f32_16x16x32_bf16 v[48:51], v[132:135], a[4:7], 0
ds_read_b64_tr_b16 v[148:149], v20 offset:3136
v_pk_max_i16 v83, v83, 0
v_mfma_f32_16x16x32_bf16 v[60:63], v[132:135], a[8:11], 0
ds_read_b64_tr_b16 v[150:151], v20 offset:4672
buffer_load_dwordx4 v11, s[20:23], s76 offen offset:1024 lds
v_mfma_f32_16x16x32_bf16 v[72:75], v[132:135], a[12:15], 0
buffer_load_dwordx4 v12, s[20:23], s76 offen offset:2048 lds
v_mfma_f32_16x16x32_bf16 v[40:43], v[136:139], a[0:3], 0
ds_write_b128 v22, v[80:83] offset:6144
v_cvt_pk_bf16_f32 v88, v88, v89
v_mfma_f32_16x16x32_bf16 v[52:55], v[136:139], a[4:7], 0
v_cvt_pk_bf16_f32 v89, v90, v91
v_pk_max_i16 v88, v88, 0
v_mfma_f32_16x16x32_bf16 v[64:67], v[136:139], a[8:11], 0
v_pk_max_i16 v89, v89, 0
v_mfma_f32_16x16x32_bf16 v[76:79], v[136:139], a[12:15], 0
ds_write_b64 v23, v[88:89] offset:6144
s_waitcnt lgkmcnt(2)
v_mfma_f32_16x16x32_bf16 v[32:35], v[140:143], a[16:19], v[32:35]
s_waitcnt vmcnt(12)
v_cvt_pk_bf16_f32 v92, v92, v93
v_cvt_pk_bf16_f32 v93, v94, v95
v_mfma_f32_16x16x32_bf16 v[44:47], v[140:143], a[20:23], v[44:47]
ds_read_b64_tr_b16 v[128:129], v20 offset:6144
v_pk_max_i16 v92, v92, 0
v_pk_max_i16 v93, v93, 0
v_mfma_f32_16x16x32_bf16 v[56:59], v[140:143], a[24:27], v[56:59]
ds_read_b64_tr_b16 v[130:131], v20 offset:7680
s_add_u32 m0, s62, 3072
s_add_u32 s76, s60, 2286336
v_mfma_f32_16x16x32_bf16 v[68:71], v[140:143], a[28:31], v[68:71]
ds_read_b64_tr_b16 v[132:133], v20 offset:6176
buffer_load_dwordx4 v10, s[20:23], s76 offen offset:0 lds
v_cvt_pk_bf16_f32 v94, v96, v97
v_mfma_f32_16x16x32_bf16 v[36:39], v[144:147], a[16:19], v[36:39]
ds_read_b64_tr_b16 v[134:135], v20 offset:7712
v_cvt_pk_bf16_f32 v95, v98, v99
v_pk_max_i16 v94, v94, 0
v_mfma_f32_16x16x32_bf16 v[48:51], v[144:147], a[20:23], v[48:51]
ds_read_b64_tr_b16 v[136:137], v20 offset:6208
v_pk_max_i16 v95, v95, 0
v_mfma_f32_16x16x32_bf16 v[60:63], v[144:147], a[24:27], v[60:63]
ds_read_b64_tr_b16 v[138:139], v20 offset:7744
buffer_load_dwordx4 v11, s[20:23], s76 offen offset:1024 lds
v_mfma_f32_16x16x32_bf16 v[72:75], v[144:147], a[28:31], v[72:75]
buffer_load_dwordx4 v12, s[20:23], s76 offen offset:2048 lds
v_mfma_f32_16x16x32_bf16 v[40:43], v[148:151], a[16:19], v[40:43]
ds_write_b128 v22, v[92:95] offset:24576
v_cvt_pk_bf16_f32 v100, v100, v101
v_mfma_f32_16x16x32_bf16 v[52:55], v[148:151], a[20:23], v[52:55]
v_cvt_pk_bf16_f32 v101, v102, v103
v_pk_max_i16 v100, v100, 0
v_mfma_f32_16x16x32_bf16 v[64:67], v[148:151], a[24:27], v[64:67]
v_pk_max_i16 v101, v101, 0
v_mfma_f32_16x16x32_bf16 v[76:79], v[148:151], a[28:31], v[76:79]
ds_write_b64 v23, v[100:101] offset:24576
s_waitcnt lgkmcnt(2)
v_mfma_f32_16x16x32_bf16 v[32:35], v[128:131], a[32:35], v[32:35]
ds_read_b128 a[0:3], v9 offset:0
v_cvt_pk_bf16_f32 v104, v104, v105
v_cvt_pk_bf16_f32 v105, v106, v107
v_mfma_f32_16x16x32_bf16 v[44:47], v[128:131], a[36:39], v[44:47]
ds_read_b128 a[4:7], v9 offset:18432
v_pk_max_i16 v104, v104, 0
v_pk_max_i16 v105, v105, 0
v_mfma_f32_16x16x32_bf16 v[56:59], v[128:131], a[40:43], v[56:59]
ds_read_b128 a[8:11], v5 offset:0
s_add_u32 m0, s62, 6144
s_add_u32 s76, s60, 2654976
v_mfma_f32_16x16x32_bf16 v[68:71], v[128:131], a[44:47], v[68:71]
ds_read_b128 a[12:15], v5 offset:18432
buffer_load_dwordx4 v10, s[20:23], s76 offen offset:0 lds
v_cvt_pk_bf16_f32 v106, v108, v109
v_mfma_f32_16x16x32_bf16 v[36:39], v[132:135], a[32:35], v[36:39]
s_waitcnt vmcnt(13)
v_cvt_pk_bf16_f32 v107, v110, v111
v_pk_max_i16 v106, v106, 0
v_mfma_f32_16x16x32_bf16 v[48:51], v[132:135], a[36:39], v[48:51]
ds_read_b64_tr_b16 v[140:141], v20 offset:9216
v_pk_max_i16 v107, v107, 0
buffer_load_dwordx4 v11, s[20:23], s76 offen offset:1024 lds
v_mfma_f32_16x16x32_bf16 v[60:63], v[132:135], a[40:43], v[60:63]
ds_read_b64_tr_b16 v[142:143], v20 offset:10752
ds_read_b64_tr_b16 v[144:145], v20 offset:9248
ds_read_b64_tr_b16 v[146:147], v20 offset:10784
v_mfma_f32_16x16x32_bf16 v[72:75], v[132:135], a[44:47], v[72:75]
ds_read_b64_tr_b16 v[148:149], v20 offset:9280
buffer_load_dwordx4 v12, s[20:23], s76 offen offset:2048 lds
ds_read_b64_tr_b16 v[150:151], v20 offset:10816
v_mfma_f32_16x16x32_bf16 v[40:43], v[136:139], a[32:35], v[40:43]
ds_write_b128 v24, v[104:107] offset:6144
v_cvt_pk_bf16_f32 v112, v112, v113
v_mfma_f32_16x16x32_bf16 v[52:55], v[136:139], a[36:39], v[52:55]
v_cvt_pk_bf16_f32 v113, v114, v115
v_pk_max_i16 v112, v112, 0
v_mfma_f32_16x16x32_bf16 v[64:67], v[136:139], a[40:43], v[64:67]
v_pk_max_i16 v113, v113, 0
v_mfma_f32_16x16x32_bf16 v[76:79], v[136:139], a[44:47], v[76:79]
ds_write_b64 v25, v[112:113] offset:6144
s_waitcnt lgkmcnt(2)
v_mfma_f32_16x16x32_bf16 v[32:35], v[140:143], a[48:51], v[32:35]
s_waitcnt vmcnt(12)
v_cvt_pk_bf16_f32 v116, v116, v117
v_cvt_pk_bf16_f32 v117, v118, v119
v_mfma_f32_16x16x32_bf16 v[44:47], v[140:143], a[52:55], v[44:47]
ds_read_b64_tr_b16 v[128:129], v20 offset:12288
v_pk_max_i16 v116, v116, 0
v_pk_max_i16 v117, v117, 0
v_mfma_f32_16x16x32_bf16 v[56:59], v[140:143], a[56:59], v[56:59]
ds_read_b64_tr_b16 v[130:131], v20 offset:13824
s_add_u32 m0, s62, 9216
s_add_u32 s76, s60, 2949888
v_mfma_f32_16x16x32_bf16 v[68:71], v[140:143], a[60:63], v[68:71]
ds_read_b64_tr_b16 v[132:133], v20 offset:12320
buffer_load_dwordx4 v10, s[20:23], s76 offen offset:0 lds
v_cvt_pk_bf16_f32 v118, v120, v121
v_mfma_f32_16x16x32_bf16 v[36:39], v[144:147], a[48:51], v[36:39]
ds_read_b64_tr_b16 v[134:135], v20 offset:13856
v_cvt_pk_bf16_f32 v119, v122, v123
v_pk_max_i16 v118, v118, 0
v_mfma_f32_16x16x32_bf16 v[48:51], v[144:147], a[52:55], v[48:51]
ds_read_b64_tr_b16 v[136:137], v20 offset:12352
v_pk_max_i16 v119, v119, 0
v_mfma_f32_16x16x32_bf16 v[60:63], v[144:147], a[56:59], v[60:63]
ds_read_b64_tr_b16 v[138:139], v20 offset:13888
buffer_load_dwordx4 v11, s[20:23], s76 offen offset:1024 lds
v_mfma_f32_16x16x32_bf16 v[72:75], v[144:147], a[60:63], v[72:75]
buffer_load_dwordx4 v12, s[20:23], s76 offen offset:2048 lds
v_mfma_f32_16x16x32_bf16 v[40:43], v[148:151], a[48:51], v[40:43]
ds_write_b128 v24, v[116:119] offset:24576
v_cvt_pk_bf16_f32 v124, v124, v125
v_mfma_f32_16x16x32_bf16 v[52:55], v[148:151], a[52:55], v[52:55]
v_cvt_pk_bf16_f32 v125, v126, v127
v_pk_max_i16 v124, v124, 0
v_mfma_f32_16x16x32_bf16 v[64:67], v[148:151], a[56:59], v[64:67]
v_pk_max_i16 v125, v125, 0
v_mfma_f32_16x16x32_bf16 v[76:79], v[148:151], a[60:63], v[76:79]
ds_write_b64 v25, v[124:125] offset:24576
s_waitcnt lgkmcnt(2)
v_mfma_f32_16x16x32_bf16 v[32:35], v[128:131], a[64:67], v[32:35]
ds_read_b128 a[16:19], v9 offset:1024
s_add_u32 m0, s62, 12288
v_mfma_f32_16x16x32_bf16 v[44:47], v[128:131], a[68:71], v[44:47]
ds_read_b128 a[20:23], v9 offset:19456
s_add_u32 s76, s60, 3318528
v_mfma_f32_16x16x32_bf16 v[56:59], v[128:131], a[72:75], v[56:59]
ds_read_b128 a[24:27], v5 offset:1024
buffer_load_dwordx4 v10, s[20:23], s76 offen offset:0 lds
v_mfma_f32_16x16x32_bf16 v[68:71], v[128:131], a[76:79], v[68:71]
ds_read_b128 a[28:31], v5 offset:19456
v_mfma_f32_16x16x32_bf16 v[36:39], v[132:135], a[64:67], v[36:39]
s_waitcnt vmcnt(13)
ds_read_b64_tr_b16 v[140:141], v20 offset:15360
v_mfma_f32_16x16x32_bf16 v[48:51], v[132:135], a[68:71], v[48:51]
ds_read_b64_tr_b16 v[142:143], v20 offset:16896
buffer_load_dwordx4 v11, s[20:23], s76 offen offset:1024 lds
v_mfma_f32_16x16x32_bf16 v[60:63], v[132:135], a[72:75], v[60:63]
ds_read_b64_tr_b16 v[144:145], v20 offset:15392
v_mfma_f32_16x16x32_bf16 v[72:75], v[132:135], a[76:79], v[72:75]
ds_read_b64_tr_b16 v[146:147], v20 offset:16928
v_mfma_f32_16x16x32_bf16 v[40:43], v[136:139], a[64:67], v[40:43]
ds_read_b64_tr_b16 v[148:149], v20 offset:15424
buffer_load_dwordx4 v12, s[20:23], s76 offen offset:2048 lds
v_mfma_f32_16x16x32_bf16 v[52:55], v[136:139], a[68:71], v[52:55]
ds_read_b64_tr_b16 v[150:151], v20 offset:16960
v_mfma_f32_16x16x32_bf16 v[64:67], v[136:139], a[72:75], v[64:67]
v_mfma_f32_16x16x32_bf16 v[76:79], v[136:139], a[76:79], v[76:79]
s_waitcnt lgkmcnt(0)
v_mfma_f32_16x16x32_bf16 v[32:35], v[140:143], a[80:83], v[32:35]
s_waitcnt vmcnt(12)
s_add_u32 m0, s62, 15360
v_mfma_f32_16x16x32_bf16 v[44:47], v[140:143], a[84:87], v[44:47]
ds_read_b64_tr_b16 v[128:129], v20 offset:0
s_add_u32 s76, s60, 3613440
v_mfma_f32_16x16x32_bf16 v[56:59], v[140:143], a[88:91], v[56:59]
ds_read_b64_tr_b16 v[130:131], v20 offset:1536
buffer_load_dwordx4 v10, s[20:23], s76 offen offset:0 lds
v_mfma_f32_16x16x32_bf16 v[68:71], v[140:143], a[92:95], v[68:71]
ds_read_b64_tr_b16 v[132:133], v20 offset:32
v_mfma_f32_16x16x32_bf16 v[36:39], v[144:147], a[80:83], v[36:39]
ds_read_b64_tr_b16 v[134:135], v20 offset:1568
buffer_load_dwordx4 v11, s[20:23], s76 offen offset:1024 lds
v_mfma_f32_16x16x32_bf16 v[48:51], v[144:147], a[84:87], v[48:51]
ds_read_b64_tr_b16 v[136:137], v20 offset:64
v_mfma_f32_16x16x32_bf16 v[60:63], v[144:147], a[88:91], v[60:63]
ds_read_b64_tr_b16 v[138:139], v20 offset:1600
v_mfma_f32_16x16x32_bf16 v[72:75], v[144:147], a[92:95], v[72:75]
v_mfma_f32_16x16x32_bf16 v[40:43], v[148:151], a[80:83], v[40:43]
buffer_load_dwordx4 v12, s[20:23], s76 offen offset:2048 lds
v_mfma_f32_16x16x32_bf16 v[52:55], v[148:151], a[84:87], v[52:55]
v_mfma_f32_16x16x32_bf16 v[64:67], v[148:151], a[88:91], v[64:67]
v_mfma_f32_16x16x32_bf16 v[76:79], v[148:151], a[92:95], v[76:79]
s_waitcnt lgkmcnt(0)
v_mfma_f32_16x16x32_bf16 v[32:35], v[128:131], a[96:99], v[32:35]
ds_read_b128 a[32:35], v9 offset:2048
s_add_u32 m0, s62, 0
v_mfma_f32_16x16x32_bf16 v[44:47], v[128:131], a[100:103], v[44:47]
ds_read_b128 a[36:39], v9 offset:20480
s_add_u32 s76, s60, 3982080
v_mfma_f32_16x16x32_bf16 v[56:59], v[128:131], a[104:107], v[56:59]
ds_read_b128 a[40:43], v5 offset:2048
buffer_load_dwordx4 v10, s[20:23], s76 offen offset:0 lds
v_mfma_f32_16x16x32_bf16 v[68:71], v[128:131], a[108:111], v[68:71]
ds_read_b128 a[44:47], v5 offset:20480
v_mfma_f32_16x16x32_bf16 v[36:39], v[132:135], a[96:99], v[36:39]
s_waitcnt vmcnt(13)
ds_read_b64_tr_b16 v[140:141], v20 offset:3072
v_mfma_f32_16x16x32_bf16 v[48:51], v[132:135], a[100:103], v[48:51]
ds_read_b64_tr_b16 v[142:143], v20 offset:4608
buffer_load_dwordx4 v11, s[20:23], s76 offen offset:1024 lds
v_mfma_f32_16x16x32_bf16 v[60:63], v[132:135], a[104:107], v[60:63]
ds_read_b64_tr_b16 v[144:145], v20 offset:3104
v_mfma_f32_16x16x32_bf16 v[72:75], v[132:135], a[108:111], v[72:75]
ds_read_b64_tr_b16 v[146:147], v20 offset:4640
v_mfma_f32_16x16x32_bf16 v[40:43], v[136:139], a[96:99], v[40:43]
ds_read_b64_tr_b16 v[148:149], v20 offset:3136
buffer_load_dwordx4 v12, s[20:23], s76 offen offset:2048 lds
v_mfma_f32_16x16x32_bf16 v[52:55], v[136:139], a[100:103], v[52:55]
ds_read_b64_tr_b16 v[150:151], v20 offset:4672
v_mfma_f32_16x16x32_bf16 v[64:67], v[136:139], a[104:107], v[64:67]
v_mfma_f32_16x16x32_bf16 v[76:79], v[136:139], a[108:111], v[76:79]
s_waitcnt lgkmcnt(0)
v_mfma_f32_16x16x32_bf16 v[32:35], v[140:143], a[112:115], v[32:35]
s_waitcnt vmcnt(12)
s_add_u32 m0, s62, 3072
v_mfma_f32_16x16x32_bf16 v[44:47], v[140:143], a[116:119], v[44:47]
ds_read_b64_tr_b16 v[128:129], v20 offset:6144
s_add_u32 s76, s60, 4276992
v_mfma_f32_16x16x32_bf16 v[56:59], v[140:143], a[120:123], v[56:59]
ds_read_b64_tr_b16 v[130:131], v20 offset:7680
buffer_load_dwordx4 v10, s[20:23], s76 offen offset:0 lds
v_mfma_f32_16x16x32_bf16 v[68:71], v[140:143], a[124:127], v[68:71]
ds_read_b64_tr_b16 v[132:133], v20 offset:6176
v_mfma_f32_16x16x32_bf16 v[36:39], v[144:147], a[112:115], v[36:39]
ds_read_b64_tr_b16 v[134:135], v20 offset:7712
buffer_load_dwordx4 v11, s[20:23], s76 offen offset:1024 lds
v_mfma_f32_16x16x32_bf16 v[48:51], v[144:147], a[116:119], v[48:51]
ds_read_b64_tr_b16 v[136:137], v20 offset:6208
v_mfma_f32_16x16x32_bf16 v[60:63], v[144:147], a[120:123], v[60:63]
ds_read_b64_tr_b16 v[138:139], v20 offset:7744
v_mfma_f32_16x16x32_bf16 v[72:75], v[144:147], a[124:127], v[72:75]
v_mfma_f32_16x16x32_bf16 v[40:43], v[148:151], a[112:115], v[40:43]
buffer_load_dwordx4 v12, s[20:23], s76 offen offset:2048 lds
v_mfma_f32_16x16x32_bf16 v[52:55], v[148:151], a[116:119], v[52:55]
v_mfma_f32_16x16x32_bf16 v[64:67], v[148:151], a[120:123], v[64:67]
v_mfma_f32_16x16x32_bf16 v[76:79], v[148:151], a[124:127], v[76:79]
s_waitcnt lgkmcnt(0)
v_mfma_f32_16x16x32_bf16 v[32:35], v[128:131], a[128:131], v[32:35]
ds_read_b128 a[48:51], v9 offset:3072
s_add_u32 m0, s62, 6144
v_mfma_f32_16x16x32_bf16 v[44:47], v[128:131], a[132:135], v[44:47]
ds_read_b128 a[52:55], v9 offset:21504
s_add_u32 s76, s60, 4645632
v_mfma_f32_16x16x32_bf16 v[56:59], v[128:131], a[136:139], v[56:59]
ds_read_b128 a[56:59], v5 offset:3072
buffer_load_dwordx4 v10, s[20:23], s76 offen offset:0 lds
v_mfma_f32_16x16x32_bf16 v[68:71], v[128:131], a[140:143], v[68:71]
ds_read_b128 a[60:63], v5 offset:21504
v_mfma_f32_16x16x32_bf16 v[36:39], v[132:135], a[128:131], v[36:39]
s_waitcnt vmcnt(13)
ds_read_b64_tr_b16 v[140:141], v20 offset:9216
v_mfma_f32_16x16x32_bf16 v[48:51], v[132:135], a[132:135], v[48:51]
ds_read_b64_tr_b16 v[142:143], v20 offset:10752
buffer_load_dwordx4 v11, s[20:23], s76 offen offset:1024 lds
v_mfma_f32_16x16x32_bf16 v[60:63], v[132:135], a[136:139], v[60:63]
ds_read_b64_tr_b16 v[144:145], v20 offset:9248
v_mfma_f32_16x16x32_bf16 v[72:75], v[132:135], a[140:143], v[72:75]
ds_read_b64_tr_b16 v[146:147], v20 offset:10784
v_mfma_f32_16x16x32_bf16 v[40:43], v[136:139], a[128:131], v[40:43]
ds_read_b64_tr_b16 v[148:149], v20 offset:9280
buffer_load_dwordx4 v12, s[20:23], s76 offen offset:2048 lds
v_mfma_f32_16x16x32_bf16 v[52:55], v[136:139], a[132:135], v[52:55]
ds_read_b64_tr_b16 v[150:151], v20 offset:10816
v_mfma_f32_16x16x32_bf16 v[64:67], v[136:139], a[136:139], v[64:67]
v_mfma_f32_16x16x32_bf16 v[76:79], v[136:139], a[140:143], v[76:79]
s_waitcnt lgkmcnt(0)
v_mfma_f32_16x16x32_bf16 v[32:35], v[140:143], a[144:147], v[32:35]
s_waitcnt vmcnt(12)
s_add_u32 m0, s62, 9216
v_mfma_f32_16x16x32_bf16 v[44:47], v[140:143], a[148:151], v[44:47]
ds_read_b64_tr_b16 v[128:129], v20 offset:12288
s_add_u32 s76, s60, 4940544
v_mfma_f32_16x16x32_bf16 v[56:59], v[140:143], a[152:155], v[56:59]
ds_read_b64_tr_b16 v[130:131], v20 offset:13824
buffer_load_dwordx4 v10, s[20:23], s76 offen offset:0 lds
v_mfma_f32_16x16x32_bf16 v[68:71], v[140:143], a[156:159], v[68:71]
ds_read_b64_tr_b16 v[132:133], v20 offset:12320
v_mfma_f32_16x16x32_bf16 v[36:39], v[144:147], a[144:147], v[36:39]
ds_read_b64_tr_b16 v[134:135], v20 offset:13856
buffer_load_dwordx4 v11, s[20:23], s76 offen offset:1024 lds
v_mfma_f32_16x16x32_bf16 v[48:51], v[144:147], a[148:151], v[48:51]
ds_read_b64_tr_b16 v[136:137], v20 offset:12352
v_mfma_f32_16x16x32_bf16 v[60:63], v[144:147], a[152:155], v[60:63]
ds_read_b64_tr_b16 v[138:139], v20 offset:13888
v_mfma_f32_16x16x32_bf16 v[72:75], v[144:147], a[156:159], v[72:75]
v_mfma_f32_16x16x32_bf16 v[40:43], v[148:151], a[144:147], v[40:43]
buffer_load_dwordx4 v12, s[20:23], s76 offen offset:2048 lds
v_mfma_f32_16x16x32_bf16 v[52:55], v[148:151], a[148:151], v[52:55]
v_mfma_f32_16x16x32_bf16 v[64:67], v[148:151], a[152:155], v[64:67]
v_mfma_f32_16x16x32_bf16 v[76:79], v[148:151], a[156:159], v[76:79]
s_waitcnt lgkmcnt(0)
v_mfma_f32_16x16x32_bf16 v[32:35], v[128:131], a[160:163], v[32:35]
ds_read_b128 a[64:67], v9 offset:4096
s_add_u32 m0, s62, 12288
v_mfma_f32_16x16x32_bf16 v[44:47], v[128:131], a[164:167], v[44:47]
ds_read_b128 a[68:71], v9 offset:22528
s_add_u32 s76, s60, 590592
v_mfma_f32_16x16x32_bf16 v[56:59], v[128:131], a[168:171], v[56:59]
ds_read_b128 a[72:75], v5 offset:4096
buffer_load_dwordx4 v13, s[20:23], s76 offen offset:0 lds
v_mfma_f32_16x16x32_bf16 v[68:71], v[128:131], a[172:175], v[68:71]
ds_read_b128 a[76:79], v5 offset:22528
v_mfma_f32_16x16x32_bf16 v[36:39], v[132:135], a[160:163], v[36:39]
s_waitcnt vmcnt(13)
ds_read_b64_tr_b16 v[140:141], v20 offset:15360
v_mfma_f32_16x16x32_bf16 v[48:51], v[132:135], a[164:167], v[48:51]
ds_read_b64_tr_b16 v[142:143], v20 offset:16896
buffer_load_dwordx4 v14, s[20:23], s76 offen offset:1024 lds
v_mfma_f32_16x16x32_bf16 v[60:63], v[132:135], a[168:171], v[60:63]
ds_read_b64_tr_b16 v[144:145], v20 offset:15392
v_mfma_f32_16x16x32_bf16 v[72:75], v[132:135], a[172:175], v[72:75]
ds_read_b64_tr_b16 v[146:147], v20 offset:16928
v_mfma_f32_16x16x32_bf16 v[40:43], v[136:139], a[160:163], v[40:43]
ds_read_b64_tr_b16 v[148:149], v20 offset:15424
buffer_load_dwordx4 v15, s[20:23], s76 offen offset:2048 lds
v_mfma_f32_16x16x32_bf16 v[52:55], v[136:139], a[164:167], v[52:55]
ds_read_b64_tr_b16 v[150:151], v20 offset:16960
v_mfma_f32_16x16x32_bf16 v[64:67], v[136:139], a[168:171], v[64:67]
v_mfma_f32_16x16x32_bf16 v[76:79], v[136:139], a[172:175], v[76:79]
s_waitcnt lgkmcnt(0)
v_mfma_f32_16x16x32_bf16 v[32:35], v[140:143], a[176:179], v[32:35]
s_waitcnt vmcnt(12)
s_add_u32 m0, s62, 15360
v_mfma_f32_16x16x32_bf16 v[44:47], v[140:143], a[180:183], v[44:47]
ds_read_b64_tr_b16 v[128:129], v20 offset:0
s_add_u32 s76, s60, 3244800
v_mfma_f32_16x16x32_bf16 v[56:59], v[140:143], a[184:187], v[56:59]
ds_read_b64_tr_b16 v[130:131], v20 offset:1536
buffer_load_dwordx4 v13, s[20:23], s76 offen offset:0 lds
v_mfma_f32_16x16x32_bf16 v[68:71], v[140:143], a[188:191], v[68:71]
ds_read_b64_tr_b16 v[132:133], v20 offset:32
v_mfma_f32_16x16x32_bf16 v[36:39], v[144:147], a[176:179], v[36:39]
ds_read_b64_tr_b16 v[134:135], v20 offset:1568
buffer_load_dwordx4 v14, s[20:23], s76 offen offset:1024 lds
v_mfma_f32_16x16x32_bf16 v[48:51], v[144:147], a[180:183], v[48:51]
ds_read_b64_tr_b16 v[136:137], v20 offset:64
v_mfma_f32_16x16x32_bf16 v[60:63], v[144:147], a[184:187], v[60:63]
ds_read_b64_tr_b16 v[138:139], v20 offset:1600
v_mfma_f32_16x16x32_bf16 v[72:75], v[144:147], a[188:191], v[72:75]
v_mfma_f32_16x16x32_bf16 v[40:43], v[148:151], a[176:179], v[40:43]
buffer_load_dwordx4 v15, s[20:23], s76 offen offset:2048 lds
v_mfma_f32_16x16x32_bf16 v[52:55], v[148:151], a[180:183], v[52:55]
v_mfma_f32_16x16x32_bf16 v[64:67], v[148:151], a[184:187], v[64:67]
v_mfma_f32_16x16x32_bf16 v[76:79], v[148:151], a[188:191], v[76:79]
s_waitcnt lgkmcnt(0)
v_mfma_f32_16x16x32_bf16 v[32:35], v[128:131], a[192:195], v[32:35]
ds_read_b128 a[80:83], v9 offset:5120
s_add_u32 m0, s62, 0
v_mfma_f32_16x16x32_bf16 v[44:47], v[128:131], a[196:199], v[44:47]
ds_read_b128 a[84:87], v9 offset:23552
s_add_u32 s76, s61, 0
v_mfma_f32_16x16x32_bf16 v[56:59], v[128:131], a[200:203], v[56:59]
ds_read_b128 a[88:91], v5 offset:5120
buffer_load_dwordx4 v17, s[24:27], s76 offen offset:0 lds
v_mfma_f32_16x16x32_bf16 v[68:71], v[128:131], a[204:207], v[68:71]
ds_read_b128 a[92:95], v5 offset:23552
v_mfma_f32_16x16x32_bf16 v[36:39], v[132:135], a[192:195], v[36:39]
s_waitcnt vmcnt(13)
ds_read_b64_tr_b16 v[140:141], v20 offset:3072
v_mfma_f32_16x16x32_bf16 v[48:51], v[132:135], a[196:199], v[48:51]
ds_read_b64_tr_b16 v[142:143], v20 offset:4608
buffer_load_dwordx4 v18, s[24:27], s76 offen offset:1024 lds
v_mfma_f32_16x16x32_bf16 v[60:63], v[132:135], a[200:203], v[60:63]
ds_read_b64_tr_b16 v[144:145], v20 offset:3104
v_mfma_f32_16x16x32_bf16 v[72:75], v[132:135], a[204:207], v[72:75]
ds_read_b64_tr_b16 v[146:147], v20 offset:4640
v_mfma_f32_16x16x32_bf16 v[40:43], v[136:139], a[192:195], v[40:43]
ds_read_b64_tr_b16 v[148:149], v20 offset:3136
buffer_load_dwordx4 v19, s[24:27], s76 offen offset:2048 lds
v_mfma_f32_16x16x32_bf16 v[52:55], v[136:139], a[196:199], v[52:55]
ds_read_b64_tr_b16 v[150:151], v20 offset:4672
v_mfma_f32_16x16x32_bf16 v[64:67], v[136:139], a[200:203], v[64:67]
v_mfma_f32_16x16x32_bf16 v[76:79], v[136:139], a[204:207], v[76:79]
s_waitcnt lgkmcnt(0)
s_waitcnt lgkmcnt(0)
s_barrier
v_mfma_f32_16x16x32_bf16 v[32:35], v[140:143], a[208:211], v[32:35]
ds_read_b128 a[96:99], v9 offset:6144
s_add_u32 m0, s62, 3072
v_mfma_f32_16x16x32_bf16 v[44:47], v[140:143], a[212:215], v[44:47]
ds_read_b128 a[100:103], v9 offset:24576
s_add_u32 s76, s61, 55296
v_mfma_f32_16x16x32_bf16 v[56:59], v[140:143], a[216:219], v[56:59]
ds_read_b128 a[104:107], v5 offset:6144
buffer_load_dwordx4 v17, s[24:27], s76 offen offset:0 lds
v_mfma_f32_16x16x32_bf16 v[68:71], v[140:143], a[220:223], v[68:71]
ds_read_b128 a[108:111], v5 offset:24576
v_mfma_f32_16x16x32_bf16 v[36:39], v[144:147], a[208:211], v[36:39]
s_waitcnt vmcnt(13)
ds_read_b64_tr_b16 v[128:129], v20 offset:6144
v_mfma_f32_16x16x32_bf16 v[48:51], v[144:147], a[212:215], v[48:51]
ds_read_b64_tr_b16 v[130:131], v20 offset:7680
buffer_load_dwordx4 v18, s[24:27], s76 offen offset:1024 lds
v_mfma_f32_16x16x32_bf16 v[60:63], v[144:147], a[216:219], v[60:63]
ds_read_b64_tr_b16 v[132:133], v20 offset:6176
v_mfma_f32_16x16x32_bf16 v[72:75], v[144:147], a[220:223], v[72:75]
ds_read_b64_tr_b16 v[134:135], v20 offset:7712
v_mfma_f32_16x16x32_bf16 v[40:43], v[148:151], a[208:211], v[40:43]
ds_read_b64_tr_b16 v[136:137], v20 offset:6208
buffer_load_dwordx4 v19, s[24:27], s76 offen offset:2048 lds
v_mfma_f32_16x16x32_bf16 v[52:55], v[148:151], a[212:215], v[52:55]
ds_read_b64_tr_b16 v[138:139], v20 offset:7744
v_mfma_f32_16x16x32_bf16 v[64:67], v[148:151], a[216:219], v[64:67]
v_mfma_f32_16x16x32_bf16 v[76:79], v[148:151], a[220:223], v[76:79]
s_waitcnt lgkmcnt(0)
v_mfma_f32_16x16x32_bf16 v[32:35], v[128:131], a[224:227], v[32:35]
ds_read_b128 a[112:115], v9 offset:7168
s_add_u32 m0, s62, 6144
v_mfma_f32_16x16x32_bf16 v[44:47], v[128:131], a[228:231], v[44:47]
ds_read_b128 a[116:119], v9 offset:25600
s_add_u32 s76, s61, 110592
v_mfma_f32_16x16x32_bf16 v[56:59], v[128:131], a[232:235], v[56:59]
ds_read_b128 a[120:123], v5 offset:7168
buffer_load_dwordx4 v17, s[24:27], s76 offen offset:0 lds
v_mfma_f32_16x16x32_bf16 v[68:71], v[128:131], a[236:239], v[68:71]
ds_read_b128 a[124:127], v5 offset:25600
v_mfma_f32_16x16x32_bf16 v[36:39], v[132:135], a[224:227], v[36:39]
s_waitcnt vmcnt(13)
ds_read_b64_tr_b16 v[140:141], v20 offset:9216
v_mfma_f32_16x16x32_bf16 v[48:51], v[132:135], a[228:231], v[48:51]
ds_read_b64_tr_b16 v[142:143], v20 offset:10752
buffer_load_dwordx4 v18, s[24:27], s76 offen offset:1024 lds
v_mfma_f32_16x16x32_bf16 v[60:63], v[132:135], a[232:235], v[60:63]
ds_read_b64_tr_b16 v[144:145], v20 offset:9248
v_mfma_f32_16x16x32_bf16 v[72:75], v[132:135], a[236:239], v[72:75]
ds_read_b64_tr_b16 v[146:147], v20 offset:10784
v_mfma_f32_16x16x32_bf16 v[40:43], v[136:139], a[224:227], v[40:43]
ds_read_b64_tr_b16 v[148:149], v20 offset:9280
buffer_load_dwordx4 v19, s[24:27], s76 offen offset:2048 lds
v_mfma_f32_16x16x32_bf16 v[52:55], v[136:139], a[228:231], v[52:55]
ds_read_b64_tr_b16 v[150:151], v20 offset:10816
v_mfma_f32_16x16x32_bf16 v[64:67], v[136:139], a[232:235], v[64:67]
v_mfma_f32_16x16x32_bf16 v[76:79], v[136:139], a[236:239], v[76:79]
s_waitcnt lgkmcnt(0)
v_mfma_f32_16x16x32_bf16 v[32:35], v[140:143], a[240:243], v[32:35]
ds_read_b128 a[128:131], v9 offset:8192
s_add_u32 m0, s62, 9216
v_mfma_f32_16x16x32_bf16 v[44:47], v[140:143], a[244:247], v[44:47]
ds_read_b128 a[132:135], v9 offset:26624
s_add_u32 s76, s61, 165888
v_mfma_f32_16x16x32_bf16 v[56:59], v[140:143], a[248:251], v[56:59]
ds_read_b128 a[136:139], v5 offset:8192
buffer_load_dwordx4 v17, s[24:27], s76 offen offset:0 lds
v_mfma_f32_16x16x32_bf16 v[68:71], v[140:143], a[252:255], v[68:71]
ds_read_b128 a[140:143], v5 offset:26624
v_mfma_f32_16x16x32_bf16 v[36:39], v[144:147], a[240:243], v[36:39]
s_waitcnt vmcnt(13)
ds_read_b64_tr_b16 v[128:129], v20 offset:12288
v_mfma_f32_16x16x32_bf16 v[48:51], v[144:147], a[244:247], v[48:51]
ds_read_b64_tr_b16 v[130:131], v20 offset:13824
buffer_load_dwordx4 v18, s[24:27], s76 offen offset:1024 lds
v_mfma_f32_16x16x32_bf16 v[60:63], v[144:147], a[248:251], v[60:63]
ds_read_b64_tr_b16 v[132:133], v20 offset:12320
v_mfma_f32_16x16x32_bf16 v[72:75], v[144:147], a[252:255], v[72:75]
ds_read_b64_tr_b16 v[134:135], v20 offset:13856
v_mfma_f32_16x16x32_bf16 v[40:43], v[148:151], a[240:243], v[40:43]
ds_read_b64_tr_b16 v[136:137], v20 offset:12352
buffer_load_dwordx4 v19, s[24:27], s76 offen offset:2048 lds
v_mfma_f32_16x16x32_bf16 v[52:55], v[148:151], a[244:247], v[52:55]
ds_read_b64_tr_b16 v[138:139], v20 offset:13888
v_mfma_f32_16x16x32_bf16 v[64:67], v[148:151], a[248:251], v[64:67]
v_mfma_f32_16x16x32_bf16 v[76:79], v[148:151], a[252:255], v[76:79]
s_waitcnt lgkmcnt(0)
v_mfma_f32_16x16x32_bf16 v[32:35], v[128:131], v[224:227], v[32:35]
ds_read_b128 a[144:147], v9 offset:9216
s_add_u32 m0, s62, 12288
v_mfma_f32_16x16x32_bf16 v[44:47], v[128:131], v[228:231], v[44:47]
ds_read_b128 a[148:151], v9 offset:27648
s_add_u32 s76, s61, 36864
v_mfma_f32_16x16x32_bf16 v[56:59], v[128:131], v[232:235], v[56:59]
ds_read_b128 a[152:155], v5 offset:9216
buffer_load_dwordx4 v17, s[24:27], s76 offen offset:0 lds
v_mfma_f32_16x16x32_bf16 v[68:71], v[128:131], v[236:239], v[68:71]
ds_read_b128 a[156:159], v5 offset:27648
v_mfma_f32_16x16x32_bf16 v[36:39], v[132:135], v[224:227], v[36:39]
s_waitcnt vmcnt(13)
ds_read_b64_tr_b16 v[140:141], v20 offset:15360
v_mfma_f32_16x16x32_bf16 v[48:51], v[132:135], v[228:231], v[48:51]
ds_read_b64_tr_b16 v[142:143], v20 offset:16896
buffer_load_dwordx4 v8, s[24:27], s76 offen offset:1024 lds
v_mfma_f32_16x16x32_bf16 v[60:63], v[132:135], v[232:235], v[60:63]
ds_read_b64_tr_b16 v[144:145], v20 offset:15392
v_mfma_f32_16x16x32_bf16 v[72:75], v[132:135], v[236:239], v[72:75]
ds_read_b64_tr_b16 v[146:147], v20 offset:16928
v_mfma_f32_16x16x32_bf16 v[40:43], v[136:139], v[224:227], v[40:43]
ds_read_b64_tr_b16 v[148:149], v20 offset:15424
buffer_load_dwordx4 v0, s[24:27], s76 offen offset:2048 lds
v_mfma_f32_16x16x32_bf16 v[52:55], v[136:139], v[228:231], v[52:55]
ds_read_b64_tr_b16 v[150:151], v20 offset:16960
v_mfma_f32_16x16x32_bf16 v[64:67], v[136:139], v[232:235], v[64:67]
v_mfma_f32_16x16x32_bf16 v[76:79], v[136:139], v[236:239], v[76:79]
s_waitcnt lgkmcnt(0)
v_mfma_f32_16x16x32_bf16 v[32:35], v[140:143], v[240:243], v[32:35]
ds_read_b128 a[160:163], v9 offset:10240
s_add_u32 m0, s62, 15360
v_mfma_f32_16x16x32_bf16 v[44:47], v[140:143], v[244:247], v[44:47]
ds_read_b128 a[164:167], v9 offset:28672
s_add_u32 s76, s61, 147456
v_mfma_f32_16x16x32_bf16 v[56:59], v[140:143], v[248:251], v[56:59]
ds_read_b128 a[168:171], v5 offset:10240
buffer_load_dwordx4 v17, s[24:27], s76 offen offset:0 lds
v_mfma_f32_16x16x32_bf16 v[68:71], v[140:143], v[252:255], v[68:71]
ds_read_b128 a[172:175], v5 offset:28672
v_mfma_f32_16x16x32_bf16 v[36:39], v[144:147], v[240:243], v[36:39]
s_waitcnt vmcnt(13)
ds_read_b64_tr_b16 v[128:129], v20 offset:0
v_mfma_f32_16x16x32_bf16 v[48:51], v[144:147], v[244:247], v[48:51]
ds_read_b64_tr_b16 v[130:131], v20 offset:1536
buffer_load_dwordx4 v8, s[24:27], s76 offen offset:1024 lds
v_mfma_f32_16x16x32_bf16 v[60:63], v[144:147], v[248:251], v[60:63]
ds_read_b64_tr_b16 v[132:133], v20 offset:32
v_mfma_f32_16x16x32_bf16 v[72:75], v[144:147], v[252:255], v[72:75]
ds_read_b64_tr_b16 v[134:135], v20 offset:1568
v_mfma_f32_16x16x32_bf16 v[40:43], v[148:151], v[240:243], v[40:43]
ds_read_b64_tr_b16 v[136:137], v20 offset:64
buffer_load_dwordx4 v0, s[24:27], s76 offen offset:2048 lds
v_mfma_f32_16x16x32_bf16 v[52:55], v[148:151], v[244:247], v[52:55]
ds_read_b64_tr_b16 v[138:139], v20 offset:1600
v_mfma_f32_16x16x32_bf16 v[64:67], v[148:151], v[248:251], v[64:67]
v_mfma_f32_16x16x32_bf16 v[76:79], v[148:151], v[252:255], v[76:79]
s_waitcnt lgkmcnt(0)
v_mfma_f32_16x16x32_bf16 v[80:83], v[128:131], a[0:3], 0
ds_read_b128 a[176:179], v9 offset:11264
v_cvt_pk_bf16_f32 v32, v32, v33
v_cvt_pk_bf16_f32 v33, v34, v35
v_mfma_f32_16x16x32_bf16 v[92:95], v[128:131], a[4:7], 0
ds_read_b128 a[180:183], v9 offset:29696
v_pk_max_i16 v32, v32, 0
v_pk_max_i16 v33, v33, 0
v_mfma_f32_16x16x32_bf16 v[104:107], v[128:131], a[8:11], 0
ds_read_b128 a[184:187], v5 offset:11264
s_add_u32 m0, s62, 0
s_add_u32 s76, s61, 221184
v_mfma_f32_16x16x32_bf16 v[116:119], v[128:131], a[12:15], 0
ds_read_b128 a[188:191], v5 offset:29696
buffer_load_dwordx4 v17, s[24:27], s76 offen offset:0 lds
v_cvt_pk_bf16_f32 v34, v36, v37
v_mfma_f32_16x16x32_bf16 v[84:87], v[132:135], a[0:3], 0
s_waitcnt vmcnt(13)
v_cvt_pk_bf16_f32 v35, v38, v39
v_pk_max_i16 v34, v34, 0
v_mfma_f32_16x16x32_bf16 v[96:99], v[132:135], a[4:7], 0
ds_read_b64_tr_b16 v[140:141], v20 offset:3072
v_pk_max_i16 v35, v35, 0
buffer_load_dwordx4 v18, s[24:27], s76 offen offset:1024 lds
v_mfma_f32_16x16x32_bf16 v[108:111], v[132:135], a[8:11], 0
ds_read_b64_tr_b16 v[142:143], v20 offset:4608
ds_read_b64_tr_b16 v[144:145], v20 offset:3104
ds_read_b64_tr_b16 v[146:147], v20 offset:4640
v_mfma_f32_16x16x32_bf16 v[120:123], v[132:135], a[12:15], 0
ds_read_b64_tr_b16 v[148:149], v20 offset:3136
buffer_load_dwordx4 v19, s[24:27], s76 offen offset:2048 lds
ds_read_b64_tr_b16 v[150:151], v20 offset:4672
v_mfma_f32_16x16x32_bf16 v[88:91], v[136:139], a[0:3], 0
ds_write_b128 v22, v[32:35] offset:12288
v_cvt_pk_bf16_f32 v40, v40, v41
v_mfma_f32_16x16x32_bf16 v[100:103], v[136:139], a[4:7], 0
v_cvt_pk_bf16_f32 v41, v42, v43
v_pk_max_i16 v40, v40, 0
v_mfma_f32_16x16x32_bf16 v[112:115], v[136:139], a[8:11], 0
v_pk_max_i16 v41, v41, 0
v_mfma_f32_16x16x32_bf16 v[124:127], v[136:139], a[12:15], 0
ds_write_b64 v23, v[40:41] offset:12288
s_waitcnt lgkmcnt(2)
v_mfma_f32_16x16x32_bf16 v[80:83], v[140:143], a[16:19], v[80:83]
s_waitcnt vmcnt(12)
v_cvt_pk_bf16_f32 v44, v44, v45
v_cvt_pk_bf16_f32 v45, v46, v47
v_mfma_f32_16x16x32_bf16 v[92:95], v[140:143], a[20:23], v[92:95]
ds_read_b64_tr_b16 v[128:129], v20 offset:6144
v_pk_max_i16 v44, v44, 0
v_pk_max_i16 v45, v45, 0
v_mfma_f32_16x16x32_bf16 v[104:107], v[140:143], a[24:27], v[104:107]
ds_read_b64_tr_b16 v[130:131], v20 offset:7680
s_add_u32 m0, s62, 3072
s_add_u32 s76, s61, 276480
v_mfma_f32_16x16x32_bf16 v[116:119], v[140:143], a[28:31], v[116:119]
ds_read_b64_tr_b16 v[132:133], v20 offset:6176
buffer_load_dwordx4 v17, s[24:27], s76 offen offset:0 lds
v_cvt_pk_bf16_f32 v46, v48, v49
v_mfma_f32_16x16x32_bf16 v[84:87], v[144:147], a[16:19], v[84:87]
ds_read_b64_tr_b16 v[134:135], v20 offset:7712
v_cvt_pk_bf16_f32 v47, v50, v51
v_pk_max_i16 v46, v46, 0
v_mfma_f32_16x16x32_bf16 v[96:99], v[144:147], a[20:23], v[96:99]
ds_read_b64_tr_b16 v[136:137], v20 offset:6208
v_pk_max_i16 v47, v47, 0
v_mfma_f32_16x16x32_bf16 v[108:111], v[144:147], a[24:27], v[108:111]
ds_read_b64_tr_b16 v[138:139], v20 offset:7744
buffer_load_dwordx4 v18, s[24:27], s76 offen offset:1024 lds
v_mfma_f32_16x16x32_bf16 v[120:123], v[144:147], a[28:31], v[120:123]
buffer_load_dwordx4 v19, s[24:27], s76 offen offset:2048 lds
v_mfma_f32_16x16x32_bf16 v[88:91], v[148:151], a[16:19], v[88:91]
ds_write_b128 v22, v[44:47] offset:30720
v_cvt_pk_bf16_f32 v52, v52, v53
v_mfma_f32_16x16x32_bf16 v[100:103], v[148:151], a[20:23], v[100:103]
v_cvt_pk_bf16_f32 v53, v54, v55
v_pk_max_i16 v52, v52, 0
v_mfma_f32_16x16x32_bf16 v[112:115], v[148:151], a[24:27], v[112:115]
v_pk_max_i16 v53, v53, 0
v_mfma_f32_16x16x32_bf16 v[124:127], v[148:151], a[28:31], v[124:127]
ds_write_b64 v23, v[52:53] offset:30720
s_waitcnt lgkmcnt(2)
v_mfma_f32_16x16x32_bf16 v[80:83], v[128:131], a[32:35], v[80:83]
s_waitcnt vmcnt(12)
v_cvt_pk_bf16_f32 v56, v56, v57
v_cvt_pk_bf16_f32 v57, v58, v59
v_mfma_f32_16x16x32_bf16 v[92:95], v[128:131], a[36:39], v[92:95]
ds_read_b64_tr_b16 v[140:141], v20 offset:9216
v_pk_max_i16 v56, v56, 0
v_pk_max_i16 v57, v57, 0
v_mfma_f32_16x16x32_bf16 v[104:107], v[128:131], a[40:43], v[104:107]
ds_read_b64_tr_b16 v[142:143], v20 offset:10752
s_add_u32 m0, s62, 6144
s_add_u32 s76, s61, 331776
v_mfma_f32_16x16x32_bf16 v[116:119], v[128:131], a[44:47], v[116:119]
ds_read_b64_tr_b16 v[144:145], v20 offset:9248
buffer_load_dwordx4 v17, s[24:27], s76 offen offset:0 lds
v_cvt_pk_bf16_f32 v58, v60, v61
v_mfma_f32_16x16x32_bf16 v[84:87], v[132:135], a[32:35], v[84:87]
ds_read_b64_tr_b16 v[146:147], v20 offset:10784
v_cvt_pk_bf16_f32 v59, v62, v63
v_pk_max_i16 v58, v58, 0
v_mfma_f32_16x16x32_bf16 v[96:99], v[132:135], a[36:39], v[96:99]
ds_read_b64_tr_b16 v[148:149], v20 offset:9280
v_pk_max_i16 v59, v59, 0
v_mfma_f32_16x16x32_bf16 v[108:111], v[132:135], a[40:43], v[108:111]
ds_read_b64_tr_b16 v[150:151], v20 offset:10816
buffer_load_dwordx4 v18, s[24:27], s76 offen offset:1024 lds
v_mfma_f32_16x16x32_bf16 v[120:123], v[132:135], a[44:47], v[120:123]
buffer_load_dwordx4 v19, s[24:27], s76 offen offset:2048 lds
v_mfma_f32_16x16x32_bf16 v[88:91], v[136:139], a[32:35], v[88:91]
ds_write_b128 v24, v[56:59] offset:12288
v_cvt_pk_bf16_f32 v64, v64, v65
v_mfma_f32_16x16x32_bf16 v[100:103], v[136:139], a[36:39], v[100:103]
v_cvt_pk_bf16_f32 v65, v66, v67
v_pk_max_i16 v64, v64, 0
v_mfma_f32_16x16x32_bf16 v[112:115], v[136:139], a[40:43], v[112:115]
v_pk_max_i16 v65, v65, 0
v_mfma_f32_16x16x32_bf16 v[124:127], v[136:139], a[44:47], v[124:127]
ds_write_b64 v25, v[64:65] offset:12288
s_waitcnt lgkmcnt(2)
v_mfma_f32_16x16x32_bf16 v[80:83], v[140:143], a[48:51], v[80:83]
s_waitcnt vmcnt(12)
v_cvt_pk_bf16_f32 v68, v68, v69
v_cvt_pk_bf16_f32 v69, v70, v71
v_mfma_f32_16x16x32_bf16 v[92:95], v[140:143], a[52:55], v[92:95]
ds_read_b64_tr_b16 v[128:129], v20 offset:12288
v_pk_max_i16 v68, v68, 0
v_pk_max_i16 v69, v69, 0
v_mfma_f32_16x16x32_bf16 v[104:107], v[140:143], a[56:59], v[104:107]
ds_read_b64_tr_b16 v[130:131], v20 offset:13824
s_add_u32 m0, s62, 9216
s_add_u32 s76, s61, 387072
v_mfma_f32_16x16x32_bf16 v[116:119], v[140:143], a[60:63], v[116:119]
ds_read_b64_tr_b16 v[132:133], v20 offset:12320
buffer_load_dwordx4 v17, s[24:27], s76 offen offset:0 lds
v_cvt_pk_bf16_f32 v70, v72, v73
v_mfma_f32_16x16x32_bf16 v[84:87], v[144:147], a[48:51], v[84:87]
ds_read_b64_tr_b16 v[134:135], v20 offset:13856
v_cvt_pk_bf16_f32 v71, v74, v75
v_pk_max_i16 v70, v70, 0
v_mfma_f32_16x16x32_bf16 v[96:99], v[144:147], a[52:55], v[96:99]
ds_read_b64_tr_b16 v[136:137], v20 offset:12352
v_pk_max_i16 v71, v71, 0
v_mfma_f32_16x16x32_bf16 v[108:111], v[144:147], a[56:59], v[108:111]
ds_read_b64_tr_b16 v[138:139], v20 offset:13888
buffer_load_dwordx4 v18, s[24:27], s76 offen offset:1024 lds
v_mfma_f32_16x16x32_bf16 v[120:123], v[144:147], a[60:63], v[120:123]
buffer_load_dwordx4 v19, s[24:27], s76 offen offset:2048 lds
v_mfma_f32_16x16x32_bf16 v[88:91], v[148:151], a[48:51], v[88:91]
ds_write_b128 v24, v[68:71] offset:30720
v_cvt_pk_bf16_f32 v76, v76, v77
v_mfma_f32_16x16x32_bf16 v[100:103], v[148:151], a[52:55], v[100:103]
v_cvt_pk_bf16_f32 v77, v78, v79
v_pk_max_i16 v76, v76, 0
v_mfma_f32_16x16x32_bf16 v[112:115], v[148:151], a[56:59], v[112:115]
v_pk_max_i16 v77, v77, 0
v_mfma_f32_16x16x32_bf16 v[124:127], v[148:151], a[60:63], v[124:127]
ds_write_b64 v25, v[76:77] offset:30720
s_waitcnt lgkmcnt(2)
v_mfma_f32_16x16x32_bf16 v[80:83], v[128:131], a[64:67], v[80:83]
s_waitcnt vmcnt(12)
s_add_u32 m0, s62, 12288
v_mfma_f32_16x16x32_bf16 v[92:95], v[128:131], a[68:71], v[92:95]
ds_read_b64_tr_b16 v[140:141], v20 offset:15360
s_add_u32 s76, s61, 258048
v_mfma_f32_16x16x32_bf16 v[104:107], v[128:131], a[72:75], v[104:107]
ds_read_b64_tr_b16 v[142:143], v20 offset:16896
buffer_load_dwordx4 v17, s[24:27], s76 offen offset:0 lds
v_mfma_f32_16x16x32_bf16 v[116:119], v[128:131], a[76:79], v[116:119]
ds_read_b64_tr_b16 v[144:145], v20 offset:15392
v_mfma_f32_16x16x32_bf16 v[84:87], v[132:135], a[64:67], v[84:87]
ds_read_b64_tr_b16 v[146:147], v20 offset:16928
buffer_load_dwordx4 v8, s[24:27], s76 offen offset:1024 lds
v_mfma_f32_16x16x32_bf16 v[96:99], v[132:135], a[68:71], v[96:99]
ds_read_b64_tr_b16 v[148:149], v20 offset:15424
v_mfma_f32_16x16x32_bf16 v[108:111], v[132:135], a[72:75], v[108:111]
ds_read_b64_tr_b16 v[150:151], v20 offset:16960
v_mfma_f32_16x16x32_bf16 v[120:123], v[132:135], a[76:79], v[120:123]
v_mfma_f32_16x16x32_bf16 v[88:91], v[136:139], a[64:67], v[88:91]
buffer_load_dwordx4 v0, s[24:27], s76 offen offset:2048 lds
v_mfma_f32_16x16x32_bf16 v[100:103], v[136:139], a[68:71], v[100:103]
v_mfma_f32_16x16x32_bf16 v[112:115], v[136:139], a[72:75], v[112:115]
v_mfma_f32_16x16x32_bf16 v[124:127], v[136:139], a[76:79], v[124:127]
s_waitcnt lgkmcnt(0)
v_mfma_f32_16x16x32_bf16 v[80:83], v[140:143], a[80:83], v[80:83]
s_waitcnt vmcnt(12)
s_add_u32 m0, s62, 15360
v_mfma_f32_16x16x32_bf16 v[92:95], v[140:143], a[84:87], v[92:95]
ds_read_b64_tr_b16 v[128:129], v20 offset:0
s_add_u32 s76, s61, 368640
v_mfma_f32_16x16x32_bf16 v[104:107], v[140:143], a[88:91], v[104:107]
ds_read_b64_tr_b16 v[130:131], v20 offset:1536
buffer_load_dwordx4 v17, s[24:27], s76 offen offset:0 lds
v_mfma_f32_16x16x32_bf16 v[116:119], v[140:143], a[92:95], v[116:119]
ds_read_b64_tr_b16 v[132:133], v20 offset:32
v_mfma_f32_16x16x32_bf16 v[84:87], v[144:147], a[80:83], v[84:87]
ds_read_b64_tr_b16 v[134:135], v20 offset:1568
buffer_load_dwordx4 v8, s[24:27], s76 offen offset:1024 lds
v_mfma_f32_16x16x32_bf16 v[96:99], v[144:147], a[84:87], v[96:99]
ds_read_b64_tr_b16 v[136:137], v20 offset:64
v_mfma_f32_16x16x32_bf16 v[108:111], v[144:147], a[88:91], v[108:111]
ds_read_b64_tr_b16 v[138:139], v20 offset:1600
v_mfma_f32_16x16x32_bf16 v[120:123], v[144:147], a[92:95], v[120:123]
v_mfma_f32_16x16x32_bf16 v[88:91], v[148:151], a[80:83], v[88:91]
buffer_load_dwordx4 v0, s[24:27], s76 offen offset:2048 lds
v_mfma_f32_16x16x32_bf16 v[100:103], v[148:151], a[84:87], v[100:103]
v_mfma_f32_16x16x32_bf16 v[112:115], v[148:151], a[88:91], v[112:115]
v_mfma_f32_16x16x32_bf16 v[124:127], v[148:151], a[92:95], v[124:127]
s_waitcnt lgkmcnt(0)
v_mfma_f32_16x16x32_bf16 v[80:83], v[128:131], a[96:99], v[80:83]
s_waitcnt vmcnt(12)
s_add_u32 m0, s62, 0
v_mfma_f32_16x16x32_bf16 v[92:95], v[128:131], a[100:103], v[92:95]
ds_read_b64_tr_b16 v[140:141], v20 offset:3072
s_add_u32 s76, s61, 442368
v_mfma_f32_16x16x32_bf16 v[104:107], v[128:131], a[104:107], v[104:107]
ds_read_b64_tr_b16 v[142:143], v20 offset:4608
buffer_load_dwordx4 v17, s[24:27], s76 offen offset:0 lds
v_mfma_f32_16x16x32_bf16 v[116:119], v[128:131], a[108:111], v[116:119]
ds_read_b64_tr_b16 v[144:145], v20 offset:3104
v_mfma_f32_16x16x32_bf16 v[84:87], v[132:135], a[96:99], v[84:87]
ds_read_b64_tr_b16 v[146:147], v20 offset:4640
buffer_load_dwordx4 v18, s[24:27], s76 offen offset:1024 lds
v_mfma_f32_16x16x32_bf16 v[96:99], v[132:135], a[100:103], v[96:99]
ds_read_b64_tr_b16 v[148:149], v20 offset:3136
v_mfma_f32_16x16x32_bf16 v[108:111], v[132:135], a[104:107], v[108:111]
ds_read_b64_tr_b16 v[150:151], v20 offset:4672
v_mfma_f32_16x16x32_bf16 v[120:123], v[132:135], a[108:111], v[120:123]
v_mfma_f32_16x16x32_bf16 v[88:91], v[136:139], a[96:99], v[88:91]
buffer_load_dwordx4 v19, s[24:27], s76 offen offset:2048 lds
v_mfma_f32_16x16x32_bf16 v[100:103], v[136:139], a[100:103], v[100:103]
v_mfma_f32_16x16x32_bf16 v[112:115], v[136:139], a[104:107], v[112:115]
v_mfma_f32_16x16x32_bf16 v[124:127], v[136:139], a[108:111], v[124:127]
s_waitcnt lgkmcnt(0)
v_mfma_f32_16x16x32_bf16 v[80:83], v[140:143], a[112:115], v[80:83]
s_waitcnt vmcnt(12)
s_add_u32 m0, s62, 3072
v_mfma_f32_16x16x32_bf16 v[92:95], v[140:143], a[116:119], v[92:95]
ds_read_b64_tr_b16 v[128:129], v20 offset:6144
s_add_u32 s76, s61, 497664
v_mfma_f32_16x16x32_bf16 v[104:107], v[140:143], a[120:123], v[104:107]
ds_read_b64_tr_b16 v[130:131], v20 offset:7680
buffer_load_dwordx4 v17, s[24:27], s76 offen offset:0 lds
v_mfma_f32_16x16x32_bf16 v[116:119], v[140:143], a[124:127], v[116:119]
ds_read_b64_tr_b16 v[132:133], v20 offset:6176
v_mfma_f32_16x16x32_bf16 v[84:87], v[144:147], a[112:115], v[84:87]
ds_read_b64_tr_b16 v[134:135], v20 offset:7712
buffer_load_dwordx4 v18, s[24:27], s76 offen offset:1024 lds
v_mfma_f32_16x16x32_bf16 v[96:99], v[144:147], a[116:119], v[96:99]
ds_read_b64_tr_b16 v[136:137], v20 offset:6208
v_mfma_f32_16x16x32_bf16 v[108:111], v[144:147], a[120:123], v[108:111]
ds_read_b64_tr_b16 v[138:139], v20 offset:7744
v_mfma_f32_16x16x32_bf16 v[120:123], v[144:147], a[124:127], v[120:123]
v_mfma_f32_16x16x32_bf16 v[88:91], v[148:151], a[112:115], v[88:91]
buffer_load_dwordx4 v19, s[24:27], s76 offen offset:2048 lds
v_mfma_f32_16x16x32_bf16 v[100:103], v[148:151], a[116:119], v[100:103]
v_mfma_f32_16x16x32_bf16 v[112:115], v[148:151], a[120:123], v[112:115]
v_mfma_f32_16x16x32_bf16 v[124:127], v[148:151], a[124:127], v[124:127]
s_waitcnt lgkmcnt(0)
v_mfma_f32_16x16x32_bf16 v[80:83], v[128:131], a[128:131], v[80:83]
s_waitcnt vmcnt(12)
s_add_u32 m0, s62, 6144
v_mfma_f32_16x16x32_bf16 v[92:95], v[128:131], a[132:135], v[92:95]
ds_read_b64_tr_b16 v[140:141], v20 offset:9216
s_add_u32 s76, s61, 552960
v_mfma_f32_16x16x32_bf16 v[104:107], v[128:131], a[136:139], v[104:107]
ds_read_b64_tr_b16 v[142:143], v20 offset:10752
buffer_load_dwordx4 v17, s[24:27], s76 offen offset:0 lds
v_mfma_f32_16x16x32_bf16 v[116:119], v[128:131], a[140:143], v[116:119]
ds_read_b64_tr_b16 v[144:145], v20 offset:9248
v_mfma_f32_16x16x32_bf16 v[84:87], v[132:135], a[128:131], v[84:87]
ds_read_b64_tr_b16 v[146:147], v20 offset:10784
buffer_load_dwordx4 v18, s[24:27], s76 offen offset:1024 lds
v_mfma_f32_16x16x32_bf16 v[96:99], v[132:135], a[132:135], v[96:99]
ds_read_b64_tr_b16 v[148:149], v20 offset:9280
v_mfma_f32_16x16x32_bf16 v[108:111], v[132:135], a[136:139], v[108:111]
ds_read_b64_tr_b16 v[150:151], v20 offset:10816
v_mfma_f32_16x16x32_bf16 v[120:123], v[132:135], a[140:143], v[120:123]
v_mfma_f32_16x16x32_bf16 v[88:91], v[136:139], a[128:131], v[88:91]
buffer_load_dwordx4 v19, s[24:27], s76 offen offset:2048 lds
v_mfma_f32_16x16x32_bf16 v[100:103], v[136:139], a[132:135], v[100:103]
v_mfma_f32_16x16x32_bf16 v[112:115], v[136:139], a[136:139], v[112:115]
v_mfma_f32_16x16x32_bf16 v[124:127], v[136:139], a[140:143], v[124:127]
s_waitcnt lgkmcnt(0)
v_mfma_f32_16x16x32_bf16 v[80:83], v[140:143], a[144:147], v[80:83]
s_waitcnt vmcnt(12)
s_add_u32 m0, s62, 9216
v_mfma_f32_16x16x32_bf16 v[92:95], v[140:143], a[148:151], v[92:95]
ds_read_b64_tr_b16 v[128:129], v20 offset:12288
s_add_u32 s76, s61, 608256
v_mfma_f32_16x16x32_bf16 v[104:107], v[140:143], a[152:155], v[104:107]
ds_read_b64_tr_b16 v[130:131], v20 offset:13824
buffer_load_dwordx4 v17, s[24:27], s76 offen offset:0 lds
v_mfma_f32_16x16x32_bf16 v[116:119], v[140:143], a[156:159], v[116:119]
ds_read_b64_tr_b16 v[132:133], v20 offset:12320
v_mfma_f32_16x16x32_bf16 v[84:87], v[144:147], a[144:147], v[84:87]
ds_read_b64_tr_b16 v[134:135], v20 offset:13856
buffer_load_dwordx4 v18, s[24:27], s76 offen offset:1024 lds
v_mfma_f32_16x16x32_bf16 v[96:99], v[144:147], a[148:151], v[96:99]
ds_read_b64_tr_b16 v[136:137], v20 offset:12352
v_mfma_f32_16x16x32_bf16 v[108:111], v[144:147], a[152:155], v[108:111]
ds_read_b64_tr_b16 v[138:139], v20 offset:13888
v_mfma_f32_16x16x32_bf16 v[120:123], v[144:147], a[156:159], v[120:123]
v_mfma_f32_16x16x32_bf16 v[88:91], v[148:151], a[144:147], v[88:91]
buffer_load_dwordx4 v19, s[24:27], s76 offen offset:2048 lds
v_mfma_f32_16x16x32_bf16 v[100:103], v[148:151], a[148:151], v[100:103]
v_mfma_f32_16x16x32_bf16 v[112:115], v[148:151], a[152:155], v[112:115]
v_mfma_f32_16x16x32_bf16 v[124:127], v[148:151], a[156:159], v[124:127]
s_waitcnt lgkmcnt(0)
s_waitcnt lgkmcnt(0)
s_barrier
v_mfma_f32_16x16x32_bf16 v[80:83], v[128:131], a[160:163], v[80:83]
ds_read_b128 a[192:195], v9 offset:12288
s_add_u32 m0, s62, 12288
v_mfma_f32_16x16x32_bf16 v[92:95], v[128:131], a[164:167], v[92:95]
ds_read_b128 a[196:199], v9 offset:30720
s_add_u32 s76, s61, 479232
v_mfma_f32_16x16x32_bf16 v[104:107], v[128:131], a[168:171], v[104:107]
ds_read_b128 a[200:203], v5 offset:12288
buffer_load_dwordx4 v17, s[24:27], s76 offen offset:0 lds
v_mfma_f32_16x16x32_bf16 v[116:119], v[128:131], a[172:175], v[116:119]
ds_read_b128 a[204:207], v5 offset:30720
v_mfma_f32_16x16x32_bf16 v[84:87], v[132:135], a[160:163], v[84:87]
s_waitcnt vmcnt(13)
ds_read_b64_tr_b16 v[140:141], v20 offset:15360
v_mfma_f32_16x16x32_bf16 v[96:99], v[132:135], a[164:167], v[96:99]
ds_read_b64_tr_b16 v[142:143], v20 offset:16896
buffer_load_dwordx4 v8, s[24:27], s76 offen offset:1024 lds
v_mfma_f32_16x16x32_bf16 v[108:111], v[132:135], a[168:171], v[108:111]
ds_read_b64_tr_b16 v[144:145], v20 offset:15392
v_mfma_f32_16x16x32_bf16 v[120:123], v[132:135], a[172:175], v[120:123]
ds_read_b64_tr_b16 v[146:147], v20 offset:16928
v_mfma_f32_16x16x32_bf16 v[88:91], v[136:139], a[160:163], v[88:91]
ds_read_b64_tr_b16 v[148:149], v20 offset:15424
buffer_load_dwordx4 v0, s[24:27], s76 offen offset:2048 lds
v_mfma_f32_16x16x32_bf16 v[100:103], v[136:139], a[164:167], v[100:103]
ds_read_b64_tr_b16 v[150:151], v20 offset:16960
v_mfma_f32_16x16x32_bf16 v[112:115], v[136:139], a[168:171], v[112:115]
v_mfma_f32_16x16x32_bf16 v[124:127], v[136:139], a[172:175], v[124:127]
s_waitcnt lgkmcnt(0)
v_mfma_f32_16x16x32_bf16 v[80:83], v[140:143], a[176:179], v[80:83]
ds_read_b128 a[208:211], v9 offset:13312
s_add_u32 m0, s62, 15360
v_mfma_f32_16x16x32_bf16 v[92:95], v[140:143], a[180:183], v[92:95]
ds_read_b128 a[212:215], v9 offset:31744
s_add_u32 s76, s61, 589824
v_mfma_f32_16x16x32_bf16 v[104:107], v[140:143], a[184:187], v[104:107]
ds_read_b128 a[216:219], v5 offset:13312
buffer_load_dwordx4 v17, s[24:27], s76 offen offset:0 lds
v_mfma_f32_16x16x32_bf16 v[116:119], v[140:143], a[188:191], v[116:119]
ds_read_b128 a[220:223], v5 offset:31744
v_mfma_f32_16x16x32_bf16 v[84:87], v[144:147], a[176:179], v[84:87]
s_waitcnt vmcnt(13)
ds_read_b64_tr_b16 v[128:129], v20 offset:0
v_mfma_f32_16x16x32_bf16 v[96:99], v[144:147], a[180:183], v[96:99]
ds_read_b64_tr_b16 v[130:131], v20 offset:1536
buffer_load_dwordx4 v8, s[24:27], s76 offen offset:1024 lds
v_mfma_f32_16x16x32_bf16 v[108:111], v[144:147], a[184:187], v[108:111]
ds_read_b64_tr_b16 v[132:133], v20 offset:32
v_mfma_f32_16x16x32_bf16 v[120:123], v[144:147], a[188:191], v[120:123]
ds_read_b64_tr_b16 v[134:135], v20 offset:1568
v_mfma_f32_16x16x32_bf16 v[88:91], v[148:151], a[176:179], v[88:91]
ds_read_b64_tr_b16 v[136:137], v20 offset:64
buffer_load_dwordx4 v0, s[24:27], s76 offen offset:2048 lds
v_mfma_f32_16x16x32_bf16 v[100:103], v[148:151], a[180:183], v[100:103]
ds_read_b64_tr_b16 v[138:139], v20 offset:1600
v_mfma_f32_16x16x32_bf16 v[112:115], v[148:151], a[184:187], v[112:115]
v_mfma_f32_16x16x32_bf16 v[124:127], v[148:151], a[188:191], v[124:127]
s_waitcnt lgkmcnt(0)
v_mfma_f32_16x16x32_bf16 v[80:83], v[128:131], a[192:195], v[80:83]
ds_read_b128 a[224:227], v9 offset:14336
s_add_u32 m0, s62, 0
v_mfma_f32_16x16x32_bf16 v[92:95], v[128:131], a[196:199], v[92:95]
ds_read_b128 a[228:231], v9 offset:32768
s_add_u32 s76, s61, 384
v_mfma_f32_16x16x32_bf16 v[104:107], v[128:131], a[200:203], v[104:107]
ds_read_b128 a[232:235], v5 offset:14336
buffer_load_dwordx4 v17, s[24:27], s76 offen offset:0 lds
v_mfma_f32_16x16x32_bf16 v[116:119], v[128:131], a[204:207], v[116:119]
ds_read_b128 a[236:239], v5 offset:32768
v_mfma_f32_16x16x32_bf16 v[84:87], v[132:135], a[192:195], v[84:87]
s_waitcnt vmcnt(13)
ds_read_b64_tr_b16 v[140:141], v20 offset:3072
v_mfma_f32_16x16x32_bf16 v[96:99], v[132:135], a[196:199], v[96:99]
ds_read_b64_tr_b16 v[142:143], v20 offset:4608
buffer_load_dwordx4 v18, s[24:27], s76 offen offset:1024 lds
v_mfma_f32_16x16x32_bf16 v[108:111], v[132:135], a[200:203], v[108:111]
ds_read_b64_tr_b16 v[144:145], v20 offset:3104
v_mfma_f32_16x16x32_bf16 v[120:123], v[132:135], a[204:207], v[120:123]
ds_read_b64_tr_b16 v[146:147], v20 offset:4640
v_mfma_f32_16x16x32_bf16 v[88:91], v[136:139], a[192:195], v[88:91]
ds_read_b64_tr_b16 v[148:149], v20 offset:3136
buffer_load_dwordx4 v19, s[24:27], s76 offen offset:2048 lds
v_mfma_f32_16x16x32_bf16 v[100:103], v[136:139], a[196:199], v[100:103]
ds_read_b64_tr_b16 v[150:151], v20 offset:4672
v_mfma_f32_16x16x32_bf16 v[112:115], v[136:139], a[200:203], v[112:115]
v_mfma_f32_16x16x32_bf16 v[124:127], v[136:139], a[204:207], v[124:127]
s_waitcnt lgkmcnt(0)
v_mfma_f32_16x16x32_bf16 v[80:83], v[140:143], a[208:211], v[80:83]
ds_read_b128 a[240:243], v9 offset:15360
s_add_u32 m0, s62, 3072
v_mfma_f32_16x16x32_bf16 v[92:95], v[140:143], a[212:215], v[92:95]
ds_read_b128 a[244:247], v9 offset:33792
s_add_u32 s76, s61, 55680
v_mfma_f32_16x16x32_bf16 v[104:107], v[140:143], a[216:219], v[104:107]
ds_read_b128 a[248:251], v5 offset:15360
buffer_load_dwordx4 v17, s[24:27], s76 offen offset:0 lds
v_mfma_f32_16x16x32_bf16 v[116:119], v[140:143], a[220:223], v[116:119]
ds_read_b128 a[252:255], v5 offset:33792
v_mfma_f32_16x16x32_bf16 v[84:87], v[144:147], a[208:211], v[84:87]
s_waitcnt vmcnt(13)
ds_read_b64_tr_b16 v[128:129], v20 offset:6144
v_mfma_f32_16x16x32_bf16 v[96:99], v[144:147], a[212:215], v[96:99]
ds_read_b64_tr_b16 v[130:131], v20 offset:7680
buffer_load_dwordx4 v18, s[24:27], s76 offen offset:1024 lds
v_mfma_f32_16x16x32_bf16 v[108:111], v[144:147], a[216:219], v[108:111]
ds_read_b64_tr_b16 v[132:133], v20 offset:6176
v_mfma_f32_16x16x32_bf16 v[120:123], v[144:147], a[220:223], v[120:123]
ds_read_b64_tr_b16 v[134:135], v20 offset:7712
v_mfma_f32_16x16x32_bf16 v[88:91], v[148:151], a[208:211], v[88:91]
ds_read_b64_tr_b16 v[136:137], v20 offset:6208
buffer_load_dwordx4 v19, s[24:27], s76 offen offset:2048 lds
v_mfma_f32_16x16x32_bf16 v[100:103], v[148:151], a[212:215], v[100:103]
ds_read_b64_tr_b16 v[138:139], v20 offset:7744
v_mfma_f32_16x16x32_bf16 v[112:115], v[148:151], a[216:219], v[112:115]
v_mfma_f32_16x16x32_bf16 v[124:127], v[148:151], a[220:223], v[124:127]
s_waitcnt lgkmcnt(0)
v_mfma_f32_16x16x32_bf16 v[80:83], v[128:131], a[224:227], v[80:83]
ds_read_b128 v[224:227], v9 offset:16384
s_add_u32 m0, s62, 6144
v_mfma_f32_16x16x32_bf16 v[92:95], v[128:131], a[228:231], v[92:95]
ds_read_b128 v[228:231], v9 offset:34816
s_add_u32 s76, s61, 110976
v_mfma_f32_16x16x32_bf16 v[104:107], v[128:131], a[232:235], v[104:107]
ds_read_b128 v[232:235], v5 offset:16384
buffer_load_dwordx4 v17, s[24:27], s76 offen offset:0 lds
v_mfma_f32_16x16x32_bf16 v[116:119], v[128:131], a[236:239], v[116:119]
ds_read_b128 v[236:239], v5 offset:34816
v_mfma_f32_16x16x32_bf16 v[84:87], v[132:135], a[224:227], v[84:87]
s_waitcnt vmcnt(13)
ds_read_b64_tr_b16 v[140:141], v20 offset:9216
v_mfma_f32_16x16x32_bf16 v[96:99], v[132:135], a[228:231], v[96:99]
ds_read_b64_tr_b16 v[142:143], v20 offset:10752
buffer_load_dwordx4 v18, s[24:27], s76 offen offset:1024 lds
v_mfma_f32_16x16x32_bf16 v[108:111], v[132:135], a[232:235], v[108:111]
ds_read_b64_tr_b16 v[144:145], v20 offset:9248
v_mfma_f32_16x16x32_bf16 v[120:123], v[132:135], a[236:239], v[120:123]
ds_read_b64_tr_b16 v[146:147], v20 offset:10784
v_mfma_f32_16x16x32_bf16 v[88:91], v[136:139], a[224:227], v[88:91]
ds_read_b64_tr_b16 v[148:149], v20 offset:9280
buffer_load_dwordx4 v19, s[24:27], s76 offen offset:2048 lds
v_mfma_f32_16x16x32_bf16 v[100:103], v[136:139], a[228:231], v[100:103]
ds_read_b64_tr_b16 v[150:151], v20 offset:10816
v_mfma_f32_16x16x32_bf16 v[112:115], v[136:139], a[232:235], v[112:115]
v_mfma_f32_16x16x32_bf16 v[124:127], v[136:139], a[236:239], v[124:127]
s_waitcnt lgkmcnt(0)
v_mfma_f32_16x16x32_bf16 v[80:83], v[140:143], a[240:243], v[80:83]
ds_read_b128 v[240:243], v9 offset:17408
s_add_u32 m0, s62, 9216
v_mfma_f32_16x16x32_bf16 v[92:95], v[140:143], a[244:247], v[92:95]
ds_read_b128 v[244:247], v9 offset:35840
s_add_u32 s76, s61, 166272
v_mfma_f32_16x16x32_bf16 v[104:107], v[140:143], a[248:251], v[104:107]
ds_read_b128 v[248:251], v5 offset:17408
buffer_load_dwordx4 v17, s[24:27], s76 offen offset:0 lds
v_mfma_f32_16x16x32_bf16 v[116:119], v[140:143], a[252:255], v[116:119]
ds_read_b128 v[252:255], v5 offset:35840
v_mfma_f32_16x16x32_bf16 v[84:87], v[144:147], a[240:243], v[84:87]
s_waitcnt vmcnt(13)
ds_read_b64_tr_b16 v[128:129], v20 offset:12288
v_mfma_f32_16x16x32_bf16 v[96:99], v[144:147], a[244:247], v[96:99]
ds_read_b64_tr_b16 v[130:131], v20 offset:13824
buffer_load_dwordx4 v18, s[24:27], s76 offen offset:1024 lds
v_mfma_f32_16x16x32_bf16 v[108:111], v[144:147], a[248:251], v[108:111]
ds_read_b64_tr_b16 v[132:133], v20 offset:12320
v_mfma_f32_16x16x32_bf16 v[120:123], v[144:147], a[252:255], v[120:123]
ds_read_b64_tr_b16 v[134:135], v20 offset:13856
v_mfma_f32_16x16x32_bf16 v[88:91], v[148:151], a[240:243], v[88:91]
ds_read_b64_tr_b16 v[136:137], v20 offset:12352
buffer_load_dwordx4 v19, s[24:27], s76 offen offset:2048 lds
v_mfma_f32_16x16x32_bf16 v[100:103], v[148:151], a[244:247], v[100:103]
ds_read_b64_tr_b16 v[138:139], v20 offset:13888
v_mfma_f32_16x16x32_bf16 v[112:115], v[148:151], a[248:251], v[112:115]
v_mfma_f32_16x16x32_bf16 v[124:127], v[148:151], a[252:255], v[124:127]
s_waitcnt lgkmcnt(0)
v_mfma_f32_16x16x32_bf16 v[80:83], v[128:131], v[224:227], v[80:83]
s_waitcnt vmcnt(12)
v_bfe_u32 v2, v1, 2, 2
v_mfma_f32_16x16x32_bf16 v[92:95], v[128:131], v[228:231], v[92:95]
ds_read_b64_tr_b16 v[140:141], v20 offset:15360
s_add_u32 m0, s62, 12288
v_mfma_f32_16x16x32_bf16 v[104:107], v[128:131], v[232:235], v[104:107]
ds_read_b64_tr_b16 v[142:143], v20 offset:16896
s_add_u32 s76, s61, 37248
v_mfma_f32_16x16x32_bf16 v[116:119], v[128:131], v[236:239], v[116:119]
ds_read_b64_tr_b16 v[144:145], v20 offset:15392
buffer_load_dwordx4 v17, s[24:27], s76 offen offset:0 lds
v_mfma_f32_16x16x32_bf16 v[84:87], v[132:135], v[224:227], v[84:87]
ds_read_b64_tr_b16 v[146:147], v20 offset:16928
s_and_b32 s69, s52, 3
v_mfma_f32_16x16x32_bf16 v[96:99], v[132:135], v[228:231], v[96:99]
ds_read_b64_tr_b16 v[148:149], v20 offset:15424
s_lshl_b32 s69, s69, 2
v_mfma_f32_16x16x32_bf16 v[108:111], v[132:135], v[232:235], v[108:111]
ds_read_b64_tr_b16 v[150:151], v20 offset:16960
buffer_load_dwordx4 v8, s[24:27], s76 offen offset:1024 lds
v_mfma_f32_16x16x32_bf16 v[120:123], v[132:135], v[236:239], v[120:123]
v_add_u32 v3, s69, v16
v_add_u32 v4, s69, v2
v_mfma_f32_16x16x32_bf16 v[88:91], v[136:139], v[224:227], v[88:91]
s_mul_i32 s70, s48, 48
s_lshr_b32 s71, s52, 2
v_mfma_f32_16x16x32_bf16 v[100:103], v[136:139], v[228:231], v[100:103]
buffer_load_dwordx4 v0, s[24:27], s76 offen offset:2048 lds
s_lshl_b32 s71, s71, 1
v_mfma_f32_16x16x32_bf16 v[112:115], v[136:139], v[232:235], v[112:115]
v_lshl_add_u32 v27, v16, 2, v2
v_lshl_add_u32 v27, v7, 4, v27
v_mfma_f32_16x16x32_bf16 v[124:127], v[136:139], v[236:239], v[124:127]
s_waitcnt lgkmcnt(0)
v_mfma_f32_16x16x32_bf16 v[80:83], v[140:143], v[240:243], v[80:83]
s_waitcnt vmcnt(12)
v_lshlrev_b32 v27, 2, v27
v_mfma_f32_16x16x32_bf16 v[92:95], v[140:143], v[244:247], v[92:95]
ds_read_b64_tr_b16 v[128:129], v20 offset:0
v_lshlrev_b32 v30, 7, v1
v_mfma_f32_16x16x32_bf16 v[104:107], v[140:143], v[248:251], v[104:107]
ds_read_b64_tr_b16 v[130:131], v20 offset:1536
s_add_u32 m0, s62, 15360
v_mfma_f32_16x16x32_bf16 v[116:119], v[140:143], v[252:255], v[116:119]
ds_read_b64_tr_b16 v[132:133], v20 offset:32
s_add_u32 s76, s61, 147840
v_mfma_f32_16x16x32_bf16 v[84:87], v[144:147], v[240:243], v[84:87]
ds_read_b64_tr_b16 v[134:135], v20 offset:1568
buffer_load_dwordx4 v17, s[24:27], s76 offen offset:0 lds
v_mfma_f32_16x16x32_bf16 v[96:99], v[144:147], v[244:247], v[96:99]
ds_read_b64_tr_b16 v[136:137], v20 offset:64
s_mul_i32 s65, s51, 73728
v_mfma_f32_16x16x32_bf16 v[108:111], v[144:147], v[248:251], v[108:111]
ds_read_b64_tr_b16 v[138:139], v20 offset:1600
buffer_load_dwordx4 v8, s[24:27], s76 offen offset:1024 lds
v_mfma_f32_16x16x32_bf16 v[120:123], v[144:147], v[252:255], v[120:123]
s_add_u32 s66, s65, 1048576
s_mov_b32 s67, 158976
v_mfma_f32_16x16x32_bf16 v[88:91], v[148:151], v[240:243], v[88:91]
s_mul_i32 s68, s51, 24
s_add_u32 s68, s68, s48
v_mfma_f32_16x16x32_bf16 v[100:103], v[148:151], v[244:247], v[100:103]
buffer_load_dwordx4 v0, s[24:27], s76 offen offset:2048 lds
s_lshl_b32 s68, s68, 10
v_mfma_f32_16x16x32_bf16 v[112:115], v[148:151], v[248:251], v[112:115]
s_add_u32 s68, s68, 196608
v_lshl_add_u32 v10, v7, 1, 0
v_mfma_f32_16x16x32_bf16 v[124:127], v[148:151], v[252:255], v[124:127]
s_waitcnt lgkmcnt(0)
s_barrier
v_mfma_f32_16x16x32_bf16 v[32:35], v[128:131], a[0:3], 0
s_waitcnt vmcnt(12)
v_cvt_pk_bf16_f32 v80, v80, v81
v_mfma_f32_16x16x32_bf16 v[44:47], v[128:131], a[4:7], 0
ds_read_b64_tr_b16 v[140:141], v20 offset:3072
v_cvt_pk_bf16_f32 v81, v82, v83
v_mfma_f32_16x16x32_bf16 v[56:59], v[128:131], a[8:11], 0
ds_read_b64_tr_b16 v[142:143], v20 offset:4608
s_add_u32 m0, s62, 0
v_mfma_f32_16x16x32_bf16 v[68:71], v[128:131], a[12:15], 0
ds_read_b64_tr_b16 v[144:145], v20 offset:3104
s_add_u32 s76, s61, 221568
v_mfma_f32_16x16x32_bf16 v[36:39], v[132:135], a[0:3], 0
ds_read_b64_tr_b16 v[146:147], v20 offset:4640
buffer_load_dwordx4 v17, s[24:27], s76 offen offset:0 lds
v_mfma_f32_16x16x32_bf16 v[48:51], v[132:135], a[4:7], 0
ds_read_b64_tr_b16 v[148:149], v20 offset:3136
v_cvt_pk_bf16_f32 v82, v84, v85
v_mfma_f32_16x16x32_bf16 v[60:63], v[132:135], a[8:11], 0
ds_read_b64_tr_b16 v[150:151], v20 offset:4672
buffer_load_dwordx4 v18, s[24:27], s76 offen offset:1024 lds
v_mfma_f32_16x16x32_bf16 v[72:75], v[132:135], a[12:15], 0
buffer_load_dwordx4 v19, s[24:27], s76 offen offset:2048 lds
v_cvt_pk_bf16_f32 v83, v86, v87
v_mfma_f32_16x16x32_bf16 v[40:43], v[136:139], a[0:3], 0
s_add_u32 s53, s64, 0
buffer_store_dwordx4 v[80:83], v26, s[44:47], s53 offen offset:0 sc1
v_mfma_f32_16x16x32_bf16 v[52:55], v[136:139], a[4:7], 0
v_mul_u32_u24 v11, 11, v10
v_lshrrev_b32 v11, 5, v11
v_mfma_f32_16x16x32_bf16 v[64:67], v[136:139], a[8:11], 0
v_mul_u32_u24 v12, 3, v11
v_sub_u32 v12, v10, v12
v_mfma_f32_16x16x32_bf16 v[76:79], v[136:139], a[12:15], 0
v_lshl_add_u32 v12, v12, 4, s70
s_waitcnt lgkmcnt(0)
v_mfma_f32_16x16x32_bf16 v[32:35], v[140:143], a[16:19], v[32:35]
s_waitcnt vmcnt(13)
v_cvt_pk_bf16_f32 v84, v88, v89
v_mfma_f32_16x16x32_bf16 v[44:47], v[140:143], a[20:23], v[44:47]
ds_read_b64_tr_b16 v[128:129], v20 offset:6144
v_cvt_pk_bf16_f32 v85, v90, v91
v_mfma_f32_16x16x32_bf16 v[56:59], v[140:143], a[24:27], v[56:59]
ds_read_b64_tr_b16 v[130:131], v20 offset:7680
s_add_u32 m0, s62, 3072
v_mfma_f32_16x16x32_bf16 v[68:71], v[140:143], a[28:31], v[68:71]
ds_read_b64_tr_b16 v[132:133], v20 offset:6176
s_add_u32 s76, s61, 276864
v_mfma_f32_16x16x32_bf16 v[36:39], v[144:147], a[16:19], v[36:39]
ds_read_b64_tr_b16 v[134:135], v20 offset:7712
buffer_load_dwordx4 v17, s[24:27], s76 offen offset:0 lds
v_mfma_f32_16x16x32_bf16 v[48:51], v[144:147], a[20:23], v[48:51]
ds_read_b64_tr_b16 v[136:137], v20 offset:6208
v_cvt_pk_bf16_f32 v86, v92, v93
v_mfma_f32_16x16x32_bf16 v[60:63], v[144:147], a[24:27], v[60:63]
ds_read_b64_tr_b16 v[138:139], v20 offset:7744
buffer_load_dwordx4 v18, s[24:27], s76 offen offset:1024 lds
v_mfma_f32_16x16x32_bf16 v[72:75], v[144:147], a[28:31], v[72:75]
v_cvt_pk_bf16_f32 v87, v94, v95
s_add_u32 s53, s64, 0
v_mfma_f32_16x16x32_bf16 v[40:43], v[148:151], a[16:19], v[40:43]
buffer_store_dwordx4 v[84:87], v26, s[44:47], s53 offen offset:256 sc1
v_add_u32 v11, s71, v11
v_mfma_f32_16x16x32_bf16 v[52:55], v[148:151], a[20:23], v[52:55]
v_lshl_add_u32 v13, v11, 4, v4
v_mul_u32_u24 v13, 1152, v13
v_mfma_f32_16x16x32_bf16 v[64:67], v[148:151], a[24:27], v[64:67]
buffer_load_dwordx4 v19, s[24:27], s76 offen offset:2048 lds
v_lshl_add_u32 v14, v16, 2, v12
v_mfma_f32_16x16x32_bf16 v[76:79], v[148:151], a[28:31], v[76:79]
v_lshl_add_u32 v22, v14, 1, v13
s_waitcnt lgkmcnt(0)
v_mfma_f32_16x16x32_bf16 v[32:35], v[128:131], a[32:35], v[32:35]
s_waitcnt vmcnt(14)
v_cvt_pk_bf16_f32 v88, v96, v97
v_mfma_f32_16x16x32_bf16 v[44:47], v[128:131], a[36:39], v[44:47]
ds_read_b64_tr_b16 v[140:141], v20 offset:9216
v_cvt_pk_bf16_f32 v89, v98, v99
v_mfma_f32_16x16x32_bf16 v[56:59], v[128:131], a[40:43], v[56:59]
ds_read_b64_tr_b16 v[142:143], v20 offset:10752
s_add_u32 m0, s62, 6144
v_mfma_f32_16x16x32_bf16 v[68:71], v[128:131], a[44:47], v[68:71]
ds_read_b64_tr_b16 v[144:145], v20 offset:9248
s_add_u32 s76, s61, 332160
v_mfma_f32_16x16x32_bf16 v[36:39], v[132:135], a[32:35], v[36:39]
ds_read_b64_tr_b16 v[146:147], v20 offset:10784
buffer_load_dwordx4 v17, s[24:27], s76 offen offset:0 lds
v_mfma_f32_16x16x32_bf16 v[48:51], v[132:135], a[36:39], v[48:51]
ds_read_b64_tr_b16 v[148:149], v20 offset:9280
v_cvt_pk_bf16_f32 v90, v100, v101
v_mfma_f32_16x16x32_bf16 v[60:63], v[132:135], a[40:43], v[60:63]
ds_read_b64_tr_b16 v[150:151], v20 offset:10816
buffer_load_dwordx4 v18, s[24:27], s76 offen offset:1024 lds
v_mfma_f32_16x16x32_bf16 v[72:75], v[132:135], a[44:47], v[72:75]
v_cvt_pk_bf16_f32 v91, v102, v103
s_add_u32 s53, s64, 0
v_mfma_f32_16x16x32_bf16 v[40:43], v[136:139], a[32:35], v[40:43]
buffer_store_dwordx4 v[88:91], v26, s[44:47], s53 offen offset:512 sc1
v_lshl_add_u32 v12, v2, 2, v12
v_mfma_f32_16x16x32_bf16 v[52:55], v[136:139], a[36:39], v[52:55]
v_lshl_add_u32 v24, v12, 2, s67
v_mul_u32_u24 v11, 18432, v11
v_mfma_f32_16x16x32_bf16 v[64:67], v[136:139], a[40:43], v[64:67]
buffer_load_dwordx4 v19, s[24:27], s76 offen offset:2048 lds
v_lshl_add_u32 v11, v3, 4, v11
v_mfma_f32_16x16x32_bf16 v[76:79], v[136:139], a[44:47], v[76:79]
v_add_u32 v13, 0, v12
s_waitcnt lgkmcnt(0)
s_barrier
v_mfma_f32_16x16x32_bf16 v[32:35], v[140:143], a[48:51], v[32:35]
s_waitcnt vmcnt(15)
v_cvt_pk_bf16_f32 v92, v104, v105
v_mfma_f32_16x16x32_bf16 v[44:47], v[140:143], a[52:55], v[44:47]
ds_read_b64_tr_b16 v[128:129], v20 offset:12288
v_cvt_pk_bf16_f32 v93, v106, v107
v_mfma_f32_16x16x32_bf16 v[56:59], v[140:143], a[56:59], v[56:59]
ds_read_b64_tr_b16 v[130:131], v20 offset:13824
s_add_u32 m0, s62, 9216
v_mfma_f32_16x16x32_bf16 v[68:71], v[140:143], a[60:63], v[68:71]
ds_read_b64_tr_b16 v[132:133], v20 offset:12320
s_add_u32 s76, s61, 387456
v_mfma_f32_16x16x32_bf16 v[36:39], v[144:147], a[48:51], v[36:39]
ds_read_b64_tr_b16 v[134:135], v20 offset:13856
buffer_load_dwordx4 v17, s[24:27], s76 offen offset:0 lds
v_mfma_f32_16x16x32_bf16 v[48:51], v[144:147], a[52:55], v[48:51]
ds_read_b64_tr_b16 v[136:137], v20 offset:12352
v_cvt_pk_bf16_f32 v94, v108, v109
v_mfma_f32_16x16x32_bf16 v[60:63], v[144:147], a[56:59], v[60:63]
ds_read_b64_tr_b16 v[138:139], v20 offset:13888
buffer_load_dwordx4 v18, s[24:27], s76 offen offset:1024 lds
v_mfma_f32_16x16x32_bf16 v[72:75], v[144:147], a[60:63], v[72:75]
v_cvt_pk_bf16_f32 v95, v110, v111
s_add_u32 s53, s64, 98304
v_mfma_f32_16x16x32_bf16 v[40:43], v[148:151], a[48:51], v[40:43]
buffer_store_dwordx4 v[92:95], v26, s[44:47], s53 offen offset:0 sc1
v_mul_u32_u24 v14, 911, v13
v_mfma_f32_16x16x32_bf16 v[52:55], v[148:151], a[52:55], v[52:55]
v_lshrrev_b32 v14, 16, v14
v_mul_u32_u24 v15, 72, v14
v_mfma_f32_16x16x32_bf16 v[64:67], v[148:151], a[56:59], v[64:67]
buffer_load_dwordx4 v19, s[24:27], s76 offen offset:2048 lds
v_sub_u32 v15, v13, v15
v_mfma_f32_16x16x32_bf16 v[76:79], v[148:151], a[60:63], v[76:79]
v_cmp_gt_u32 s[40:41], 64, v15
s_waitcnt lgkmcnt(0)
v_mfma_f32_16x16x32_bf16 v[32:35], v[128:131], a[64:67], v[32:35]
s_waitcnt vmcnt(16)
v_cvt_pk_bf16_f32 v96, v112, v113
v_mfma_f32_16x16x32_bf16 v[44:47], v[128:131], a[68:71], v[44:47]
ds_read_b64_tr_b16 v[140:141], v20 offset:15360
v_cvt_pk_bf16_f32 v97, v114, v115
v_mfma_f32_16x16x32_bf16 v[56:59], v[128:131], a[72:75], v[56:59]
ds_read_b64_tr_b16 v[142:143], v20 offset:16896
s_add_u32 m0, s62, 12288
v_mfma_f32_16x16x32_bf16 v[68:71], v[128:131], a[76:79], v[68:71]
ds_read_b64_tr_b16 v[144:145], v20 offset:15392
s_add_u32 s76, s61, 258432
v_mfma_f32_16x16x32_bf16 v[36:39], v[132:135], a[64:67], v[36:39]
ds_read_b64_tr_b16 v[146:147], v20 offset:16928
buffer_load_dwordx4 v17, s[24:27], s76 offen offset:0 lds
v_mfma_f32_16x16x32_bf16 v[48:51], v[132:135], a[68:71], v[48:51]
ds_read_b64_tr_b16 v[148:149], v20 offset:15424
v_cvt_pk_bf16_f32 v98, v116, v117
v_mfma_f32_16x16x32_bf16 v[60:63], v[132:135], a[72:75], v[60:63]
ds_read_b64_tr_b16 v[150:151], v20 offset:16960
buffer_load_dwordx4 v8, s[24:27], s76 offen offset:1024 lds
v_mfma_f32_16x16x32_bf16 v[72:75], v[132:135], a[76:79], v[72:75]
v_cvt_pk_bf16_f32 v99, v118, v119
s_add_u32 s53, s64, 98304
v_mfma_f32_16x16x32_bf16 v[40:43], v[136:139], a[64:67], v[40:43]
buffer_store_dwordx4 v[96:99], v26, s[44:47], s53 offen offset:256 sc1
v_lshrrev_b32 v28, 5, v15
v_mfma_f32_16x16x32_bf16 v[52:55], v[136:139], a[68:71], v[52:55]
v_lshl_add_u32 v28, v14, 1, v28
v_lshlrev_b32 v28, 10, v28
v_mfma_f32_16x16x32_bf16 v[64:67], v[136:139], a[72:75], v[64:67]
buffer_load_dwordx4 v0, s[24:27], s76 offen offset:2048 lds
v_bfe_u32 v29, v15, 2, 2
v_mfma_f32_16x16x32_bf16 v[76:79], v[136:139], a[76:79], v[76:79]
v_lshl_add_u32 v28, v29, 8, v28
s_waitcnt lgkmcnt(0)
v_mfma_f32_16x16x32_bf16 v[32:35], v[140:143], a[80:83], v[32:35]
s_waitcnt vmcnt(17)
v_cvt_pk_bf16_f32 v100, v120, v121
v_mfma_f32_16x16x32_bf16 v[44:47], v[140:143], a[84:87], v[44:47]
ds_read_b64_tr_b16 v[128:129], v20 offset:0
v_cvt_pk_bf16_f32 v101, v122, v123
v_mfma_f32_16x16x32_bf16 v[56:59], v[140:143], a[88:91], v[56:59]
ds_read_b64_tr_b16 v[130:131], v20 offset:1536
s_add_u32 m0, s62, 15360
v_mfma_f32_16x16x32_bf16 v[68:71], v[140:143], a[92:95], v[68:71]
ds_read_b64_tr_b16 v[132:133], v20 offset:32
s_add_u32 s76, s61, 369024
v_mfma_f32_16x16x32_bf16 v[36:39], v[144:147], a[80:83], v[36:39]
ds_read_b64_tr_b16 v[134:135], v20 offset:1568
buffer_load_dwordx4 v17, s[24:27], s76 offen offset:0 lds
v_mfma_f32_16x16x32_bf16 v[48:51], v[144:147], a[84:87], v[48:51]
ds_read_b64_tr_b16 v[136:137], v20 offset:64
v_cvt_pk_bf16_f32 v102, v124, v125
v_mfma_f32_16x16x32_bf16 v[60:63], v[144:147], a[88:91], v[60:63]
ds_read_b64_tr_b16 v[138:139], v20 offset:1600
buffer_load_dwordx4 v8, s[24:27], s76 offen offset:1024 lds
v_mfma_f32_16x16x32_bf16 v[72:75], v[144:147], a[92:95], v[72:75]
v_cvt_pk_bf16_f32 v103, v126, v127
s_add_u32 s53, s64, 98304
v_mfma_f32_16x16x32_bf16 v[40:43], v[148:151], a[80:83], v[40:43]
buffer_store_dwordx4 v[100:103], v26, s[44:47], s53 offen offset:512 sc1
v_bfe_u32 v29, v15, 4, 1
v_mfma_f32_16x16x32_bf16 v[52:55], v[148:151], a[84:87], v[52:55]
v_lshl_add_u32 v28, v29, 3, v28
v_lshlrev_b32 v14, 8, v14
v_mfma_f32_16x16x32_bf16 v[64:67], v[148:151], a[88:91], v[64:67]
buffer_load_dwordx4 v0, s[24:27], s76 offen offset:2048 lds
v_bfe_u32 v29, v15, 2, 1
v_mfma_f32_16x16x32_bf16 v[76:79], v[148:151], a[92:95], v[76:79]
v_lshl_add_u32 v14, v29, 3, v14
s_waitcnt lgkmcnt(0)
s_barrier
v_mfma_f32_16x16x32_bf16 v[32:35], v[128:131], a[96:99], v[32:35]
s_waitcnt vmcnt(16)
v_add_u32 v14, 16384, v14
v_cndmask_b32 v14, v14, v28, s[40:41]
v_mfma_f32_16x16x32_bf16 v[44:47], v[128:131], a[100:103], v[44:47]
ds_read_b64_tr_b16 v[140:141], v20 offset:3072
v_add_u32 v14, v14, v11
v_mfma_f32_16x16x32_bf16 v[56:59], v[128:131], a[104:107], v[56:59]
ds_read_b64_tr_b16 v[142:143], v20 offset:4608
s_add_u32 m0, s62, 0
v_mfma_f32_16x16x32_bf16 v[68:71], v[128:131], a[108:111], v[68:71]
ds_read_b64_tr_b16 v[144:145], v20 offset:3104
s_add_u32 s76, s61, 442752
v_mfma_f32_16x16x32_bf16 v[36:39], v[132:135], a[96:99], v[36:39]
ds_read_b64_tr_b16 v[146:147], v20 offset:4640
buffer_load_dwordx4 v17, s[24:27], s76 offen offset:0 lds
v_mfma_f32_16x16x32_bf16 v[48:51], v[132:135], a[100:103], v[48:51]
ds_read_b64_tr_b16 v[148:149], v20 offset:3136
s_mov_b32 exec_hi, 0xffff
v_mfma_f32_16x16x32_bf16 v[60:63], v[132:135], a[104:107], v[60:63]
buffer_load_dwordx2 v[152:153], v14, s[44:47], s66 offen sc1
s_mov_b32 exec_hi, -1
v_mfma_f32_16x16x32_bf16 v[72:75], v[132:135], a[108:111], v[72:75]
ds_read_b64_tr_b16 v[150:151], v20 offset:4672
buffer_load_dwordx4 v18, s[24:27], s76 offen offset:1024 lds
v_mfma_f32_16x16x32_bf16 v[40:43], v[136:139], a[96:99], v[40:43]
v_add_u32 v13, 192, v12
v_mul_u32_u24 v14, 911, v13
v_mfma_f32_16x16x32_bf16 v[52:55], v[136:139], a[100:103], v[52:55]
v_lshrrev_b32 v14, 16, v14
v_mul_u32_u24 v15, 72, v14
v_mfma_f32_16x16x32_bf16 v[64:67], v[136:139], a[104:107], v[64:67]
buffer_load_dwordx4 v19, s[24:27], s76 offen offset:2048 lds
v_sub_u32 v15, v13, v15
v_mfma_f32_16x16x32_bf16 v[76:79], v[136:139], a[108:111], v[76:79]
v_cmp_gt_u32 s[40:41], 64, v15
s_waitcnt lgkmcnt(0)
v_mfma_f32_16x16x32_bf16 v[32:35], v[140:143], a[112:115], v[32:35]
s_waitcnt vmcnt(16)
v_lshrrev_b32 v28, 5, v15
v_mfma_f32_16x16x32_bf16 v[44:47], v[140:143], a[116:119], v[44:47]
ds_read_b64_tr_b16 v[128:129], v20 offset:6144
v_lshl_add_u32 v28, v14, 1, v28
v_mfma_f32_16x16x32_bf16 v[56:59], v[140:143], a[120:123], v[56:59]
ds_read_b64_tr_b16 v[130:131], v20 offset:7680
s_add_u32 m0, s62, 3072
v_mfma_f32_16x16x32_bf16 v[68:71], v[140:143], a[124:127], v[68:71]
ds_read_b64_tr_b16 v[132:133], v20 offset:6176
s_add_u32 s76, s61, 498048
v_mfma_f32_16x16x32_bf16 v[36:39], v[144:147], a[112:115], v[36:39]
ds_read_b64_tr_b16 v[134:135], v20 offset:7712
buffer_load_dwordx4 v17, s[24:27], s76 offen offset:0 lds
v_mfma_f32_16x16x32_bf16 v[48:51], v[144:147], a[116:119], v[48:51]
ds_read_b64_tr_b16 v[136:137], v20 offset:6208
v_lshlrev_b32 v28, 10, v28
v_mfma_f32_16x16x32_bf16 v[60:63], v[144:147], a[120:123], v[60:63]
ds_read_b64_tr_b16 v[138:139], v20 offset:7744
buffer_load_dwordx4 v18, s[24:27], s76 offen offset:1024 lds
v_mfma_f32_16x16x32_bf16 v[72:75], v[144:147], a[124:127], v[72:75]
v_bfe_u32 v29, v15, 2, 2
v_lshl_add_u32 v28, v29, 8, v28
v_mfma_f32_16x16x32_bf16 v[40:43], v[148:151], a[112:115], v[40:43]
v_bfe_u32 v29, v15, 4, 1
v_lshl_add_u32 v28, v29, 3, v28
v_mfma_f32_16x16x32_bf16 v[52:55], v[148:151], a[116:119], v[52:55]
buffer_load_dwordx4 v19, s[24:27], s76 offen offset:2048 lds
v_lshlrev_b32 v14, 8, v14
v_mfma_f32_16x16x32_bf16 v[64:67], v[148:151], a[120:123], v[64:67]
v_bfe_u32 v29, v15, 2, 1
v_lshl_add_u32 v14, v29, 3, v14
v_mfma_f32_16x16x32_bf16 v[76:79], v[148:151], a[124:127], v[76:79]
s_waitcnt lgkmcnt(0)
v_mfma_f32_16x16x32_bf16 v[32:35], v[128:131], a[128:131], v[32:35]
s_waitcnt vmcnt(15)
v_add_u32 v14, 16384, v14
v_cndmask_b32 v14, v14, v28, s[40:41]
v_mfma_f32_16x16x32_bf16 v[44:47], v[128:131], a[132:135], v[44:47]
ds_read_b64_tr_b16 v[140:141], v20 offset:9216
v_add_u32 v14, v14, v11
v_mfma_f32_16x16x32_bf16 v[56:59], v[128:131], a[136:139], v[56:59]
ds_read_b64_tr_b16 v[142:143], v20 offset:10752
s_add_u32 m0, s62, 6144
v_mfma_f32_16x16x32_bf16 v[68:71], v[128:131], a[140:143], v[68:71]
ds_read_b64_tr_b16 v[144:145], v20 offset:9248
s_add_u32 s76, s61, 553344
v_mfma_f32_16x16x32_bf16 v[36:39], v[132:135], a[128:131], v[36:39]
ds_read_b64_tr_b16 v[146:147], v20 offset:10784
buffer_load_dwordx4 v17, s[24:27], s76 offen offset:0 lds
v_mfma_f32_16x16x32_bf16 v[48:51], v[132:135], a[132:135], v[48:51]
ds_read_b64_tr_b16 v[148:149], v20 offset:9280
s_mov_b32 exec_hi, 0xffff
v_mfma_f32_16x16x32_bf16 v[60:63], v[132:135], a[136:139], v[60:63]
buffer_load_dwordx2 v[156:157], v14, s[44:47], s66 offen sc1
s_mov_b32 exec_hi, -1
v_mfma_f32_16x16x32_bf16 v[72:75], v[132:135], a[140:143], v[72:75]
ds_read_b64_tr_b16 v[150:151], v20 offset:10816
buffer_load_dwordx4 v18, s[24:27], s76 offen offset:1024 lds
v_mfma_f32_16x16x32_bf16 v[40:43], v[136:139], a[128:131], v[40:43]
v_add_u32 v13, 384, v12
v_mul_u32_u24 v14, 911, v13
v_mfma_f32_16x16x32_bf16 v[52:55], v[136:139], a[132:135], v[52:55]
v_lshrrev_b32 v14, 16, v14
v_mul_u32_u24 v15, 72, v14
v_mfma_f32_16x16x32_bf16 v[64:67], v[136:139], a[136:139], v[64:67]
buffer_load_dwordx4 v19, s[24:27], s76 offen offset:2048 lds
v_sub_u32 v15, v13, v15
v_mfma_f32_16x16x32_bf16 v[76:79], v[136:139], a[140:143], v[76:79]
v_cmp_gt_u32 s[40:41], 64, v15
s_waitcnt lgkmcnt(0)
s_barrier
v_mfma_f32_16x16x32_bf16 v[32:35], v[140:143], a[144:147], v[32:35]
s_waitcnt vmcnt(15)
v_lshrrev_b32 v28, 5, v15
v_mfma_f32_16x16x32_bf16 v[44:47], v[140:143], a[148:151], v[44:47]
ds_read_b64_tr_b16 v[128:129], v20 offset:12288
v_lshl_add_u32 v28, v14, 1, v28
v_mfma_f32_16x16x32_bf16 v[56:59], v[140:143], a[152:155], v[56:59]
ds_read_b64_tr_b16 v[130:131], v20 offset:13824
s_add_u32 m0, s62, 9216
v_mfma_f32_16x16x32_bf16 v[68:71], v[140:143], a[156:159], v[68:71]
ds_read_b64_tr_b16 v[132:133], v20 offset:12320
s_add_u32 s76, s61, 608640
v_mfma_f32_16x16x32_bf16 v[36:39], v[144:147], a[144:147], v[36:39]
ds_read_b64_tr_b16 v[134:135], v20 offset:13856
buffer_load_dwordx4 v17, s[24:27], s76 offen offset:0 lds
v_mfma_f32_16x16x32_bf16 v[48:51], v[144:147], a[148:151], v[48:51]
ds_read_b64_tr_b16 v[136:137], v20 offset:12352
v_lshlrev_b32 v28, 10, v28
v_mfma_f32_16x16x32_bf16 v[60:63], v[144:147], a[152:155], v[60:63]
ds_read_b64_tr_b16 v[138:139], v20 offset:13888
buffer_load_dwordx4 v18, s[24:27], s76 offen offset:1024 lds
v_mfma_f32_16x16x32_bf16 v[72:75], v[144:147], a[156:159], v[72:75]
v_bfe_u32 v29, v15, 2, 2
v_lshl_add_u32 v28, v29, 8, v28
v_mfma_f32_16x16x32_bf16 v[40:43], v[148:151], a[144:147], v[40:43]
v_bfe_u32 v29, v15, 4, 1
v_lshl_add_u32 v28, v29, 3, v28
v_mfma_f32_16x16x32_bf16 v[52:55], v[148:151], a[148:151], v[52:55]
buffer_load_dwordx4 v19, s[24:27], s76 offen offset:2048 lds
v_lshlrev_b32 v14, 8, v14
v_mfma_f32_16x16x32_bf16 v[64:67], v[148:151], a[152:155], v[64:67]
v_bfe_u32 v29, v15, 2, 1
v_lshl_add_u32 v14, v29, 3, v14
v_mfma_f32_16x16x32_bf16 v[76:79], v[148:151], a[156:159], v[76:79]
s_waitcnt lgkmcnt(0)
v_mfma_f32_16x16x32_bf16 v[32:35], v[128:131], a[160:163], v[32:35]
s_waitcnt vmcnt(14)
v_add_u32 v14, 16384, v14
v_cndmask_b32 v14, v14, v28, s[40:41]
v_mfma_f32_16x16x32_bf16 v[44:47], v[128:131], a[164:167], v[44:47]
ds_read_b64_tr_b16 v[140:141], v20 offset:15360
v_add_u32 v14, v14, v11
v_mfma_f32_16x16x32_bf16 v[56:59], v[128:131], a[168:171], v[56:59]
ds_read_b64_tr_b16 v[142:143], v20 offset:16896
s_add_u32 m0, s62, 12288
v_mfma_f32_16x16x32_bf16 v[68:71], v[128:131], a[172:175], v[68:71]
ds_read_b64_tr_b16 v[144:145], v20 offset:15392
s_add_u32 s76, s61, 479616
v_mfma_f32_16x16x32_bf16 v[36:39], v[132:135], a[160:163], v[36:39]
ds_read_b64_tr_b16 v[146:147], v20 offset:16928
buffer_load_dwordx4 v17, s[24:27], s76 offen offset:0 lds
v_mfma_f32_16x16x32_bf16 v[48:51], v[132:135], a[164:167], v[48:51]
ds_read_b64_tr_b16 v[148:149], v20 offset:15424
s_mov_b32 exec_hi, 0xffff
v_mfma_f32_16x16x32_bf16 v[60:63], v[132:135], a[168:171], v[60:63]
buffer_load_dwordx2 v[160:161], v14, s[44:47], s66 offen sc1
s_mov_b32 exec_hi, -1
v_mfma_f32_16x16x32_bf16 v[72:75], v[132:135], a[172:175], v[72:75]
ds_read_b64_tr_b16 v[150:151], v20 offset:16960
buffer_load_dwordx4 v8, s[24:27], s76 offen offset:1024 lds
v_mfma_f32_16x16x32_bf16 v[40:43], v[136:139], a[160:163], v[40:43]
v_lshl_add_u32 v10, v7, 1, 1
v_mul_u32_u24 v11, 11, v10
v_mfma_f32_16x16x32_bf16 v[52:55], v[136:139], a[164:167], v[52:55]
v_lshrrev_b32 v11, 5, v11
v_mul_u32_u24 v12, 3, v11
v_mfma_f32_16x16x32_bf16 v[64:67], v[136:139], a[168:171], v[64:67]
buffer_load_dwordx4 v0, s[24:27], s76 offen offset:2048 lds
v_sub_u32 v12, v10, v12
v_mfma_f32_16x16x32_bf16 v[76:79], v[136:139], a[172:175], v[76:79]
v_lshl_add_u32 v12, v12, 4, s70
s_waitcnt lgkmcnt(0)
v_mfma_f32_16x16x32_bf16 v[32:35], v[140:143], a[176:179], v[32:35]
s_waitcnt vmcnt(14)
s_add_u32 m0, s62, 15360
s_add_u32 s76, s61, 590208
v_mfma_f32_16x16x32_bf16 v[44:47], v[140:143], a[180:183], v[44:47]
ds_read_b64_tr_b16 v[128:129], v20 offset:0
v_mfma_f32_16x16x32_bf16 v[56:59], v[140:143], a[184:187], v[56:59]
ds_read_b64_tr_b16 v[130:131], v20 offset:1536
buffer_load_dwordx4 v17, s[24:27], s76 offen offset:0 lds
v_mfma_f32_16x16x32_bf16 v[68:71], v[140:143], a[188:191], v[68:71]
ds_read_b64_tr_b16 v[132:133], v20 offset:32
s_mul_i32 s53, s51, 24
v_mfma_f32_16x16x32_bf16 v[36:39], v[144:147], a[176:179], v[36:39]
ds_read_b64_tr_b16 v[134:135], v20 offset:1568
s_add_u32 s53, s53, s48
v_mfma_f32_16x16x32_bf16 v[48:51], v[144:147], a[180:183], v[48:51]
ds_read_b64_tr_b16 v[136:137], v20 offset:64
s_lshl_b32 s53, s53, 3
v_mfma_f32_16x16x32_bf16 v[60:63], v[144:147], a[184:187], v[60:63]
ds_read_b64_tr_b16 v[138:139], v20 offset:1600
s_add_u32 s53, s53, s52
v_mfma_f32_16x16x32_bf16 v[72:75], v[144:147], a[188:191], v[72:75]
s_lshl_b32 s53, s53, 7
s_add_u32 s53, s53, 204800
v_mfma_f32_16x16x32_bf16 v[40:43], v[148:151], a[176:179], v[40:43]
s_mov_b64 exec, 1
buffer_store_dword v21, v9, s[44:47], s53 offen sc1
v_mfma_f32_16x16x32_bf16 v[52:55], v[148:151], a[180:183], v[52:55]
s_mov_b64 exec, -1
buffer_load_dwordx4 v8, s[24:27], s76 offen offset:1024 lds
v_mfma_f32_16x16x32_bf16 v[64:67], v[148:151], a[184:187], v[64:67]
v_add_u32 v11, s71, v11
v_lshl_add_u32 v13, v11, 4, v4
v_mfma_f32_16x16x32_bf16 v[76:79], v[148:151], a[188:191], v[76:79]
buffer_load_dwordx4 v0, s[24:27], s76 offen offset:2048 lds
s_waitcnt lgkmcnt(0)
s_barrier
v_mfma_f32_16x16x32_bf16 v[32:35], v[128:131], a[192:195], v[32:35]
s_waitcnt vmcnt(15)
v_mul_u32_u24 v13, 1152, v13
v_mfma_f32_16x16x32_bf16 v[44:47], v[128:131], a[196:199], v[44:47]
ds_read_b64_tr_b16 v[140:141], v20 offset:3072
v_lshl_add_u32 v14, v16, 2, v12
v_mfma_f32_16x16x32_bf16 v[56:59], v[128:131], a[200:203], v[56:59]
ds_read_b64_tr_b16 v[142:143], v20 offset:4608
s_add_u32 m0, s62, 0
v_mfma_f32_16x16x32_bf16 v[68:71], v[128:131], a[204:207], v[68:71]
ds_read_b64_tr_b16 v[144:145], v20 offset:3104
s_add_u32 s76, s61, 768
v_mfma_f32_16x16x32_bf16 v[36:39], v[132:135], a[192:195], v[36:39]
ds_read_b64_tr_b16 v[146:147], v20 offset:4640
buffer_load_dwordx4 v17, s[24:27], s76 offen offset:0 lds
v_mfma_f32_16x16x32_bf16 v[48:51], v[132:135], a[196:199], v[48:51]
ds_read_b64_tr_b16 v[148:149], v20 offset:3136
v_lshl_add_u32 v23, v14, 1, v13
v_mfma_f32_16x16x32_bf16 v[60:63], v[132:135], a[200:203], v[60:63]
ds_read_b64_tr_b16 v[150:151], v20 offset:4672
buffer_load_dwordx4 v18, s[24:27], s76 offen offset:1024 lds
v_mfma_f32_16x16x32_bf16 v[72:75], v[132:135], a[204:207], v[72:75]
v_lshl_add_u32 v12, v2, 2, v12
v_lshl_add_u32 v25, v12, 2, s67
v_mfma_f32_16x16x32_bf16 v[40:43], v[136:139], a[192:195], v[40:43]
v_mul_u32_u24 v11, 18432, v11
v_lshl_add_u32 v11, v3, 4, v11
v_mfma_f32_16x16x32_bf16 v[52:55], v[136:139], a[196:199], v[52:55]
buffer_load_dwordx4 v19, s[24:27], s76 offen offset:2048 lds
v_add_u32 v13, 0, v12
v_mfma_f32_16x16x32_bf16 v[64:67], v[136:139], a[200:203], v[64:67]
v_mul_u32_u24 v14, 911, v13
v_lshrrev_b32 v14, 16, v14
v_mfma_f32_16x16x32_bf16 v[76:79], v[136:139], a[204:207], v[76:79]
s_waitcnt lgkmcnt(0)
v_mfma_f32_16x16x32_bf16 v[32:35], v[140:143], a[208:211], v[32:35]
s_waitcnt vmcnt(14)
v_mul_u32_u24 v15, 72, v14
v_mfma_f32_16x16x32_bf16 v[44:47], v[140:143], a[212:215], v[44:47]
ds_read_b64_tr_b16 v[128:129], v20 offset:6144
v_sub_u32 v15, v13, v15
v_mfma_f32_16x16x32_bf16 v[56:59], v[140:143], a[216:219], v[56:59]
ds_read_b64_tr_b16 v[130:131], v20 offset:7680
s_add_u32 m0, s62, 3072
v_mfma_f32_16x16x32_bf16 v[68:71], v[140:143], a[220:223], v[68:71]
ds_read_b64_tr_b16 v[132:133], v20 offset:6176
s_add_u32 s76, s61, 56064
v_mfma_f32_16x16x32_bf16 v[36:39], v[144:147], a[208:211], v[36:39]
ds_read_b64_tr_b16 v[134:135], v20 offset:7712
buffer_load_dwordx4 v17, s[24:27], s76 offen offset:0 lds
v_mfma_f32_16x16x32_bf16 v[48:51], v[144:147], a[212:215], v[48:51]
ds_read_b64_tr_b16 v[136:137], v20 offset:6208
v_cmp_gt_u32 s[40:41], 64, v15
v_mfma_f32_16x16x32_bf16 v[60:63], v[144:147], a[216:219], v[60:63]
ds_read_b64_tr_b16 v[138:139], v20 offset:7744
buffer_load_dwordx4 v18, s[24:27], s76 offen offset:1024 lds
v_mfma_f32_16x16x32_bf16 v[72:75], v[144:147], a[220:223], v[72:75]
v_lshrrev_b32 v28, 5, v15
v_lshl_add_u32 v28, v14, 1, v28
v_mfma_f32_16x16x32_bf16 v[40:43], v[148:151], a[208:211], v[40:43]
v_lshlrev_b32 v28, 10, v28
v_bfe_u32 v29, v15, 2, 2
v_mfma_f32_16x16x32_bf16 v[52:55], v[148:151], a[212:215], v[52:55]
buffer_load_dwordx4 v19, s[24:27], s76 offen offset:2048 lds
v_lshl_add_u32 v28, v29, 8, v28
v_mfma_f32_16x16x32_bf16 v[64:67], v[148:151], a[216:219], v[64:67]
v_bfe_u32 v29, v15, 4, 1
v_lshl_add_u32 v28, v29, 3, v28
v_mfma_f32_16x16x32_bf16 v[76:79], v[148:151], a[220:223], v[76:79]
s_waitcnt lgkmcnt(0)
v_mfma_f32_16x16x32_bf16 v[32:35], v[128:131], a[224:227], v[32:35]
s_waitcnt vmcnt(14)
v_lshlrev_b32 v14, 8, v14
v_bfe_u32 v29, v15, 2, 1
v_mfma_f32_16x16x32_bf16 v[44:47], v[128:131], a[228:231], v[44:47]
ds_read_b64_tr_b16 v[140:141], v20 offset:9216
v_lshl_add_u32 v14, v29, 3, v14
v_mfma_f32_16x16x32_bf16 v[56:59], v[128:131], a[232:235], v[56:59]
ds_read_b64_tr_b16 v[142:143], v20 offset:10752
s_add_u32 m0, s62, 6144
v_mfma_f32_16x16x32_bf16 v[68:71], v[128:131], a[236:239], v[68:71]
ds_read_b64_tr_b16 v[144:145], v20 offset:9248
s_add_u32 s76, s61, 111360
v_mfma_f32_16x16x32_bf16 v[36:39], v[132:135], a[224:227], v[36:39]
ds_read_b64_tr_b16 v[146:147], v20 offset:10784
buffer_load_dwordx4 v17, s[24:27], s76 offen offset:0 lds
v_mfma_f32_16x16x32_bf16 v[48:51], v[132:135], a[228:231], v[48:51]
ds_read_b64_tr_b16 v[148:149], v20 offset:9280
v_add_u32 v14, 16384, v14
v_mfma_f32_16x16x32_bf16 v[60:63], v[132:135], a[232:235], v[60:63]
ds_read_b64_tr_b16 v[150:151], v20 offset:10816
buffer_load_dwordx4 v18, s[24:27], s76 offen offset:1024 lds
v_mfma_f32_16x16x32_bf16 v[72:75], v[132:135], a[236:239], v[72:75]
v_cndmask_b32 v14, v14, v28, s[40:41]
v_add_u32 v14, v14, v11
v_mfma_f32_16x16x32_bf16 v[40:43], v[136:139], a[224:227], v[40:43]
buffer_load_dwordx4 v19, s[24:27], s76 offen offset:2048 lds
s_mov_b32 exec_hi, 0xffff
v_mfma_f32_16x16x32_bf16 v[52:55], v[136:139], a[228:231], v[52:55]
buffer_load_dwordx2 v[154:155], v14, s[44:47], s66 offen sc1
s_mov_b32 exec_hi, -1
v_mfma_f32_16x16x32_bf16 v[64:67], v[136:139], a[232:235], v[64:67]
v_add_u32 v13, 192, v12
v_mul_u32_u24 v14, 911, v13
v_mfma_f32_16x16x32_bf16 v[76:79], v[136:139], a[236:239], v[76:79]
v_lshrrev_b32 v14, 16, v14
s_waitcnt lgkmcnt(0)
s_barrier
v_mfma_f32_16x16x32_bf16 v[32:35], v[140:143], a[240:243], v[32:35]
s_waitcnt vmcnt(14)
v_mul_u32_u24 v15, 72, v14
v_mfma_f32_16x16x32_bf16 v[44:47], v[140:143], a[244:247], v[44:47]
ds_read_b64_tr_b16 v[128:129], v20 offset:12288
v_sub_u32 v15, v13, v15
v_mfma_f32_16x16x32_bf16 v[56:59], v[140:143], a[248:251], v[56:59]
ds_read_b64_tr_b16 v[130:131], v20 offset:13824
s_add_u32 m0, s62, 9216
v_mfma_f32_16x16x32_bf16 v[68:71], v[140:143], a[252:255], v[68:71]
ds_read_b64_tr_b16 v[132:133], v20 offset:12320
s_add_u32 s76, s61, 166656
v_mfma_f32_16x16x32_bf16 v[36:39], v[144:147], a[240:243], v[36:39]
ds_read_b64_tr_b16 v[134:135], v20 offset:13856
buffer_load_dwordx4 v17, s[24:27], s76 offen offset:0 lds
v_mfma_f32_16x16x32_bf16 v[48:51], v[144:147], a[244:247], v[48:51]
ds_read_b64_tr_b16 v[136:137], v20 offset:12352
v_cmp_gt_u32 s[40:41], 64, v15
v_mfma_f32_16x16x32_bf16 v[60:63], v[144:147], a[248:251], v[60:63]
ds_read_b64_tr_b16 v[138:139], v20 offset:13888
buffer_load_dwordx4 v18, s[24:27], s76 offen offset:1024 lds
v_mfma_f32_16x16x32_bf16 v[72:75], v[144:147], a[252:255], v[72:75]
v_lshrrev_b32 v28, 5, v15
v_lshl_add_u32 v28, v14, 1, v28
v_mfma_f32_16x16x32_bf16 v[40:43], v[148:151], a[240:243], v[40:43]
v_lshlrev_b32 v28, 10, v28
v_bfe_u32 v29, v15, 2, 2
v_mfma_f32_16x16x32_bf16 v[52:55], v[148:151], a[244:247], v[52:55]
buffer_load_dwordx4 v19, s[24:27], s76 offen offset:2048 lds
v_lshl_add_u32 v28, v29, 8, v28
v_mfma_f32_16x16x32_bf16 v[64:67], v[148:151], a[248:251], v[64:67]
v_bfe_u32 v29, v15, 4, 1
v_lshl_add_u32 v28, v29, 3, v28
v_mfma_f32_16x16x32_bf16 v[76:79], v[148:151], a[252:255], v[76:79]
s_waitcnt lgkmcnt(0)
v_mfma_f32_16x16x32_bf16 v[32:35], v[128:131], v[224:227], v[32:35]
s_waitcnt vmcnt(13)
v_lshlrev_b32 v14, 8, v14
v_bfe_u32 v29, v15, 2, 1
v_mfma_f32_16x16x32_bf16 v[44:47], v[128:131], v[228:231], v[44:47]
ds_read_b64_tr_b16 v[140:141], v20 offset:15360
v_lshl_add_u32 v14, v29, 3, v14
v_mfma_f32_16x16x32_bf16 v[56:59], v[128:131], v[232:235], v[56:59]
ds_read_b64_tr_b16 v[142:143], v20 offset:16896
s_add_u32 m0, s62, 12288
v_mfma_f32_16x16x32_bf16 v[68:71], v[128:131], v[236:239], v[68:71]
ds_read_b64_tr_b16 v[144:145], v20 offset:15392
s_add_u32 s76, s61, 37632
v_mfma_f32_16x16x32_bf16 v[36:39], v[132:135], v[224:227], v[36:39]
ds_read_b64_tr_b16 v[146:147], v20 offset:16928
buffer_load_dwordx4 v17, s[24:27], s76 offen offset:0 lds
v_mfma_f32_16x16x32_bf16 v[48:51], v[132:135], v[228:231], v[48:51]
ds_read_b64_tr_b16 v[148:149], v20 offset:15424
v_add_u32 v14, 16384, v14
v_mfma_f32_16x16x32_bf16 v[60:63], v[132:135], v[232:235], v[60:63]
ds_read_b64_tr_b16 v[150:151], v20 offset:16960
buffer_load_dwordx4 v8, s[24:27], s76 offen offset:1024 lds
v_mfma_f32_16x16x32_bf16 v[72:75], v[132:135], v[236:239], v[72:75]
v_cndmask_b32 v14, v14, v28, s[40:41]
v_add_u32 v14, v14, v11
v_mfma_f32_16x16x32_bf16 v[40:43], v[136:139], v[224:227], v[40:43]
buffer_load_dwordx4 v0, s[24:27], s76 offen offset:2048 lds
s_mov_b32 exec_hi, 0xffff
v_mfma_f32_16x16x32_bf16 v[52:55], v[136:139], v[228:231], v[52:55]
buffer_load_dwordx2 v[158:159], v14, s[44:47], s66 offen sc1
s_mov_b32 exec_hi, -1
v_mfma_f32_16x16x32_bf16 v[64:67], v[136:139], v[232:235], v[64:67]
v_add_u32 v13, 384, v12
v_mul_u32_u24 v14, 911, v13
v_mfma_f32_16x16x32_bf16 v[76:79], v[136:139], v[236:239], v[76:79]
v_lshrrev_b32 v14, 16, v14
s_waitcnt lgkmcnt(0)
v_mfma_f32_16x16x32_bf16 v[32:35], v[140:143], v[240:243], v[32:35]
s_waitcnt vmcnt(14)
v_mul_u32_u24 v15, 72, v14
v_mfma_f32_16x16x32_bf16 v[44:47], v[140:143], v[244:247], v[44:47]
ds_read_b64_tr_b16 v[128:129], v20 offset:0
v_sub_u32 v15, v13, v15
v_mfma_f32_16x16x32_bf16 v[56:59], v[140:143], v[248:251], v[56:59]
ds_read_b64_tr_b16 v[130:131], v20 offset:1536
s_add_u32 m0, s62, 15360
v_mfma_f32_16x16x32_bf16 v[68:71], v[140:143], v[252:255], v[68:71]
ds_read_b64_tr_b16 v[132:133], v20 offset:32
s_add_u32 s76, s61, 148224
v_mfma_f32_16x16x32_bf16 v[36:39], v[144:147], v[240:243], v[36:39]
ds_read_b64_tr_b16 v[134:135], v20 offset:1568
buffer_load_dwordx4 v17, s[24:27], s76 offen offset:0 lds
v_mfma_f32_16x16x32_bf16 v[48:51], v[144:147], v[244:247], v[48:51]
ds_read_b64_tr_b16 v[136:137], v20 offset:64
v_cmp_gt_u32 s[40:41], 64, v15
v_mfma_f32_16x16x32_bf16 v[60:63], v[144:147], v[248:251], v[60:63]
ds_read_b64_tr_b16 v[138:139], v20 offset:1600
buffer_load_dwordx4 v8, s[24:27], s76 offen offset:1024 lds
v_mfma_f32_16x16x32_bf16 v[72:75], v[144:147], v[252:255], v[72:75]
v_lshrrev_b32 v28, 5, v15
v_lshl_add_u32 v28, v14, 1, v28
v_mfma_f32_16x16x32_bf16 v[40:43], v[148:151], v[240:243], v[40:43]
v_lshlrev_b32 v28, 10, v28
v_bfe_u32 v29, v15, 2, 2
v_mfma_f32_16x16x32_bf16 v[52:55], v[148:151], v[244:247], v[52:55]
buffer_load_dwordx4 v0, s[24:27], s76 offen offset:2048 lds
v_lshl_add_u32 v28, v29, 8, v28
v_mfma_f32_16x16x32_bf16 v[64:67], v[148:151], v[248:251], v[64:67]
v_bfe_u32 v29, v15, 4, 1
v_lshl_add_u32 v28, v29, 3, v28
v_mfma_f32_16x16x32_bf16 v[76:79], v[148:151], v[252:255], v[76:79]
s_waitcnt lgkmcnt(0)
s_barrier
v_mfma_f32_16x16x32_bf16 v[80:83], v[128:131], a[0:3], 0
s_waitcnt vmcnt(14)
v_cvt_pk_bf16_f32 v32, v32, v33
v_mfma_f32_16x16x32_bf16 v[92:95], v[128:131], a[4:7], 0
ds_read_b64_tr_b16 v[140:141], v20 offset:3072
v_cvt_pk_bf16_f32 v33, v34, v35
v_mfma_f32_16x16x32_bf16 v[104:107], v[128:131], a[8:11], 0
ds_read_b64_tr_b16 v[142:143], v20 offset:4608
s_add_u32 m0, s62, 0
v_mfma_f32_16x16x32_bf16 v[116:119], v[128:131], a[12:15], 0
ds_read_b64_tr_b16 v[144:145], v20 offset:3104
s_add_u32 s76, s61, 221952
v_mfma_f32_16x16x32_bf16 v[84:87], v[132:135], a[0:3], 0
ds_read_b64_tr_b16 v[146:147], v20 offset:4640
buffer_load_dwordx4 v17, s[24:27], s76 offen offset:0 lds
v_mfma_f32_16x16x32_bf16 v[96:99], v[132:135], a[4:7], 0
ds_read_b64_tr_b16 v[148:149], v20 offset:3136
v_cvt_pk_bf16_f32 v34, v36, v37
v_mfma_f32_16x16x32_bf16 v[108:111], v[132:135], a[8:11], 0
ds_read_b64_tr_b16 v[150:151], v20 offset:4672
buffer_load_dwordx4 v18, s[24:27], s76 offen offset:1024 lds
v_mfma_f32_16x16x32_bf16 v[120:123], v[132:135], a[12:15], 0
buffer_load_dwordx4 v19, s[24:27], s76 offen offset:2048 lds
v_cvt_pk_bf16_f32 v35, v38, v39
v_mfma_f32_16x16x32_bf16 v[88:91], v[136:139], a[0:3], 0
s_add_u32 s53, s64, 411648
buffer_store_dwordx4 v[32:35], v26, s[44:47], s53 offen offset:0 sc1
v_mfma_f32_16x16x32_bf16 v[100:103], v[136:139], a[4:7], 0
v_cvt_pk_bf16_f32 v36, v40, v41
v_cvt_pk_bf16_f32 v37, v42, v43
v_mfma_f32_16x16x32_bf16 v[112:115], v[136:139], a[8:11], 0
v_cvt_pk_bf16_f32 v38, v44, v45
v_lshlrev_b32 v14, 8, v14
v_mfma_f32_16x16x32_bf16 v[124:127], v[136:139], a[12:15], 0
v_bfe_u32 v29, v15, 2, 1
s_waitcnt lgkmcnt(0)
v_mfma_f32_16x16x32_bf16 v[80:83], v[140:143], a[16:19], v[80:83]
s_waitcnt vmcnt(15)
v_cvt_pk_bf16_f32 v39, v46, v47
s_add_u32 m0, s62, 3072
v_mfma_f32_16x16x32_bf16 v[92:95], v[140:143], a[20:23], v[92:95]
ds_read_b64_tr_b16 v[128:129], v20 offset:6144
s_add_u32 s76, s61, 277248
v_mfma_f32_16x16x32_bf16 v[104:107], v[140:143], a[24:27], v[104:107]
ds_read_b64_tr_b16 v[130:131], v20 offset:7680
buffer_load_dwordx4 v17, s[24:27], s76 offen offset:0 lds
v_mfma_f32_16x16x32_bf16 v[116:119], v[140:143], a[28:31], v[116:119]
ds_read_b64_tr_b16 v[132:133], v20 offset:6176
s_add_u32 s53, s64, 411648
v_mfma_f32_16x16x32_bf16 v[84:87], v[144:147], a[16:19], v[84:87]
ds_read_b64_tr_b16 v[134:135], v20 offset:7712
buffer_store_dwordx4 v[36:39], v26, s[44:47], s53 offen offset:256 sc1
v_mfma_f32_16x16x32_bf16 v[96:99], v[144:147], a[20:23], v[96:99]
ds_read_b64_tr_b16 v[136:137], v20 offset:6208
v_cvt_pk_bf16_f32 v40, v48, v49
v_mfma_f32_16x16x32_bf16 v[108:111], v[144:147], a[24:27], v[108:111]
ds_read_b64_tr_b16 v[138:139], v20 offset:7744
buffer_load_dwordx4 v18, s[24:27], s76 offen offset:1024 lds
v_mfma_f32_16x16x32_bf16 v[120:123], v[144:147], a[28:31], v[120:123]
v_cvt_pk_bf16_f32 v41, v50, v51
v_cvt_pk_bf16_f32 v42, v52, v53
v_mfma_f32_16x16x32_bf16 v[88:91], v[148:151], a[16:19], v[88:91]
v_cvt_pk_bf16_f32 v43, v54, v55
s_add_u32 s53, s64, 411648
v_mfma_f32_16x16x32_bf16 v[100:103], v[148:151], a[20:23], v[100:103]
buffer_store_dwordx4 v[40:43], v26, s[44:47], s53 offen offset:512 sc1
v_cvt_pk_bf16_f32 v44, v56, v57
v_mfma_f32_16x16x32_bf16 v[112:115], v[148:151], a[24:27], v[112:115]
buffer_load_dwordx4 v19, s[24:27], s76 offen offset:2048 lds
v_lshl_add_u32 v14, v29, 3, v14
v_mfma_f32_16x16x32_bf16 v[124:127], v[148:151], a[28:31], v[124:127]
v_add_u32 v14, 16384, v14
s_waitcnt lgkmcnt(0)
v_mfma_f32_16x16x32_bf16 v[80:83], v[128:131], a[32:35], v[80:83]
s_waitcnt vmcnt(16)
v_cvt_pk_bf16_f32 v45, v58, v59
v_cvt_pk_bf16_f32 v46, v60, v61
v_mfma_f32_16x16x32_bf16 v[92:95], v[128:131], a[36:39], v[92:95]
ds_read_b64_tr_b16 v[140:141], v20 offset:9216
v_cvt_pk_bf16_f32 v47, v62, v63
s_add_u32 m0, s62, 6144
v_mfma_f32_16x16x32_bf16 v[104:107], v[128:131], a[40:43], v[104:107]
ds_read_b64_tr_b16 v[142:143], v20 offset:10752
s_add_u32 s76, s61, 332544
buffer_load_dwordx4 v17, s[24:27], s76 offen offset:0 lds
v_mfma_f32_16x16x32_bf16 v[116:119], v[128:131], a[44:47], v[116:119]
ds_read_b64_tr_b16 v[144:145], v20 offset:9248
s_add_u32 s53, s64, 509952
ds_read_b64_tr_b16 v[146:147], v20 offset:10784
v_mfma_f32_16x16x32_bf16 v[84:87], v[132:135], a[32:35], v[84:87]
ds_read_b64_tr_b16 v[148:149], v20 offset:9280
buffer_load_dwordx4 v18, s[24:27], s76 offen offset:1024 lds
v_mfma_f32_16x16x32_bf16 v[96:99], v[132:135], a[36:39], v[96:99]
ds_read_b64_tr_b16 v[150:151], v20 offset:10816
buffer_store_dwordx4 v[44:47], v26, s[44:47], s53 offen offset:0 sc1
v_mfma_f32_16x16x32_bf16 v[108:111], v[132:135], a[40:43], v[108:111]
buffer_load_dwordx4 v19, s[24:27], s76 offen offset:2048 lds
v_cvt_pk_bf16_f32 v48, v64, v65
v_mfma_f32_16x16x32_bf16 v[120:123], v[132:135], a[44:47], v[120:123]
v_cvt_pk_bf16_f32 v49, v66, v67
v_cvt_pk_bf16_f32 v50, v68, v69
v_mfma_f32_16x16x32_bf16 v[88:91], v[136:139], a[32:35], v[88:91]
v_cvt_pk_bf16_f32 v51, v70, v71
v_cndmask_b32 v14, v14, v28, s[40:41]
v_mfma_f32_16x16x32_bf16 v[100:103], v[136:139], a[36:39], v[100:103]
v_add_u32 v14, v14, v11
s_add_u32 s6, s68, 8192
v_mfma_f32_16x16x32_bf16 v[112:115], v[136:139], a[40:43], v[112:115]
s_mov_b32 exec_lo, 0xff
s_mov_b32 exec_hi, 0x0
buffer_load_dword v31, v30, s[44:47], s6 offen sc1
v_mfma_f32_16x16x32_bf16 v[124:127], v[136:139], a[44:47], v[124:127]
s_mov_b64 exec, -1
s_waitcnt lgkmcnt(0)
s_barrier
v_mfma_f32_16x16x32_bf16 v[80:83], v[140:143], a[48:51], v[80:83]
s_waitcnt vmcnt(18)
s_add_u32 m0, s62, 9216
v_mfma_f32_16x16x32_bf16 v[92:95], v[140:143], a[52:55], v[92:95]
ds_read_b64_tr_b16 v[128:129], v20 offset:12288
s_add_u32 s76, s61, 387840
v_mfma_f32_16x16x32_bf16 v[104:107], v[140:143], a[56:59], v[104:107]
ds_read_b64_tr_b16 v[130:131], v20 offset:13824
buffer_load_dwordx4 v17, s[24:27], s76 offen offset:0 lds
v_mfma_f32_16x16x32_bf16 v[116:119], v[140:143], a[60:63], v[116:119]
ds_read_b64_tr_b16 v[132:133], v20 offset:12320
s_add_u32 s53, s64, 509952
v_mfma_f32_16x16x32_bf16 v[84:87], v[144:147], a[48:51], v[84:87]
ds_read_b64_tr_b16 v[134:135], v20 offset:13856
buffer_store_dwordx4 v[48:51], v26, s[44:47], s53 offen offset:256 sc1
v_mfma_f32_16x16x32_bf16 v[96:99], v[144:147], a[52:55], v[96:99]
ds_read_b64_tr_b16 v[136:137], v20 offset:12352
v_cvt_pk_bf16_f32 v52, v72, v73
v_mfma_f32_16x16x32_bf16 v[108:111], v[144:147], a[56:59], v[108:111]
ds_read_b64_tr_b16 v[138:139], v20 offset:13888
buffer_load_dwordx4 v18, s[24:27], s76 offen offset:1024 lds
v_mfma_f32_16x16x32_bf16 v[120:123], v[144:147], a[60:63], v[120:123]
v_cvt_pk_bf16_f32 v53, v74, v75
v_cvt_pk_bf16_f32 v54, v76, v77
v_mfma_f32_16x16x32_bf16 v[88:91], v[148:151], a[48:51], v[88:91]
buffer_load_dwordx4 v19, s[24:27], s76 offen offset:2048 lds
v_cvt_pk_bf16_f32 v55, v78, v79
v_mfma_f32_16x16x32_bf16 v[100:103], v[148:151], a[52:55], v[100:103]
s_add_u32 s53, s64, 509952
buffer_store_dwordx4 v[52:55], v26, s[44:47], s53 offen offset:512 sc1
v_mfma_f32_16x16x32_bf16 v[112:115], v[148:151], a[56:59], v[112:115]
s_mov_b32 exec_hi, 0xffff
buffer_load_dwordx2 v[162:163], v14, s[44:47], s66 offen sc1
v_mfma_f32_16x16x32_bf16 v[124:127], v[148:151], a[60:63], v[124:127]
s_mov_b32 exec_hi, -1
s_waitcnt lgkmcnt(0)
v_mfma_f32_16x16x32_bf16 v[80:83], v[128:131], a[64:67], v[80:83]
s_waitcnt vmcnt(20)
s_add_u32 m0, s62, 12288
v_mfma_f32_16x16x32_bf16 v[92:95], v[128:131], a[68:71], v[92:95]
ds_read_b64_tr_b16 v[140:141], v20 offset:15360
s_add_u32 s76, s61, 258816
v_mfma_f32_16x16x32_bf16 v[104:107], v[128:131], a[72:75], v[104:107]
ds_read_b64_tr_b16 v[142:143], v20 offset:16896
buffer_load_dwordx4 v17, s[24:27], s76 offen offset:0 lds
v_mfma_f32_16x16x32_bf16 v[116:119], v[128:131], a[76:79], v[116:119]
ds_read_b64_tr_b16 v[144:145], v20 offset:15392
v_mfma_f32_16x16x32_bf16 v[84:87], v[132:135], a[64:67], v[84:87]
ds_read_b64_tr_b16 v[146:147], v20 offset:16928
buffer_load_dwordx4 v8, s[24:27], s76 offen offset:1024 lds
v_mfma_f32_16x16x32_bf16 v[96:99], v[132:135], a[68:71], v[96:99]
ds_read_b64_tr_b16 v[148:149], v20 offset:15424
v_mfma_f32_16x16x32_bf16 v[108:111], v[132:135], a[72:75], v[108:111]
ds_read_b64_tr_b16 v[150:151], v20 offset:16960
v_mfma_f32_16x16x32_bf16 v[120:123], v[132:135], a[76:79], v[120:123]
v_mfma_f32_16x16x32_bf16 v[88:91], v[136:139], a[64:67], v[88:91]
buffer_load_dwordx4 v0, s[24:27], s76 offen offset:2048 lds
v_mfma_f32_16x16x32_bf16 v[100:103], v[136:139], a[68:71], v[100:103]
v_mfma_f32_16x16x32_bf16 v[112:115], v[136:139], a[72:75], v[112:115]
v_mfma_f32_16x16x32_bf16 v[124:127], v[136:139], a[76:79], v[124:127]
s_waitcnt lgkmcnt(0)
v_mfma_f32_16x16x32_bf16 v[80:83], v[140:143], a[80:83], v[80:83]
s_waitcnt vmcnt(20)
s_add_u32 m0, s62, 15360
v_mfma_f32_16x16x32_bf16 v[92:95], v[140:143], a[84:87], v[92:95]
ds_read_b64_tr_b16 v[128:129], v20 offset:0
s_add_u32 s76, s61, 369408
v_mfma_f32_16x16x32_bf16 v[104:107], v[140:143], a[88:91], v[104:107]
ds_read_b64_tr_b16 v[130:131], v20 offset:1536
buffer_load_dwordx4 v17, s[24:27], s76 offen offset:0 lds
v_mfma_f32_16x16x32_bf16 v[116:119], v[140:143], a[92:95], v[116:119]
ds_read_b64_tr_b16 v[132:133], v20 offset:32
v_mfma_f32_16x16x32_bf16 v[84:87], v[144:147], a[80:83], v[84:87]
ds_read_b64_tr_b16 v[134:135], v20 offset:1568
buffer_load_dwordx4 v8, s[24:27], s76 offen offset:1024 lds
v_mfma_f32_16x16x32_bf16 v[96:99], v[144:147], a[84:87], v[96:99]
ds_read_b64_tr_b16 v[136:137], v20 offset:64
v_mfma_f32_16x16x32_bf16 v[108:111], v[144:147], a[88:91], v[108:111]
ds_read_b64_tr_b16 v[138:139], v20 offset:1600
v_mfma_f32_16x16x32_bf16 v[120:123], v[144:147], a[92:95], v[120:123]
v_mfma_f32_16x16x32_bf16 v[88:91], v[148:151], a[80:83], v[88:91]
buffer_load_dwordx4 v0, s[24:27], s76 offen offset:2048 lds
v_mfma_f32_16x16x32_bf16 v[100:103], v[148:151], a[84:87], v[100:103]
v_mfma_f32_16x16x32_bf16 v[112:115], v[148:151], a[88:91], v[112:115]
v_mfma_f32_16x16x32_bf16 v[124:127], v[148:151], a[92:95], v[124:127]
s_waitcnt lgkmcnt(0)
s_barrier
v_mfma_f32_16x16x32_bf16 v[80:83], v[128:131], a[96:99], v[80:83]
s_waitcnt vmcnt(17)
s_add_u32 m0, s62, 0
v_mfma_f32_16x16x32_bf16 v[92:95], v[128:131], a[100:103], v[92:95]
ds_read_b64_tr_b16 v[140:141], v20 offset:3072
s_add_u32 s76, s61, 443136
v_mfma_f32_16x16x32_bf16 v[104:107], v[128:131], a[104:107], v[104:107]
ds_read_b64_tr_b16 v[142:143], v20 offset:4608
buffer_load_dwordx4 v17, s[24:27], s76 offen offset:0 lds
v_mfma_f32_16x16x32_bf16 v[116:119], v[128:131], a[108:111], v[116:119]
ds_read_b64_tr_b16 v[144:145], v20 offset:3104
v_mfma_f32_16x16x32_bf16 v[84:87], v[132:135], a[96:99], v[84:87]
ds_read_b64_tr_b16 v[146:147], v20 offset:4640
buffer_load_dwordx4 v18, s[24:27], s76 offen offset:1024 lds
v_mfma_f32_16x16x32_bf16 v[96:99], v[132:135], a[100:103], v[96:99]
ds_read_b64_tr_b16 v[148:149], v20 offset:3136
v_mfma_f32_16x16x32_bf16 v[108:111], v[132:135], a[104:107], v[108:111]
ds_read_b64_tr_b16 v[150:151], v20 offset:4672
v_mfma_f32_16x16x32_bf16 v[120:123], v[132:135], a[108:111], v[120:123]
v_mfma_f32_16x16x32_bf16 v[88:91], v[136:139], a[96:99], v[88:91]
buffer_load_dwordx4 v19, s[24:27], s76 offen offset:2048 lds
v_mfma_f32_16x16x32_bf16 v[100:103], v[136:139], a[100:103], v[100:103]
v_mfma_f32_16x16x32_bf16 v[112:115], v[136:139], a[104:107], v[112:115]
v_mfma_f32_16x16x32_bf16 v[124:127], v[136:139], a[108:111], v[124:127]
s_waitcnt lgkmcnt(0)
v_mfma_f32_16x16x32_bf16 v[80:83], v[140:143], a[112:115], v[80:83]
s_waitcnt vmcnt(16)
s_add_u32 m0, s62, 3072
v_mfma_f32_16x16x32_bf16 v[92:95], v[140:143], a[116:119], v[92:95]
ds_read_b64_tr_b16 v[128:129], v20 offset:6144
s_add_u32 s76, s61, 498432
v_mfma_f32_16x16x32_bf16 v[104:107], v[140:143], a[120:123], v[104:107]
ds_read_b64_tr_b16 v[130:131], v20 offset:7680
buffer_load_dwordx4 v17, s[24:27], s76 offen offset:0 lds
v_mfma_f32_16x16x32_bf16 v[116:119], v[140:143], a[124:127], v[116:119]
ds_read_b64_tr_b16 v[132:133], v20 offset:6176
v_mfma_f32_16x16x32_bf16 v[84:87], v[144:147], a[112:115], v[84:87]
ds_read_b64_tr_b16 v[134:135], v20 offset:7712
buffer_load_dwordx4 v18, s[24:27], s76 offen offset:1024 lds
v_mfma_f32_16x16x32_bf16 v[96:99], v[144:147], a[116:119], v[96:99]
ds_read_b64_tr_b16 v[136:137], v20 offset:6208
v_mfma_f32_16x16x32_bf16 v[108:111], v[144:147], a[120:123], v[108:111]
ds_read_b64_tr_b16 v[138:139], v20 offset:7744
v_mfma_f32_16x16x32_bf16 v[120:123], v[144:147], a[124:127], v[120:123]
v_mfma_f32_16x16x32_bf16 v[88:91], v[148:151], a[112:115], v[88:91]
buffer_load_dwordx4 v19, s[24:27], s76 offen offset:2048 lds
v_mfma_f32_16x16x32_bf16 v[100:103], v[148:151], a[116:119], v[100:103]
v_mfma_f32_16x16x32_bf16 v[112:115], v[148:151], a[120:123], v[112:115]
v_mfma_f32_16x16x32_bf16 v[124:127], v[148:151], a[124:127], v[124:127]
s_waitcnt lgkmcnt(0)
s_mov_b32 exec_lo, 0xff
s_mov_b32 exec_hi, 0x0
s_waitcnt vmcnt(18)
v_cmp_ne_u32 vcc, v21, v31
s_nop 4
s_cbranch_vccz L_poll7d
s_mov_b32 s77, 0x20000
L_poll7:
buffer_load_dword v31, v30, s[44:47], s6 offen sc1
s_waitcnt vmcnt(0)
v_cmp_ne_u32 vcc, v21, v31
s_nop 4
s_cbranch_vccz L_poll7d
s_sub_u32 s77, s77, 1
s_cmp_lg_u32 s77, 0
s_cbranch_scc1 L_poll7
L_poll7d:
s_mov_b64 exec, -1
v_mfma_f32_16x16x32_bf16 v[80:83], v[128:131], a[128:131], v[80:83]
s_waitcnt vmcnt(14)
s_add_u32 m0, s62, 6144
v_mfma_f32_16x16x32_bf16 v[92:95], v[128:131], a[132:135], v[92:95]
ds_read_b64_tr_b16 v[140:141], v20 offset:9216
s_add_u32 s76, s61, 553728
v_mfma_f32_16x16x32_bf16 v[104:107], v[128:131], a[136:139], v[104:107]
ds_read_b64_tr_b16 v[142:143], v20 offset:10752
buffer_load_dwordx4 v17, s[24:27], s76 offen offset:0 lds
v_mfma_f32_16x16x32_bf16 v[116:119], v[128:131], a[140:143], v[116:119]
ds_read_b64_tr_b16 v[144:145], v20 offset:9248
v_mfma_f32_16x16x32_bf16 v[84:87], v[132:135], a[128:131], v[84:87]
ds_read_b64_tr_b16 v[146:147], v20 offset:10784
buffer_load_dwordx4 v18, s[24:27], s76 offen offset:1024 lds
v_mfma_f32_16x16x32_bf16 v[96:99], v[132:135], a[132:135], v[96:99]
ds_read_b64_tr_b16 v[148:149], v20 offset:9280
v_mfma_f32_16x16x32_bf16 v[108:111], v[132:135], a[136:139], v[108:111]
ds_read_b64_tr_b16 v[150:151], v20 offset:10816
v_mfma_f32_16x16x32_bf16 v[120:123], v[132:135], a[140:143], v[120:123]
v_mfma_f32_16x16x32_bf16 v[88:91], v[136:139], a[128:131], v[88:91]
buffer_load_dwordx4 v19, s[24:27], s76 offen offset:2048 lds
v_mfma_f32_16x16x32_bf16 v[100:103], v[136:139], a[132:135], v[100:103]
v_mfma_f32_16x16x32_bf16 v[112:115], v[136:139], a[136:139], v[112:115]
v_mfma_f32_16x16x32_bf16 v[124:127], v[136:139], a[140:143], v[124:127]
s_waitcnt lgkmcnt(0)
s_barrier
v_mfma_f32_16x16x32_bf16 v[80:83], v[140:143], a[144:147], v[80:83]
s_waitcnt vmcnt(12)
s_add_u32 m0, s62, 9216
v_mfma_f32_16x16x32_bf16 v[92:95], v[140:143], a[148:151], v[92:95]
ds_read_b64_tr_b16 v[128:129], v20 offset:12288
s_add_u32 s76, s61, 609024
v_mfma_f32_16x16x32_bf16 v[104:107], v[140:143], a[152:155], v[104:107]
ds_read_b64_tr_b16 v[130:131], v20 offset:13824
buffer_load_dwordx4 v17, s[24:27], s76 offen offset:0 lds
v_mfma_f32_16x16x32_bf16 v[116:119], v[140:143], a[156:159], v[116:119]
ds_read_b64_tr_b16 v[132:133], v20 offset:12320
v_mfma_f32_16x16x32_bf16 v[84:87], v[144:147], a[144:147], v[84:87]
ds_read_b64_tr_b16 v[134:135], v20 offset:13856
s_mul_i32 s53, s51, 24
v_mfma_f32_16x16x32_bf16 v[96:99], v[144:147], a[148:151], v[96:99]
ds_read_b64_tr_b16 v[136:137], v20 offset:12352
s_add_u32 s53, s53, s48
v_mfma_f32_16x16x32_bf16 v[108:111], v[144:147], a[152:155], v[108:111]
ds_read_b64_tr_b16 v[138:139], v20 offset:13888
s_lshl_b32 s53, s53, 3
v_mfma_f32_16x16x32_bf16 v[120:123], v[144:147], a[156:159], v[120:123]
s_add_u32 s53, s53, s52
s_lshl_b32 s53, s53, 7
v_mfma_f32_16x16x32_bf16 v[88:91], v[148:151], a[144:147], v[88:91]
s_add_u32 s53, s53, 208896
s_mov_b64 exec, 1
v_mfma_f32_16x16x32_bf16 v[100:103], v[148:151], a[148:151], v[100:103]
buffer_store_dword v21, v9, s[44:47], s53 offen sc1
s_mov_b64 exec, -1
v_mfma_f32_16x16x32_bf16 v[112:115], v[148:151], a[152:155], v[112:115]
buffer_load_dwordx4 v18, s[24:27], s76 offen offset:1024 lds
buffer_load_dwordx4 v19, s[24:27], s76 offen offset:2048 lds
v_mfma_f32_16x16x32_bf16 v[124:127], v[148:151], a[156:159], v[124:127]
s_waitcnt lgkmcnt(0)
v_mfma_f32_16x16x32_bf16 v[80:83], v[128:131], a[160:163], v[80:83]
s_waitcnt vmcnt(13)
s_add_u32 m0, s62, 12288
v_mfma_f32_16x16x32_bf16 v[92:95], v[128:131], a[164:167], v[92:95]
ds_read_b64_tr_b16 v[140:141], v20 offset:15360
s_add_u32 s76, s61, 480000
v_mfma_f32_16x16x32_bf16 v[104:107], v[128:131], a[168:171], v[104:107]
ds_read_b64_tr_b16 v[142:143], v20 offset:16896
buffer_load_dwordx4 v17, s[24:27], s76 offen offset:0 lds
v_mfma_f32_16x16x32_bf16 v[116:119], v[128:131], a[172:175], v[116:119]
ds_read_b64_tr_b16 v[144:145], v20 offset:15392
v_mfma_f32_16x16x32_bf16 v[84:87], v[132:135], a[160:163], v[84:87]
ds_read_b64_tr_b16 v[146:147], v20 offset:16928
buffer_load_dwordx4 v8, s[24:27], s76 offen offset:1024 lds
v_mfma_f32_16x16x32_bf16 v[96:99], v[132:135], a[164:167], v[96:99]
ds_read_b64_tr_b16 v[148:149], v20 offset:15424
v_mfma_f32_16x16x32_bf16 v[108:111], v[132:135], a[168:171], v[108:111]
ds_read_b64_tr_b16 v[150:151], v20 offset:16960
v_mfma_f32_16x16x32_bf16 v[120:123], v[132:135], a[172:175], v[120:123]
v_mfma_f32_16x16x32_bf16 v[88:91], v[136:139], a[160:163], v[88:91]
buffer_load_dwordx4 v0, s[24:27], s76 offen offset:2048 lds
v_mfma_f32_16x16x32_bf16 v[100:103], v[136:139], a[164:167], v[100:103]
v_mfma_f32_16x16x32_bf16 v[112:115], v[136:139], a[168:171], v[112:115]
v_mfma_f32_16x16x32_bf16 v[124:127], v[136:139], a[172:175], v[124:127]
s_waitcnt lgkmcnt(0)
v_mfma_f32_16x16x32_bf16 v[80:83], v[140:143], a[176:179], v[80:83]
s_waitcnt vmcnt(13)
s_add_u32 m0, s62, 15360
v_mfma_f32_16x16x32_bf16 v[92:95], v[140:143], a[180:183], v[92:95]
ds_read_b64_tr_b16 v[128:129], v20 offset:0
s_add_u32 s76, s61, 590592
v_mfma_f32_16x16x32_bf16 v[104:107], v[140:143], a[184:187], v[104:107]
ds_read_b64_tr_b16 v[130:131], v20 offset:1536
buffer_load_dwordx4 v17, s[24:27], s76 offen offset:0 lds
v_mfma_f32_16x16x32_bf16 v[116:119], v[140:143], a[188:191], v[116:119]
ds_read_b64_tr_b16 v[132:133], v20 offset:32
v_mfma_f32_16x16x32_bf16 v[84:87], v[144:147], a[176:179], v[84:87]
ds_read_b64_tr_b16 v[134:135], v20 offset:1568
buffer_load_dwordx4 v8, s[24:27], s76 offen offset:1024 lds
v_mfma_f32_16x16x32_bf16 v[96:99], v[144:147], a[180:183], v[96:99]
ds_read_b64_tr_b16 v[136:137], v20 offset:64
v_mfma_f32_16x16x32_bf16 v[108:111], v[144:147], a[184:187], v[108:111]
ds_read_b64_tr_b16 v[138:139], v20 offset:1600
v_mfma_f32_16x16x32_bf16 v[120:123], v[144:147], a[188:191], v[120:123]
v_mfma_f32_16x16x32_bf16 v[88:91], v[148:151], a[176:179], v[88:91]
buffer_load_dwordx4 v0, s[24:27], s76 offen offset:2048 lds
v_mfma_f32_16x16x32_bf16 v[100:103], v[148:151], a[180:183], v[100:103]
v_mfma_f32_16x16x32_bf16 v[112:115], v[148:151], a[184:187], v[112:115]
v_mfma_f32_16x16x32_bf16 v[124:127], v[148:151], a[188:191], v[124:127]
s_waitcnt lgkmcnt(0)
s_barrier
v_mfma_f32_16x16x32_bf16 v[80:83], v[128:131], a[192:195], v[80:83]
s_waitcnt vmcnt(13)
ds_read_b64_tr_b16 v[140:141], v20 offset:3072
v_mfma_f32_16x16x32_bf16 v[92:95], v[128:131], a[196:199], v[92:95]
ds_read_b64_tr_b16 v[142:143], v20 offset:4608
v_mfma_f32_16x16x32_bf16 v[104:107], v[128:131], a[200:203], v[104:107]
ds_read_b64_tr_b16 v[144:145], v20 offset:3104
v_mfma_f32_16x16x32_bf16 v[116:119], v[128:131], a[204:207], v[116:119]
ds_read_b64_tr_b16 v[146:147], v20 offset:4640
v_mfma_f32_16x16x32_bf16 v[84:87], v[132:135], a[192:195], v[84:87]
ds_read_b64_tr_b16 v[148:149], v20 offset:3136
v_mfma_f32_16x16x32_bf16 v[96:99], v[132:135], a[196:199], v[96:99]
ds_read_b64_tr_b16 v[150:151], v20 offset:4672
v_mfma_f32_16x16x32_bf16 v[108:111], v[132:135], a[200:203], v[108:111]
v_mfma_f32_16x16x32_bf16 v[120:123], v[132:135], a[204:207], v[120:123]
v_mfma_f32_16x16x32_bf16 v[88:91], v[136:139], a[192:195], v[88:91]
v_mfma_f32_16x16x32_bf16 v[100:103], v[136:139], a[196:199], v[100:103]
v_mfma_f32_16x16x32_bf16 v[112:115], v[136:139], a[200:203], v[112:115]
v_mfma_f32_16x16x32_bf16 v[124:127], v[136:139], a[204:207], v[124:127]
s_waitcnt lgkmcnt(0)
v_mfma_f32_16x16x32_bf16 v[80:83], v[140:143], a[208:211], v[80:83]
s_waitcnt vmcnt(10)
ds_read_b64_tr_b16 v[128:129], v20 offset:6144
v_mfma_f32_16x16x32_bf16 v[92:95], v[140:143], a[212:215], v[92:95]
ds_read_b64_tr_b16 v[130:131], v20 offset:7680
s_add_u32 s7, s63, 0
v_mfma_f32_16x16x32_bf16 v[104:107], v[140:143], a[216:219], v[104:107]
ds_read_b64_tr_b16 v[132:133], v20 offset:6176
s_mov_b32 exec_hi, 0xffff
v_mfma_f32_16x16x32_bf16 v[116:119], v[140:143], a[220:223], v[116:119]
buffer_load_dwordx4 v[164:167], v9, s[44:47], s7 offen offset:0 sc1
s_mov_b32 exec_hi, -1
v_mfma_f32_16x16x32_bf16 v[84:87], v[144:147], a[208:211], v[84:87]
ds_read_b64_tr_b16 v[134:135], v20 offset:7712
s_mov_b32 exec_hi, 0xffff
v_mfma_f32_16x16x32_bf16 v[96:99], v[144:147], a[212:215], v[96:99]
buffer_load_dwordx4 v[168:171], v9, s[44:47], s7 offen offset:768 sc1
s_mov_b32 exec_hi, -1
v_mfma_f32_16x16x32_bf16 v[108:111], v[144:147], a[216:219], v[108:111]
ds_read_b64_tr_b16 v[136:137], v20 offset:6208
s_mov_b32 exec_hi, 0xffff
v_mfma_f32_16x16x32_bf16 v[120:123], v[144:147], a[220:223], v[120:123]
buffer_load_dwordx4 v[172:175], v9, s[44:47], s7 offen offset:1536 sc1
s_mov_b32 exec_hi, -1
v_mfma_f32_16x16x32_bf16 v[88:91], v[148:151], a[208:211], v[88:91]
ds_read_b64_tr_b16 v[138:139], v20 offset:7744
v_mfma_f32_16x16x32_bf16 v[100:103], v[148:151], a[212:215], v[100:103]
s_mov_b32 exec_hi, 0xffff
buffer_load_dwordx4 v[176:179], v9, s[44:47], s7 offen offset:2304 sc1
v_mfma_f32_16x16x32_bf16 v[112:115], v[148:151], a[216:219], v[112:115]
s_mov_b32 exec_hi, -1
v_mfma_f32_16x16x32_bf16 v[124:127], v[148:151], a[220:223], v[124:127]
s_waitcnt lgkmcnt(0)
v_mfma_f32_16x16x32_bf16 v[80:83], v[128:131], a[224:227], v[80:83]
s_waitcnt vmcnt(10)
ds_read_b64_tr_b16 v[140:141], v20 offset:9216
v_mfma_f32_16x16x32_bf16 v[92:95], v[128:131], a[228:231], v[92:95]
ds_read_b64_tr_b16 v[142:143], v20 offset:10752
s_add_u32 s7, s63, 3072
v_mfma_f32_16x16x32_bf16 v[104:107], v[128:131], a[232:235], v[104:107]
ds_read_b64_tr_b16 v[144:145], v20 offset:9248
s_mov_b32 exec_hi, 0xffff
v_mfma_f32_16x16x32_bf16 v[116:119], v[128:131], a[236:239], v[116:119]
buffer_load_dwordx4 v[180:183], v9, s[44:47], s7 offen offset:0 sc1
s_mov_b32 exec_hi, -1
v_mfma_f32_16x16x32_bf16 v[84:87], v[132:135], a[224:227], v[84:87]
ds_read_b64_tr_b16 v[146:147], v20 offset:10784
s_mov_b32 exec_hi, 0xffff
v_mfma_f32_16x16x32_bf16 v[96:99], v[132:135], a[228:231], v[96:99]
buffer_load_dwordx4 v[184:187], v9, s[44:47], s7 offen offset:768 sc1
s_mov_b32 exec_hi, -1
v_mfma_f32_16x16x32_bf16 v[108:111], v[132:135], a[232:235], v[108:111]
ds_read_b64_tr_b16 v[148:149], v20 offset:9280
s_mov_b32 exec_hi, 0xffff
v_mfma_f32_16x16x32_bf16 v[120:123], v[132:135], a[236:239], v[120:123]
buffer_load_dwordx4 v[188:191], v9, s[44:47], s7 offen offset:1536 sc1
s_mov_b32 exec_hi, -1
v_mfma_f32_16x16x32_bf16 v[88:91], v[136:139], a[224:227], v[88:91]
ds_read_b64_tr_b16 v[150:151], v20 offset:10816
v_mfma_f32_16x16x32_bf16 v[100:103], v[136:139], a[228:231], v[100:103]
s_mov_b32 exec_hi, 0xffff
buffer_load_dwordx4 v[192:195], v9, s[44:47], s7 offen offset:2304 sc1
v_mfma_f32_16x16x32_bf16 v[112:115], v[136:139], a[232:235], v[112:115]
s_mov_b32 exec_hi, -1
v_mfma_f32_16x16x32_bf16 v[124:127], v[136:139], a[236:239], v[124:127]
s_waitcnt lgkmcnt(0)
v_mfma_f32_16x16x32_bf16 v[80:83], v[140:143], a[240:243], v[80:83]
s_waitcnt vmcnt(11)
ds_read_b64_tr_b16 v[128:129], v20 offset:12288
v_mfma_f32_16x16x32_bf16 v[92:95], v[140:143], a[244:247], v[92:95]
ds_read_b64_tr_b16 v[130:131], v20 offset:13824
v_mfma_f32_16x16x32_bf16 v[104:107], v[140:143], a[248:251], v[104:107]
ds_read_b64_tr_b16 v[132:133], v20 offset:12320
v_mfma_f32_16x16x32_bf16 v[116:119], v[140:143], a[252:255], v[116:119]
ds_read_b64_tr_b16 v[134:135], v20 offset:13856
v_mfma_f32_16x16x32_bf16 v[84:87], v[144:147], a[240:243], v[84:87]
ds_read_b64_tr_b16 v[136:137], v20 offset:12352
v_mfma_f32_16x16x32_bf16 v[96:99], v[144:147], a[244:247], v[96:99]
ds_read_b64_tr_b16 v[138:139], v20 offset:13888
v_mfma_f32_16x16x32_bf16 v[108:111], v[144:147], a[248:251], v[108:111]
v_mfma_f32_16x16x32_bf16 v[120:123], v[144:147], a[252:255], v[120:123]
v_mfma_f32_16x16x32_bf16 v[88:91], v[148:151], a[240:243], v[88:91]
v_mfma_f32_16x16x32_bf16 v[100:103], v[148:151], a[244:247], v[100:103]
v_mfma_f32_16x16x32_bf16 v[112:115], v[148:151], a[248:251], v[112:115]
v_mfma_f32_16x16x32_bf16 v[124:127], v[148:151], a[252:255], v[124:127]
s_waitcnt lgkmcnt(0)
v_mfma_f32_16x16x32_bf16 v[80:83], v[128:131], v[224:227], v[80:83]
s_waitcnt vmcnt(8)
ds_read_b64_tr_b16 v[140:141], v20 offset:15360
v_mfma_f32_16x16x32_bf16 v[92:95], v[128:131], v[228:231], v[92:95]
ds_read_b64_tr_b16 v[142:143], v20 offset:16896
v_mfma_f32_16x16x32_bf16 v[104:107], v[128:131], v[232:235], v[104:107]
ds_read_b64_tr_b16 v[144:145], v20 offset:15392
v_mfma_f32_16x16x32_bf16 v[116:119], v[128:131], v[236:239], v[116:119]
ds_read_b64_tr_b16 v[146:147], v20 offset:16928
v_mfma_f32_16x16x32_bf16 v[84:87], v[132:135], v[224:227], v[84:87]
ds_read_b64_tr_b16 v[148:149], v20 offset:15424
v_mfma_f32_16x16x32_bf16 v[96:99], v[132:135], v[228:231], v[96:99]
ds_read_b64_tr_b16 v[150:151], v20 offset:16960
v_mfma_f32_16x16x32_bf16 v[108:111], v[132:135], v[232:235], v[108:111]
v_mfma_f32_16x16x32_bf16 v[120:123], v[132:135], v[236:239], v[120:123]
v_mfma_f32_16x16x32_bf16 v[88:91], v[136:139], v[224:227], v[88:91]
v_mfma_f32_16x16x32_bf16 v[100:103], v[136:139], v[228:231], v[100:103]
v_mfma_f32_16x16x32_bf16 v[112:115], v[136:139], v[232:235], v[112:115]
v_mfma_f32_16x16x32_bf16 v[124:127], v[136:139], v[236:239], v[124:127]
s_waitcnt lgkmcnt(0)
v_mfma_f32_16x16x32_bf16 v[80:83], v[140:143], v[240:243], v[80:83]
v_mfma_f32_16x16x32_bf16 v[92:95], v[140:143], v[244:247], v[92:95]
s_add_u32 s6, s68, 12288
s_mov_b32 exec_lo, 0xff
s_mov_b32 exec_hi, 0x0
v_mfma_f32_16x16x32_bf16 v[104:107], v[140:143], v[248:251], v[104:107]
buffer_load_dword v31, v30, s[44:47], s6 offen sc1
s_mov_b64 exec, -1
v_mfma_f32_16x16x32_bf16 v[116:119], v[140:143], v[252:255], v[116:119]
v_mfma_f32_16x16x32_bf16 v[84:87], v[144:147], v[240:243], v[84:87]
v_mfma_f32_16x16x32_bf16 v[96:99], v[144:147], v[244:247], v[96:99]
v_mfma_f32_16x16x32_bf16 v[108:111], v[144:147], v[248:251], v[108:111]
v_mfma_f32_16x16x32_bf16 v[120:123], v[144:147], v[252:255], v[120:123]
v_mfma_f32_16x16x32_bf16 v[88:91], v[148:151], v[240:243], v[88:91]
v_mfma_f32_16x16x32_bf16 v[100:103], v[148:151], v[244:247], v[100:103]
v_mfma_f32_16x16x32_bf16 v[112:115], v[148:151], v[248:251], v[112:115]
v_mfma_f32_16x16x32_bf16 v[124:127], v[148:151], v[252:255], v[124:127]
v_cvt_pk_bf16_f32 v80, v80, v81
v_cvt_pk_bf16_f32 v81, v82, v83
v_cvt_pk_bf16_f32 v82, v84, v85
v_cvt_pk_bf16_f32 v83, v86, v87
s_add_u32 s53, s64, 196608
buffer_store_dwordx4 v[80:83], v26, s[44:47], s53 offen offset:0 sc1
v_cvt_pk_bf16_f32 v84, v88, v89
v_cvt_pk_bf16_f32 v85, v90, v91
v_cvt_pk_bf16_f32 v86, v92, v93
v_cvt_pk_bf16_f32 v87, v94, v95
s_add_u32 s53, s64, 196608
buffer_store_dwordx4 v[84:87], v26, s[44:47], s53 offen offset:256 sc1
v_cvt_pk_bf16_f32 v88, v96, v97
v_cvt_pk_bf16_f32 v89, v98, v99
v_cvt_pk_bf16_f32 v90, v100, v101
v_cvt_pk_bf16_f32 v91, v102, v103
s_add_u32 s53, s64, 196608
buffer_store_dwordx4 v[88:91], v26, s[44:47], s53 offen offset:512 sc1
v_cvt_pk_bf16_f32 v92, v104, v105
v_cvt_pk_bf16_f32 v93, v106, v107
v_cvt_pk_bf16_f32 v94, v108, v109
v_cvt_pk_bf16_f32 v95, v110, v111
s_add_u32 s53, s64, 294912
buffer_store_dwordx4 v[92:95], v26, s[44:47], s53 offen offset:0 sc1
v_cvt_pk_bf16_f32 v96, v112, v113
v_cvt_pk_bf16_f32 v97, v114, v115
v_cvt_pk_bf16_f32 v98, v116, v117
v_cvt_pk_bf16_f32 v99, v118, v119
s_add_u32 s53, s64, 294912
buffer_store_dwordx4 v[96:99], v26, s[44:47], s53 offen offset:256 sc1
v_cvt_pk_bf16_f32 v100, v120, v121
v_cvt_pk_bf16_f32 v101, v122, v123
v_cvt_pk_bf16_f32 v102, v124, v125
v_cvt_pk_bf16_f32 v103, v126, v127
s_add_u32 s53, s64, 294912
buffer_store_dwordx4 v[100:103], v26, s[44:47], s53 offen offset:512 sc1
v_mov_b32 v28, 0x3f80
v_mov_b32 v29, 1.0
ds_read_b128 v[128:131], v24 offset:0
ds_read_b128 v[132:135], v25 offset:0
ds_read_b128 v[136:139], v24 offset:768
ds_read_b128 v[140:143], v25 offset:768
ds_read_b128 v[144:147], v24 offset:1536
ds_read_b128 v[148:151], v25 offset:1536
s_waitcnt vmcnt(14)
v_lshlrev_b32 v196, 16, v164
v_and_b32 v197, 0xffff0000, v164
v_lshlrev_b32 v198, 16, v165
v_and_b32 v199, 0xffff0000, v165
v_lshlrev_b32 v200, 16, v166
v_and_b32 v201, 0xffff0000, v166
v_lshlrev_b32 v202, 16, v167
v_and_b32 v203, 0xffff0000, v167
s_waitcnt vmcnt(13)
v_dot2_f32_bf16 v196, v168, v28, v196
v_dot2_f32_bf16 v197, v168, v29, v197
v_dot2_f32_bf16 v198, v169, v28, v198
v_dot2_f32_bf16 v199, v169, v29, v199
v_dot2_f32_bf16 v200, v170, v28, v200
v_dot2_f32_bf16 v201, v170, v29, v201
v_dot2_f32_bf16 v202, v171, v28, v202
v_dot2_f32_bf16 v203, v171, v29, v203
s_waitcnt vmcnt(12)
v_dot2_f32_bf16 v196, v172, v28, v196
v_dot2_f32_bf16 v197, v172, v29, v197
v_dot2_f32_bf16 v198, v173, v28, v198
v_dot2_f32_bf16 v199, v173, v29, v199
v_dot2_f32_bf16 v200, v174, v28, v200
v_dot2_f32_bf16 v201, v174, v29, v201
v_dot2_f32_bf16 v202, v175, v28, v202
v_dot2_f32_bf16 v203, v175, v29, v203
s_waitcnt vmcnt(11)
v_dot2_f32_bf16 v196, v176, v28, v196
v_dot2_f32_bf16 v197, v176, v29, v197
v_dot2_f32_bf16 v198, v177, v28, v198
v_dot2_f32_bf16 v199, v177, v29, v199
v_dot2_f32_bf16 v200, v178, v28, v200
v_dot2_f32_bf16 v201, v178, v29, v201
v_dot2_f32_bf16 v202, v179, v28, v202
v_dot2_f32_bf16 v203, v179, v29, v203
s_waitcnt vmcnt(10)
v_dot2_f32_bf16 v196, v180, v28, v196
v_dot2_f32_bf16 v197, v180, v29, v197
v_dot2_f32_bf16 v198, v181, v28, v198
v_dot2_f32_bf16 v199, v181, v29, v199
v_dot2_f32_bf16 v200, v182, v28, v200
v_dot2_f32_bf16 v201, v182, v29, v201
v_dot2_f32_bf16 v202, v183, v28, v202
v_dot2_f32_bf16 v203, v183, v29, v203
s_waitcnt vmcnt(9)
v_dot2_f32_bf16 v196, v184, v28, v196
v_dot2_f32_bf16 v197, v184, v29, v197
v_dot2_f32_bf16 v198, v185, v28, v198
v_dot2_f32_bf16 v199, v185, v29, v199
v_dot2_f32_bf16 v200, v186, v28, v200
v_dot2_f32_bf16 v201, v186, v29, v201
v_dot2_f32_bf16 v202, v187, v28, v202
v_dot2_f32_bf16 v203, v187, v29, v203
s_waitcnt vmcnt(8)
v_dot2_f32_bf16 v196, v188, v28, v196
v_dot2_f32_bf16 v197, v188, v29, v197
v_dot2_f32_bf16 v198, v189, v28, v198
v_dot2_f32_bf16 v199, v189, v29, v199
v_dot2_f32_bf16 v200, v190, v28, v200
v_dot2_f32_bf16 v201, v190, v29, v201
v_dot2_f32_bf16 v202, v191, v28, v202
v_dot2_f32_bf16 v203, v191, v29, v203
s_waitcnt vmcnt(7)
v_dot2_f32_bf16 v196, v192, v28, v196
v_dot2_f32_bf16 v197, v192, v29, v197
v_dot2_f32_bf16 v198, v193, v28, v198
v_dot2_f32_bf16 v199, v193, v29, v199
v_dot2_f32_bf16 v200, v194, v28, v200
v_dot2_f32_bf16 v201, v194, v29, v201
v_dot2_f32_bf16 v202, v195, v28, v202
v_dot2_f32_bf16 v203, v195, v29, v203
v_lshlrev_b32 v204, 16, v152
v_and_b32 v205, 0xffff0000, v152
v_lshlrev_b32 v206, 16, v153
v_and_b32 v207, 0xffff0000, v153
v_lshlrev_b32 v208, 16, v154
v_and_b32 v209, 0xffff0000, v154
v_lshlrev_b32 v210, 16, v155
v_and_b32 v211, 0xffff0000, v155
s_waitcnt lgkmcnt(0)
v_pk_fma_f32 v[196:197], v[196:197], v[128:129], v[204:205]
v_pk_fma_f32 v[198:199], v[198:199], v[130:131], v[206:207]
v_pk_fma_f32 v[200:201], v[200:201], v[132:133], v[208:209]
v_pk_fma_f32 v[202:203], v[202:203], v[134:135], v[210:211]
v_cvt_pk_bf16_f32 v212, v196, v197
v_cvt_pk_bf16_f32 v213, v198, v199
v_cvt_pk_bf16_f32 v214, v200, v201
v_cvt_pk_bf16_f32 v215, v202, v203
ds_bpermute_b32 v212, v27, v212
ds_bpermute_b32 v213, v27, v213
ds_bpermute_b32 v214, v27, v214
ds_bpermute_b32 v215, v27, v215
s_waitcnt vmcnt(0)
s_mul_i32 s53, s51, 24
s_add_u32 s53, s53, s48
s_lshl_b32 s53, s53, 3
s_add_u32 s53, s53, s52
s_lshl_b32 s53, s53, 7
s_add_u32 s53, s53, 212992
s_mov_b64 exec, 1
buffer_store_dword v21, v9, s[44:47], s53 offen sc1
s_mov_b64 exec, -1
s_mov_b32 exec_lo, 0xff
s_mov_b32 exec_hi, 0x0
v_cmp_ne_u32 vcc, v21, v31
s_nop 4
s_cbranch_vccz L_poll8d
s_mov_b32 s77, 0x20000
L_poll8:
buffer_load_dword v31, v30, s[44:47], s6 offen sc1
s_waitcnt vmcnt(0)
v_cmp_ne_u32 vcc, v21, v31
s_nop 4
s_cbranch_vccz L_poll8d
s_sub_u32 s77, s77, 1
s_cmp_lg_u32 s77, 0
s_cbranch_scc1 L_poll8
L_poll8d:
s_mov_b64 exec, -1
s_mov_b32 exec_hi, 0xffff
s_add_u32 s7, s63, 411648
buffer_load_dwordx4 v[32:35], v9, s[44:47], s7 offen offset:0 sc1
buffer_load_dwordx4 v[36:39], v9, s[44:47], s7 offen offset:768 sc1
buffer_load_dwordx4 v[40:43], v9, s[44:47], s7 offen offset:1536 sc1
buffer_load_dwordx4 v[44:47], v9, s[44:47], s7 offen offset:2304 sc1
s_add_u32 s7, s63, 414720
buffer_load_dwordx4 v[48:51], v9, s[44:47], s7 offen offset:0 sc1
buffer_load_dwordx4 v[52:55], v9, s[44:47], s7 offen offset:768 sc1
buffer_load_dwordx4 v[56:59], v9, s[44:47], s7 offen offset:1536 sc1
buffer_load_dwordx4 v[60:63], v9, s[44:47], s7 offen offset:2304 sc1
s_mov_b32 exec_hi, -1
s_waitcnt lgkmcnt(0)
s_mov_b32 exec_hi, 0xffff
buffer_store_dwordx2 v[212:213], v22, s[36:39], s65 offen offset:0
buffer_store_dwordx2 v[214:215], v23, s[36:39], s65 offen offset:0
s_mov_b32 exec_hi, -1
s_add_u32 s6, s68, 16384
s_mov_b32 exec_lo, 0xff
s_mov_b32 exec_hi, 0x0
buffer_load_dword v31, v30, s[44:47], s6 offen sc1
s_mov_b64 exec, -1
s_waitcnt vmcnt(10)
v_lshlrev_b32 v196, 16, v32
v_and_b32 v197, 0xffff0000, v32
v_lshlrev_b32 v198, 16, v33
v_and_b32 v199, 0xffff0000, v33
v_lshlrev_b32 v200, 16, v34
v_and_b32 v201, 0xffff0000, v34
v_lshlrev_b32 v202, 16, v35
v_and_b32 v203, 0xffff0000, v35
s_waitcnt vmcnt(9)
v_dot2_f32_bf16 v196, v36, v28, v196
v_dot2_f32_bf16 v197, v36, v29, v197
v_dot2_f32_bf16 v198, v37, v28, v198
v_dot2_f32_bf16 v199, v37, v29, v199
v_dot2_f32_bf16 v200, v38, v28, v200
v_dot2_f32_bf16 v201, v38, v29, v201
v_dot2_f32_bf16 v202, v39, v28, v202
v_dot2_f32_bf16 v203, v39, v29, v203
s_waitcnt vmcnt(8)
v_dot2_f32_bf16 v196, v40, v28, v196
v_dot2_f32_bf16 v197, v40, v29, v197
v_dot2_f32_bf16 v198, v41, v28, v198
v_dot2_f32_bf16 v199, v41, v29, v199
v_dot2_f32_bf16 v200, v42, v28, v200
v_dot2_f32_bf16 v201, v42, v29, v201
v_dot2_f32_bf16 v202, v43, v28, v202
v_dot2_f32_bf16 v203, v43, v29, v203
s_waitcnt vmcnt(7)
v_dot2_f32_bf16 v196, v44, v28, v196
v_dot2_f32_bf16 v197, v44, v29, v197
v_dot2_f32_bf16 v198, v45, v28, v198
v_dot2_f32_bf16 v199, v45, v29, v199
v_dot2_f32_bf16 v200, v46, v28, v200
v_dot2_f32_bf16 v201, v46, v29, v201
v_dot2_f32_bf16 v202, v47, v28, v202
v_dot2_f32_bf16 v203, v47, v29, v203
s_waitcnt vmcnt(6)
v_dot2_f32_bf16 v196, v48, v28, v196
v_dot2_f32_bf16 v197, v48, v29, v197
v_dot2_f32_bf16 v198, v49, v28, v198
v_dot2_f32_bf16 v199, v49, v29, v199
v_dot2_f32_bf16 v200, v50, v28, v200
v_dot2_f32_bf16 v201, v50, v29, v201
v_dot2_f32_bf16 v202, v51, v28, v202
v_dot2_f32_bf16 v203, v51, v29, v203
s_waitcnt vmcnt(5)
v_dot2_f32_bf16 v196, v52, v28, v196
v_dot2_f32_bf16 v197, v52, v29, v197
v_dot2_f32_bf16 v198, v53, v28, v198
v_dot2_f32_bf16 v199, v53, v29, v199
v_dot2_f32_bf16 v200, v54, v28, v200
v_dot2_f32_bf16 v201, v54, v29, v201
v_dot2_f32_bf16 v202, v55, v28, v202
v_dot2_f32_bf16 v203, v55, v29, v203
s_waitcnt vmcnt(4)
v_dot2_f32_bf16 v196, v56, v28, v196
v_dot2_f32_bf16 v197, v56, v29, v197
v_dot2_f32_bf16 v198, v57, v28, v198
v_dot2_f32_bf16 v199, v57, v29, v199
v_dot2_f32_bf16 v200, v58, v28, v200
v_dot2_f32_bf16 v201, v58, v29, v201
v_dot2_f32_bf16 v202, v59, v28, v202
v_dot2_f32_bf16 v203, v59, v29, v203
s_waitcnt vmcnt(3)
v_dot2_f32_bf16 v196, v60, v28, v196
v_dot2_f32_bf16 v197, v60, v29, v197
v_dot2_f32_bf16 v198, v61, v28, v198
v_dot2_f32_bf16 v199, v61, v29, v199
v_dot2_f32_bf16 v200, v62, v28, v200
v_dot2_f32_bf16 v201, v62, v29, v201
v_dot2_f32_bf16 v202, v63, v28, v202
v_dot2_f32_bf16 v203, v63, v29, v203
v_lshlrev_b32 v204, 16, v156
v_and_b32 v205, 0xffff0000, v156
v_lshlrev_b32 v206, 16, v157
v_and_b32 v207, 0xffff0000, v157
v_lshlrev_b32 v208, 16, v158
v_and_b32 v209, 0xffff0000, v158
v_lshlrev_b32 v210, 16, v159
v_and_b32 v211, 0xffff0000, v159
v_pk_fma_f32 v[196:197], v[196:197], v[136:137], v[204:205]
v_pk_fma_f32 v[198:199], v[198:199], v[138:139], v[206:207]
v_pk_fma_f32 v[200:201], v[200:201], v[140:141], v[208:209]
v_pk_fma_f32 v[202:203], v[202:203], v[142:143], v[210:211]
v_cvt_pk_bf16_f32 v216, v196, v197
v_cvt_pk_bf16_f32 v217, v198, v199
v_cvt_pk_bf16_f32 v218, v200, v201
v_cvt_pk_bf16_f32 v219, v202, v203
ds_bpermute_b32 v216, v27, v216
ds_bpermute_b32 v217, v27, v217
ds_bpermute_b32 v218, v27, v218
ds_bpermute_b32 v219, v27, v219
s_mov_b32 exec_lo, 0xff
s_mov_b32 exec_hi, 0x0
s_waitcnt vmcnt(0)
v_cmp_ne_u32 vcc, v21, v31
s_nop 4
s_cbranch_vccz L_poll9d
s_mov_b32 s77, 0x20000
L_poll9:
buffer_load_dword v31, v30, s[44:47], s6 offen sc1
s_waitcnt vmcnt(0)
v_cmp_ne_u32 vcc, v21, v31
s_nop 4
s_cbranch_vccz L_poll9d
s_sub_u32 s77, s77, 1
s_cmp_lg_u32 s77, 0
s_cbranch_scc1 L_poll9
L_poll9d:
s_mov_b64 exec, -1
s_mov_b32 exec_hi, 0xffff
s_add_u32 s7, s63, 196608
buffer_load_dwordx4 v[164:167], v9, s[44:47], s7 offen offset:0 sc1
buffer_load_dwordx4 v[168:171], v9, s[44:47], s7 offen offset:768 sc1
buffer_load_dwordx4 v[172:175], v9, s[44:47], s7 offen offset:1536 sc1
buffer_load_dwordx4 v[176:179], v9, s[44:47], s7 offen offset:2304 sc1
s_add_u32 s7, s63, 199680
buffer_load_dwordx4 v[180:183], v9, s[44:47], s7 offen offset:0 sc1
buffer_load_dwordx4 v[184:187], v9, s[44:47], s7 offen offset:768 sc1
buffer_load_dwordx4 v[188:191], v9, s[44:47], s7 offen offset:1536 sc1
buffer_load_dwordx4 v[192:195], v9, s[44:47], s7 offen offset:2304 sc1
s_mov_b32 exec_hi, -1
s_waitcnt lgkmcnt(0)
s_mov_b32 exec_hi, 0xffff
buffer_store_dwordx2 v[216:217], v22, s[36:39], s65 offen offset:384
buffer_store_dwordx2 v[218:219], v23, s[36:39], s65 offen offset:384
s_mov_b32 exec_hi, -1
s_waitcnt vmcnt(9)
v_lshlrev_b32 v196, 16, v164
v_and_b32 v197, 0xffff0000, v164
v_lshlrev_b32 v198, 16, v165
v_and_b32 v199, 0xffff0000, v165
v_lshlrev_b32 v200, 16, v166
v_and_b32 v201, 0xffff0000, v166
v_lshlrev_b32 v202, 16, v167
v_and_b32 v203, 0xffff0000, v167
s_waitcnt vmcnt(8)
v_dot2_f32_bf16 v196, v168, v28, v196
v_dot2_f32_bf16 v197, v168, v29, v197
v_dot2_f32_bf16 v198, v169, v28, v198
v_dot2_f32_bf16 v199, v169, v29, v199
v_dot2_f32_bf16 v200, v170, v28, v200
v_dot2_f32_bf16 v201, v170, v29, v201
v_dot2_f32_bf16 v202, v171, v28, v202
v_dot2_f32_bf16 v203, v171, v29, v203
s_waitcnt vmcnt(7)
v_dot2_f32_bf16 v196, v172, v28, v196
v_dot2_f32_bf16 v197, v172, v29, v197
v_dot2_f32_bf16 v198, v173, v28, v198
v_dot2_f32_bf16 v199, v173, v29, v199
v_dot2_f32_bf16 v200, v174, v28, v200
v_dot2_f32_bf16 v201, v174, v29, v201
v_dot2_f32_bf16 v202, v175, v28, v202
v_dot2_f32_bf16 v203, v175, v29, v203
s_waitcnt vmcnt(6)
v_dot2_f32_bf16 v196, v176, v28, v196
v_dot2_f32_bf16 v197, v176, v29, v197
v_dot2_f32_bf16 v198, v177, v28, v198
v_dot2_f32_bf16 v199, v177, v29, v199
v_dot2_f32_bf16 v200, v178, v28, v200
v_dot2_f32_bf16 v201, v178, v29, v201
v_dot2_f32_bf16 v202, v179, v28, v202
v_dot2_f32_bf16 v203, v179, v29, v203
s_waitcnt vmcnt(5)
v_dot2_f32_bf16 v196, v180, v28, v196
v_dot2_f32_bf16 v197, v180, v29, v197
v_dot2_f32_bf16 v198, v181, v28, v198
v_dot2_f32_bf16 v199, v181, v29, v199
v_dot2_f32_bf16 v200, v182, v28, v200
v_dot2_f32_bf16 v201, v182, v29, v201
v_dot2_f32_bf16 v202, v183, v28, v202
v_dot2_f32_bf16 v203, v183, v29, v203
s_waitcnt vmcnt(4)
v_dot2_f32_bf16 v196, v184, v28, v196
v_dot2_f32_bf16 v197, v184, v29, v197
v_dot2_f32_bf16 v198, v185, v28, v198
v_dot2_f32_bf16 v199, v185, v29, v199
v_dot2_f32_bf16 v200, v186, v28, v200
v_dot2_f32_bf16 v201, v186, v29, v201
v_dot2_f32_bf16 v202, v187, v28, v202
v_dot2_f32_bf16 v203, v187, v29, v203
s_waitcnt vmcnt(3)
v_dot2_f32_bf16 v196, v188, v28, v196
v_dot2_f32_bf16 v197, v188, v29, v197
v_dot2_f32_bf16 v198, v189, v28, v198
v_dot2_f32_bf16 v199, v189, v29, v199
v_dot2_f32_bf16 v200, v190, v28, v200
v_dot2_f32_bf16 v201, v190, v29, v201
v_dot2_f32_bf16 v202, v191, v28, v202
v_dot2_f32_bf16 v203, v191, v29, v203
s_waitcnt vmcnt(2)
v_dot2_f32_bf16 v196, v192, v28, v196
v_dot2_f32_bf16 v197, v192, v29, v197
v_dot2_f32_bf16 v198, v193, v28, v198
v_dot2_f32_bf16 v199, v193, v29, v199
v_dot2_f32_bf16 v200, v194, v28, v200
v_dot2_f32_bf16 v201, v194, v29, v201
v_dot2_f32_bf16 v202, v195, v28, v202
v_dot2_f32_bf16 v203, v195, v29, v203
v_lshlrev_b32 v204, 16, v160
v_and_b32 v205, 0xffff0000, v160
v_lshlrev_b32 v206, 16, v161
v_and_b32 v207, 0xffff0000, v161
v_lshlrev_b32 v208, 16, v162
v_and_b32 v209, 0xffff0000, v162
v_lshlrev_b32 v210, 16, v163
v_and_b32 v211, 0xffff0000, v163
v_pk_fma_f32 v[196:197], v[196:197], v[144:145], v[204:205]
v_pk_fma_f32 v[198:199], v[198:199], v[146:147], v[206:207]
v_pk_fma_f32 v[200:201], v[200:201], v[148:149], v[208:209]
v_pk_fma_f32 v[202:203], v[202:203], v[150:151], v[210:211]
v_cvt_pk_bf16_f32 v220, v196, v197
v_cvt_pk_bf16_f32 v221, v198, v199
v_cvt_pk_bf16_f32 v222, v200, v201
v_cvt_pk_bf16_f32 v223, v202, v203
ds_bpermute_b32 v220, v27, v220
ds_bpermute_b32 v221, v27, v221
ds_bpermute_b32 v222, v27, v222
ds_bpermute_b32 v223, v27, v223
s_waitcnt lgkmcnt(0)
s_mov_b32 exec_hi, 0xffff
buffer_store_dwordx2 v[220:221], v22, s[36:39], s65 offen offset:768
buffer_store_dwordx2 v[222:223], v23, s[36:39], s65 offen offset:768
s_mov_b32 exec_hi, -1
L_end:
s_endpgm
.section .rodata,"a"
.p2align 6
.amdhsa_kernel adaLN_cond__sliding_local_dilated__dense_activation_relu__prompt_kernel
  .amdhsa_next_free_vgpr 512
  .amdhsa_next_free_sgpr 102
  .amdhsa_accum_offset 256
  .amdhsa_group_segment_fixed_size 0
  .amdhsa_kernarg_size 88
  .amdhsa_user_sgpr_count 2
  .amdhsa_user_sgpr_kernarg_segment_ptr 1
  .amdhsa_system_sgpr_workgroup_id_x 1
.end_amdhsa_kernel
```
